```python
import torch

def _softmax(x, axis=-1):
    return torch.softmax(x, dim=axis)
def _gelu(x):
    return torch.nn.functional.gelu(x, approximate="tanh")
def _silu(x):
    return torch.nn.functional.silu(x)
def _sigmoid(x):
    return torch.sigmoid(x)
def _layernorm(x, axis=-1, eps=1e-5):
    m = x.mean(dim=axis, keepdim=True)
    v = x.var(dim=axis, keepdim=True, unbiased=False)
    return (x - m) / torch.sqrt(v + eps)
def _scatter_add(tgt, idx, src, axis=0):
    return tgt.clone().index_add_(axis, idx, src)
def _segment_sum(src, seg, n):
    out = torch.zeros((n,) + src.shape[1:], dtype=src.dtype)
    return out.index_add_(0, seg, src)
def _pad(x, pw):
    flat = tuple(v for pair in reversed(pw) for v in pair)
    return torch.nn.functional.pad(x, flat)

kernel_name = 'concat_heads__ssm_conv_s5__mha_block__prompt'

def setup_inputs():

    _w = (lambda a: (lambda t: t.to(torch.bfloat16) if t.is_floating_point() else t)(torch.as_tensor(a)))
    def _A_setup():
        B, S, D = 1, 2048, 640
        P = D
        Lambda_re = -0.5 * (lambda _x: torch.exp(torch.as_tensor(_x)))((lambda *s: torch.randn(*s, dtype=torch.bfloat16) * 0.8)(P))
        Lambda_im = (lambda *s: torch.randn(*s, dtype=torch.bfloat16) * 0.8)(P) * 1.0
        B_re = (lambda *s: torch.randn(*s, dtype=torch.bfloat16) * 0.8)(P, D) * (D ** -0.5)
        B_im = (lambda *s: torch.randn(*s, dtype=torch.bfloat16) * 0.8)(P, D) * (D ** -0.5)
        C_re = (lambda *s: torch.randn(*s, dtype=torch.bfloat16) * 0.8)(D, P) * (P ** -0.5)
        C_im = (lambda *s: torch.randn(*s, dtype=torch.bfloat16) * 0.8)(D, P) * (P ** -0.5)
        log_dt = (lambda *s: torch.randn(*s, dtype=torch.bfloat16) * 0.8)(P) * 0.3 - 2.0
        Dskip = (lambda *s: torch.randn(*s, dtype=torch.bfloat16) * 0.8)(D)
        return {
            "x": _w((lambda *s: torch.randn(*s, dtype=torch.bfloat16) * 0.05)(B, S, D)),
            "Lambda_re": _w(Lambda_re),
            "Lambda_im": _w(Lambda_im),
            "B_re": _w(B_re),
            "B_im": _w(B_im),
            "C_re": _w(C_re),
            "C_im": _w(C_im),
            "log_dt": _w(log_dt),
            "Dskip": _w(Dskip),
        }
    _A_in = _A_setup()

    def _B_setup():
        B, S, D, H = 1, 2048, 640, 32
        return {
            "x": _w((lambda *s: torch.randn(*s, dtype=torch.bfloat16) * 0.2)(B, S, D)),
            "wqkv": _w((lambda *s: torch.randn(*s, dtype=torch.bfloat16) * 0.2)(D, 3 * D)),
            "wo": _w((lambda *s: torch.randn(*s, dtype=torch.bfloat16) * 0.05)(D, D)),
        }
    _B_in = _B_setup()

    return {
        "A_x": _A_in["x"],
        "A_Lambda_re": _A_in["Lambda_re"],
        "A_Lambda_im": _A_in["Lambda_im"],
        "A_B_re": _A_in["B_re"],
        "A_B_im": _A_in["B_im"],
        "A_C_re": _A_in["C_re"],
        "A_C_im": _A_in["C_im"],
        "A_log_dt": _A_in["log_dt"],
        "A_Dskip": _A_in["Dskip"],
        "B_x": _B_in["x"],
        "B_wqkv": _B_in["wqkv"],
        "B_wo": _B_in["wo"],
    }

def reference(A_x, A_Lambda_re, A_Lambda_im, A_B_re, A_B_im, A_C_re, A_C_im, A_log_dt, A_Dskip, B_x, B_wqkv, B_wo):
    def _A_ref(x, Lambda_re, Lambda_im, B_re, B_im, C_re, C_im, log_dt, Dskip):
        Bsz, L, H = x.shape
        Lam = Lambda_re + 1j * Lambda_im
        Bmat = B_re + 1j * B_im
        Cmat = C_re + 1j * C_im
        dt = torch.exp(log_dt)
        Lam_bar = torch.exp(dt * Lam)
        B_bar = ((Lam_bar - 1.0) / Lam)[:, None] * Bmat
        Bu = torch.einsum("bld,pd->blp", x + 0j, B_bar)
        h = torch.zeros_like(Bu[:, 0, :])
        hs = []
        for t in range(L):
            h = Lam_bar[None, :] * h + Bu[:, t, :]
            hs.append(h)
        hseq = torch.stack(hs, 1)
        y = 2.0 * torch.einsum("blp,dp->bld", hseq, Cmat).real + x * Dskip[None, None, :]
        return y

    def _B_ref(x, wqkv, wo):
        B, S, D = x.shape
        H = 32
        Dh = D // H
        qkv = (lambda x, *d: x.permute(*d))((x @ wqkv).reshape(B, S, 3, H, Dh), 2, 0, 3, 1, 4)
        q, k, v = qkv[0], qkv[1], qkv[2]
        scores = torch.einsum("bhqd,bhkd->bhqk", q, k) * (Dh ** -0.5)
        p = _softmax(scores, axis=-1)
        o = torch.einsum("bhqk,bhkd->bhqd", p, v)
        return (lambda x, *d: x.permute(*d))(o, 0, 2, 1, 3).reshape(B, S, D) @ wo

    a = _A_ref(A_x, A_Lambda_re, A_Lambda_im, A_B_re, A_B_im, A_C_re, A_C_im, A_log_dt, A_Dskip)
    b = _B_ref(B_x, B_wqkv, B_wo)
    return torch.concatenate([a, b], axis=-1)
```

```asm
; @launch grid=(256,1,1) block=(512,1,1) lds=163840
.amdgcn_target "amdgcn-amd-amdhsa--gfx950"
.text
.globl concat_heads__ssm_conv_s5__mha_block__prompt_kernel
.p2align 8
.type concat_heads__ssm_conv_s5__mha_block__prompt_kernel,@function
concat_heads__ssm_conv_s5__mha_block__prompt_kernel:
    s_cmp_ge_u32 s2, 256
    s_cbranch_scc1 L_end
    s_load_dwordx4 s[4:7], s[0:1], 72
    s_load_dwordx2 s[10:11], s[0:1], 0
    s_load_dwordx4 s[48:51], s[0:1], 104
    v_lshrrev_b32 v1, 6, v0
    v_and_b32 v2, 63, v0
    v_readfirstlane_b32 s29, v1
    s_and_b32 s24, s2, 7
    s_lshr_b32 s25, s2, 3
    s_cmp_ge_u32 s25, 20
    s_cselect_b32 s28, 1, 0
    s_cselect_b32 s43, 20, 0
    s_cselect_b32 s32, 1, 2
    s_cselect_b32 s33, 5, 3
    s_sub_u32 s43, s25, s43
    s_lshr_b32 s27, s43, s32
    s_lshl_b32 s30, s27, s32
    s_sub_u32 s43, s43, s30
    s_and_b32 s30, s24, 3
    s_lshl_b32 s26, s30, s32
    s_add_u32 s26, s26, s43
    s_mul_i32 s98, s43, s33
    s_add_u32 s98, s98, s30
    s_lshl_b32 s30, s27, 1
    s_add_u32 s98, s98, s30
    s_mul_i32 s30, s98, 6554
    s_lshr_b32 s30, s30, 16
    s_mul_i32 s30, s30, 10
    s_sub_u32 s98, s98, s30
    s_lshr_b32 s31, s24, 2
    s_mul_i32 s31, s31, 5
    s_add_u32 s27, s27, s31
    s_and_b32 s38, s29, 3
    s_mov_b32 s36, s28
    s_cmp_ge_u32 s25, 30
    s_cbranch_scc1 L_P
    s_cmp_lt_u32 s29, 4
    s_cbranch_scc1 L_comp
    s_lshl_b32 s30, s26, 7
    s_lshl_b32 s31, s38, 5
    s_add_u32 s35, s30, s31
    s_lshl_b32 s35, s35, s28
    v_lshrrev_b32 v3, 3, v2
    v_add_u32 v9, s35, v3
    v_mul_u32_u24 v9, 1280, v9
    v_lshrrev_b32 v8, 4, v2
    v_and_b32 v10, 7, v2
    v_xor_b32 v10, v10, v8
    v_xor_b32 v11, 4, v10
    s_lshl_b32 s31, s28, 2
    s_xor_b32 s30, s31, 4
    v_lshl_add_u32 v4, v10, 4, v9
    v_xor_b32 v8, 4, v10
    v_lshl_add_u32 v5, v8, 4, v9
    v_add_u32 v5, 9216, v5
    v_xor_b32 v8, s30, v10
    v_lshl_add_u32 v6, v8, 4, v9
    v_add_u32 v6, 18432, v6
    v_xor_b32 v8, s31, v10
    v_lshl_add_u32 v7, v8, 4, v9
    v_add_u32 v7, 27648, v7
    s_lshl_b32 s34, s38, 12
    s_lshl_b32 s34, s34, s28
    s_cmp_eq_u32 s28, 0
    s_waitcnt lgkmcnt(0)
    s_cselect_b32 s12, s4, s10
    s_cselect_b32 s13, s5, s11
    s_and_b32 s13, s13, 0xffff
    s_mov_b32 s14, 2621440
    s_mov_b32 s15, 0x00020000
    s_add_u32 m0, s34, 0
    s_lshl_b32 s32, s98, 7
    buffer_load_dwordx4 v4, s[12:15], s32 offen offset:0 lds
    buffer_load_dwordx4 v5, s[12:15], s32 offen offset:1024 lds
    buffer_load_dwordx4 v6, s[12:15], s32 offen offset:2048 lds
    buffer_load_dwordx4 v7, s[12:15], s32 offen offset:3072 lds
    s_cmp_lg_u32 s28, 0
    s_cbranch_scc1 L_loadB
    s_mov_b32 s16, s6
    s_and_b32 s17, s7, 0xffff
    s_mov_b32 s18, 2457600
    s_mov_b32 s19, 0x00020000
    s_mul_i32 s30, s27, 384
    s_mul_i32 s31, s38, 61440
    s_add_u32 s30, s30, s31
    v_add_u32 v8, 0, v2
    v_mul_u32_u24 v9, 2731, v8
    v_lshrrev_b32 v9, 16, v9
    v_and_b32 v18, 2, v9
    v_mul_u32_u24 v19, 24, v9
    v_sub_u32 v8, v8, v19
    v_lshlrev_b32 v18, 1, v18
    v_xor_b32 v8, v8, v18
    v_mul_u32_u24 v9, 3840, v9
    v_add_u32 v9, s30, v9
    v_lshl_add_u32 v12, v8, 4, v9
    v_xor_b32 v8, 2, v8
    v_lshl_add_u32 v9, v8, 4, v9
    v_add_u32 v15, 27648, v9
    v_add_u32 v8, 64, v2
    v_mul_u32_u24 v9, 2731, v8
    v_lshrrev_b32 v9, 16, v9
    v_and_b32 v18, 2, v9
    v_mul_u32_u24 v19, 24, v9
    v_sub_u32 v8, v8, v19
    v_lshlrev_b32 v18, 1, v18
    v_xor_b32 v8, v8, v18
    v_mul_u32_u24 v9, 3840, v9
    v_add_u32 v9, s30, v9
    v_lshl_add_u32 v13, v8, 4, v9
    v_subrev_u32 v13, 1024, v13
    v_xor_b32 v8, 2, v8
    v_lshl_add_u32 v9, v8, 4, v9
    v_add_u32 v16, 30720, v9
    v_add_u32 v8, 128, v2
    v_mul_u32_u24 v9, 2731, v8
    v_lshrrev_b32 v9, 16, v9
    v_and_b32 v18, 2, v9
    v_mul_u32_u24 v19, 24, v9
    v_sub_u32 v8, v8, v19
    v_lshlrev_b32 v18, 1, v18
    v_xor_b32 v8, v8, v18
    v_mul_u32_u24 v9, 3840, v9
    v_add_u32 v9, s30, v9
    v_lshl_add_u32 v14, v8, 4, v9
    v_subrev_u32 v14, 2048, v14
    v_xor_b32 v8, 2, v8
    v_lshl_add_u32 v9, v8, 4, v9
    v_add_u32 v17, 29696, v9
    s_mul_i32 s35, s38, 6144
    s_add_u32 m0, s35, 16384
    s_mul_i32 s33, s98, 245760
    buffer_load_dwordx4 v12, s[16:19], s33 offen offset:0 lds
    buffer_load_dwordx4 v13, s[16:19], s33 offen offset:1024 lds
    buffer_load_dwordx4 v14, s[16:19], s33 offen offset:2048 lds
    buffer_load_dwordx4 v15, s[16:19], s33 offen offset:3072 lds
    s_add_u32 m0, s35, 20480
    s_nop 0
    buffer_load_dwordx4 v16, s[16:19], s33 offen offset:0 lds
    buffer_load_dwordx4 v17, s[16:19], s33 offen offset:1024 lds
    s_add_u32 s98, s98, 1
    s_cmp_eq_u32 s98, 10
    s_cselect_b32 s98, 0, s98
    s_add_u32 m0, s34, 40960
    s_lshl_b32 s32, s98, 7
    buffer_load_dwordx4 v4, s[12:15], s32 offen offset:0 lds
    buffer_load_dwordx4 v5, s[12:15], s32 offen offset:1024 lds
    buffer_load_dwordx4 v6, s[12:15], s32 offen offset:2048 lds
    buffer_load_dwordx4 v7, s[12:15], s32 offen offset:3072 lds
    s_add_u32 m0, s35, 57344
    s_mul_i32 s33, s98, 245760
    buffer_load_dwordx4 v12, s[16:19], s33 offen offset:0 lds
    buffer_load_dwordx4 v13, s[16:19], s33 offen offset:1024 lds
    buffer_load_dwordx4 v14, s[16:19], s33 offen offset:2048 lds
    buffer_load_dwordx4 v15, s[16:19], s33 offen offset:3072 lds
    s_add_u32 m0, s35, 61440
    s_nop 0
    buffer_load_dwordx4 v16, s[16:19], s33 offen offset:0 lds
    buffer_load_dwordx4 v17, s[16:19], s33 offen offset:1024 lds
    s_add_u32 s98, s98, 1
    s_cmp_eq_u32 s98, 10
    s_cselect_b32 s98, 0, s98
    s_branch L_loadA
L_loadB:
    s_load_dwordx4 s[68:71], s[0:1], 24
    s_add_u32 s35, s35, 32
    v_add_u32 v9, s35, v3
    v_mul_u32_u24 v9, 1280, v9
    v_lshl_add_u32 v12, v11, 4, v9
    v_lshl_add_u32 v13, v10, 4, v9
    v_add_u32 v13, 9216, v13
    v_lshl_add_u32 v14, v11, 4, v9
    v_add_u32 v14, 18432, v14
    v_lshl_add_u32 v15, v10, 4, v9
    v_add_u32 v15, 27648, v15
    s_add_u32 m0, s34, 4096
    s_nop 0
    buffer_load_dwordx4 v12, s[12:15], s32 offen offset:0 lds
    buffer_load_dwordx4 v13, s[12:15], s32 offen offset:1024 lds
    buffer_load_dwordx4 v14, s[12:15], s32 offen offset:2048 lds
    buffer_load_dwordx4 v15, s[12:15], s32 offen offset:3072 lds
    s_lshl_b32 s30, s27, 6
    s_and_b32 s31, s38, 1
    s_lshl_b32 s31, s31, 5
    s_add_u32 s35, s30, s31
    v_add_u32 v9, s35, v3
    v_mul_u32_u24 v9, 1280, v9
    v_lshl_add_u32 v16, v10, 4, v9
    v_lshl_add_u32 v17, v11, 4, v9
    v_add_u32 v17, 9216, v17
    v_lshl_add_u32 v18, v10, 4, v9
    v_add_u32 v18, 18432, v18
    v_lshl_add_u32 v19, v11, 4, v9
    v_add_u32 v19, 27648, v19
    s_lshl_b32 s35, s38, 12
    s_cmp_lt_u32 s38, 2
    s_waitcnt lgkmcnt(0)
    s_cselect_b32 s16, s68, s70
    s_cselect_b32 s17, s69, s71
    s_and_b32 s17, s17, 0xffff
    s_mov_b32 s18, 819200
    s_mov_b32 s19, 0x00020000
    s_add_u32 m0, s35, 32768
    s_nop 0
    buffer_load_dwordx4 v16, s[16:19], s32 offen offset:0 lds
    buffer_load_dwordx4 v17, s[16:19], s32 offen offset:1024 lds
    buffer_load_dwordx4 v18, s[16:19], s32 offen offset:2048 lds
    buffer_load_dwordx4 v19, s[16:19], s32 offen offset:3072 lds
    s_add_u32 s98, s98, 1
    s_cmp_eq_u32 s98, 10
    s_cselect_b32 s98, 0, s98
    s_add_u32 s8, s50, 0
    s_addc_u32 s9, s51, 0
    s_and_b32 s49, s49, 0xffff
    s_mov_b32 s50, 256
    s_mov_b32 s51, 0x00020000
    s_add_u32 s44, s8, 18022400
    s_addc_u32 s45, s9, 0
    s_and_b32 s45, s45, 0xffff
    s_mov_b32 s46, 282884
    s_mov_b32 s47, 0x00020000
    v_mov_b32 v107, 0x7f000000
    v_mov_b32 v116, 0x7f000000
    v_mov_b32 v118, 0x7f000000
    v_mov_b32 v248, 0x7f000000
    v_mov_b32 v249, 0x7f000000
    v_mov_b32 v250, 0x7f000000
    v_mov_b32 v251, 0x7f000000
    s_lshl_b32 s39, s24, 2
    s_lshr_b32 s32, s25, 3
    s_add_u32 s39, s39, s32
    s_and_b32 s42, s25, 7
    s_mov_b32 s37, 0
    v_mov_b32 v25, 0
    s_lshl_b32 s30, s27, 6
    v_add_u32 v20, s30, v2
    s_load_dwordx4 s[4:7], s[0:1], 8
    s_load_dwordx2 s[10:11], s[0:1], 56
    v_lshlrev_b32 v20, 1, v20
    s_waitcnt lgkmcnt(0)
    s_mov_b32 s64, s4
    s_and_b32 s65, s5, 0xffff
    s_mov_b32 s66, 1280
    s_mov_b32 s67, 0x00020000
    buffer_load_ushort v30, v20, s[64:67], 0 offen
    s_mov_b32 s64, s6
    s_and_b32 s65, s7, 0xffff
    s_mov_b32 s66, 1280
    s_mov_b32 s67, 0x00020000
    buffer_load_ushort v31, v20, s[64:67], 0 offen
    s_mov_b32 s64, s10
    s_and_b32 s65, s11, 0xffff
    s_mov_b32 s66, 1280
    s_mov_b32 s67, 0x00020000
    buffer_load_ushort v32, v20, s[64:67], 0 offen
    s_waitcnt vmcnt(3)
    s_barrier
    s_add_u32 m0, s34, 49152
    s_lshl_b32 s32, s98, 7
    buffer_load_dwordx4 v4, s[12:15], s32 offen offset:0 lds
    buffer_load_dwordx4 v5, s[12:15], s32 offen offset:1024 lds
    buffer_load_dwordx4 v6, s[12:15], s32 offen offset:2048 lds
    buffer_load_dwordx4 v7, s[12:15], s32 offen offset:3072 lds
    s_add_u32 m0, s34, 53248
    s_nop 0
    buffer_load_dwordx4 v12, s[12:15], s32 offen offset:0 lds
    buffer_load_dwordx4 v13, s[12:15], s32 offen offset:1024 lds
    buffer_load_dwordx4 v14, s[12:15], s32 offen offset:2048 lds
    buffer_load_dwordx4 v15, s[12:15], s32 offen offset:3072 lds
    s_add_u32 m0, s35, 81920
    s_nop 0
    buffer_load_dwordx4 v16, s[16:19], s32 offen offset:0 lds
    buffer_load_dwordx4 v17, s[16:19], s32 offen offset:1024 lds
    buffer_load_dwordx4 v18, s[16:19], s32 offen offset:2048 lds
    buffer_load_dwordx4 v19, s[16:19], s32 offen offset:3072 lds
    s_add_u32 s98, s98, 1
    s_cmp_eq_u32 s98, 10
    s_cselect_b32 s98, 0, s98
    s_add_u32 m0, s34, 98304
    s_lshl_b32 s32, s98, 7
    buffer_load_dwordx4 v4, s[12:15], s32 offen offset:0 lds
    buffer_load_dwordx4 v5, s[12:15], s32 offen offset:1024 lds
    buffer_load_dwordx4 v6, s[12:15], s32 offen offset:2048 lds
    buffer_load_dwordx4 v7, s[12:15], s32 offen offset:3072 lds
    s_add_u32 m0, s34, 102400
    s_nop 0
    buffer_load_dwordx4 v12, s[12:15], s32 offen offset:0 lds
    buffer_load_dwordx4 v13, s[12:15], s32 offen offset:1024 lds
    buffer_load_dwordx4 v14, s[12:15], s32 offen offset:2048 lds
    buffer_load_dwordx4 v15, s[12:15], s32 offen offset:3072 lds
    s_add_u32 m0, s35, 131072
    s_nop 0
    buffer_load_dwordx4 v16, s[16:19], s32 offen offset:0 lds
    buffer_load_dwordx4 v17, s[16:19], s32 offen offset:1024 lds
    buffer_load_dwordx4 v18, s[16:19], s32 offen offset:2048 lds
    buffer_load_dwordx4 v19, s[16:19], s32 offen offset:3072 lds
    s_add_u32 s98, s98, 1
    s_cmp_eq_u32 s98, 10
    s_cselect_b32 s98, 0, s98
    s_waitcnt vmcnt(12)
    s_barrier
    s_barrier
    s_add_u32 m0, s34, 0
    s_lshl_b32 s32, s98, 7
    buffer_load_dwordx4 v4, s[12:15], s32 offen offset:0 lds
    buffer_load_dwordx4 v5, s[12:15], s32 offen offset:1024 lds
    buffer_load_dwordx4 v6, s[12:15], s32 offen offset:2048 lds
    buffer_load_dwordx4 v7, s[12:15], s32 offen offset:3072 lds
    s_add_u32 m0, s34, 4096
    s_nop 0
    buffer_load_dwordx4 v12, s[12:15], s32 offen offset:0 lds
    buffer_load_dwordx4 v13, s[12:15], s32 offen offset:1024 lds
    buffer_load_dwordx4 v14, s[12:15], s32 offen offset:2048 lds
    buffer_load_dwordx4 v15, s[12:15], s32 offen offset:3072 lds
    s_add_u32 m0, s35, 32768
    s_nop 0
    buffer_load_dwordx4 v16, s[16:19], s32 offen offset:0 lds
    buffer_load_dwordx4 v17, s[16:19], s32 offen offset:1024 lds
    buffer_load_dwordx4 v18, s[16:19], s32 offen offset:2048 lds
    buffer_load_dwordx4 v19, s[16:19], s32 offen offset:3072 lds
    s_add_u32 s98, s98, 1
    s_cmp_eq_u32 s98, 10
    s_cselect_b32 s98, 0, s98
    s_waitcnt vmcnt(12)
    s_barrier
    s_barrier
    s_add_u32 m0, s34, 49152
    s_lshl_b32 s32, s98, 7
    buffer_load_dwordx4 v4, s[12:15], s32 offen offset:0 lds
    buffer_load_dwordx4 v5, s[12:15], s32 offen offset:1024 lds
    buffer_load_dwordx4 v6, s[12:15], s32 offen offset:2048 lds
    buffer_load_dwordx4 v7, s[12:15], s32 offen offset:3072 lds
    s_add_u32 m0, s34, 53248
    s_nop 0
    buffer_load_dwordx4 v12, s[12:15], s32 offen offset:0 lds
    buffer_load_dwordx4 v13, s[12:15], s32 offen offset:1024 lds
    buffer_load_dwordx4 v14, s[12:15], s32 offen offset:2048 lds
    buffer_load_dwordx4 v15, s[12:15], s32 offen offset:3072 lds
    s_add_u32 m0, s35, 81920
    s_nop 0
    buffer_load_dwordx4 v16, s[16:19], s32 offen offset:0 lds
    buffer_load_dwordx4 v17, s[16:19], s32 offen offset:1024 lds
    buffer_load_dwordx4 v18, s[16:19], s32 offen offset:2048 lds
    buffer_load_dwordx4 v19, s[16:19], s32 offen offset:3072 lds
    s_add_u32 s98, s98, 1
    s_cmp_eq_u32 s98, 10
    s_cselect_b32 s98, 0, s98
    s_waitcnt vmcnt(12)
    s_barrier
    s_barrier
    s_add_u32 m0, s34, 98304
    s_lshl_b32 s32, s98, 7
    buffer_load_dwordx4 v4, s[12:15], s32 offen offset:0 lds
    buffer_load_dwordx4 v5, s[12:15], s32 offen offset:1024 lds
    buffer_load_dwordx4 v6, s[12:15], s32 offen offset:2048 lds
    buffer_load_dwordx4 v7, s[12:15], s32 offen offset:3072 lds
    s_add_u32 m0, s34, 102400
    s_nop 0
    buffer_load_dwordx4 v12, s[12:15], s32 offen offset:0 lds
    buffer_load_dwordx4 v13, s[12:15], s32 offen offset:1024 lds
    buffer_load_dwordx4 v14, s[12:15], s32 offen offset:2048 lds
    buffer_load_dwordx4 v15, s[12:15], s32 offen offset:3072 lds
    s_add_u32 m0, s35, 131072
    s_nop 0
    buffer_load_dwordx4 v16, s[16:19], s32 offen offset:0 lds
    buffer_load_dwordx4 v17, s[16:19], s32 offen offset:1024 lds
    buffer_load_dwordx4 v18, s[16:19], s32 offen offset:2048 lds
    buffer_load_dwordx4 v19, s[16:19], s32 offen offset:3072 lds
    s_add_u32 s98, s98, 1
    s_cmp_eq_u32 s98, 10
    s_cselect_b32 s98, 0, s98
    s_waitcnt vmcnt(12)
    s_barrier
    s_barrier
    s_add_u32 m0, s34, 0
    s_lshl_b32 s32, s98, 7
    buffer_load_dwordx4 v4, s[12:15], s32 offen offset:0 lds
    buffer_load_dwordx4 v5, s[12:15], s32 offen offset:1024 lds
    buffer_load_dwordx4 v6, s[12:15], s32 offen offset:2048 lds
    buffer_load_dwordx4 v7, s[12:15], s32 offen offset:3072 lds
    s_add_u32 m0, s34, 4096
    s_nop 0
    buffer_load_dwordx4 v12, s[12:15], s32 offen offset:0 lds
    buffer_load_dwordx4 v13, s[12:15], s32 offen offset:1024 lds
    buffer_load_dwordx4 v14, s[12:15], s32 offen offset:2048 lds
    buffer_load_dwordx4 v15, s[12:15], s32 offen offset:3072 lds
    s_add_u32 m0, s35, 32768
    s_nop 0
    buffer_load_dwordx4 v16, s[16:19], s32 offen offset:0 lds
    buffer_load_dwordx4 v17, s[16:19], s32 offen offset:1024 lds
    buffer_load_dwordx4 v18, s[16:19], s32 offen offset:2048 lds
    buffer_load_dwordx4 v19, s[16:19], s32 offen offset:3072 lds
    s_add_u32 s98, s98, 1
    s_cmp_eq_u32 s98, 10
    s_cselect_b32 s98, 0, s98
    s_cmp_lg_u32 s29, 4
    s_cbranch_scc1 L_w4_1
    buffer_load_dword v25, off, s[48:51], 0 sc1
    v_lshlrev_b32 v30, 16, v30
    v_lshlrev_b32 v31, 16, v31
    v_lshlrev_b32 v32, 16, v32
    v_mul_f32 v32, 1069066811, v32
    v_exp_f32 v32, v32
    s_nop 0
    v_cvt_pk_bf16_f32 v32, v32, v32
    v_lshlrev_b32 v32, 16, v32
    v_mul_f32 v36, v32, v30
    v_mul_f32 v37, v32, v31
    v_mul_f32 v36, 1069066811, v36
    v_mul_f32 v37, 1042479491, v37
    v_exp_f32 v36, v36
    v_fract_f32 v37, v37
    v_cos_f32 v38, v37
    v_sin_f32 v39, v37
    s_nop 0
    v_mul_f32 v34, v36, v38
    v_mul_f32 v35, v36, v39
    v_mul_f32 v36, v34, v34
    v_mul_f32 v37, v34, v35
    v_fma_f32 v36, -v35, v35, v36
    v_add_f32 v37, v37, v37
    v_mul_f32 v34, v36, v36
    v_mul_f32 v35, v36, v37
    v_fma_f32 v34, -v37, v37, v34
    v_add_f32 v35, v35, v35
    v_mul_f32 v36, v34, v34
    v_mul_f32 v37, v34, v35
    v_fma_f32 v36, -v35, v35, v36
    v_add_f32 v37, v37, v37
    v_mul_f32 v34, v36, v36
    v_mul_f32 v35, v36, v37
    v_fma_f32 v34, -v37, v37, v34
    v_add_f32 v35, v35, v35
    v_mul_f32 v128, v34, v34
    v_mul_f32 v129, v34, v35
    v_fma_f32 v128, -v35, v35, v128
    v_add_f32 v129, v129, v129
    v_mul_f32 v36, v128, v128
    v_mul_f32 v37, v128, v129
    v_fma_f32 v36, -v129, v129, v36
    v_add_f32 v37, v37, v37
    v_mul_f32 v34, v36, v36
    v_mul_f32 v35, v36, v37
    v_fma_f32 v34, -v37, v37, v34
    v_add_f32 v35, v35, v35
    v_mul_f32 v130, v34, v34
    v_mul_f32 v131, v34, v35
    v_fma_f32 v130, -v35, v35, v130
    v_add_f32 v131, v131, v131
L_w4_1:
    s_waitcnt vmcnt(12)
    s_barrier
    s_barrier
    s_add_u32 m0, s34, 49152
    s_lshl_b32 s32, s98, 7
    buffer_load_dwordx4 v4, s[12:15], s32 offen offset:0 lds
    buffer_load_dwordx4 v5, s[12:15], s32 offen offset:1024 lds
    buffer_load_dwordx4 v6, s[12:15], s32 offen offset:2048 lds
    buffer_load_dwordx4 v7, s[12:15], s32 offen offset:3072 lds
    s_add_u32 m0, s34, 53248
    s_nop 0
    buffer_load_dwordx4 v12, s[12:15], s32 offen offset:0 lds
    buffer_load_dwordx4 v13, s[12:15], s32 offen offset:1024 lds
    buffer_load_dwordx4 v14, s[12:15], s32 offen offset:2048 lds
    buffer_load_dwordx4 v15, s[12:15], s32 offen offset:3072 lds
    s_add_u32 m0, s35, 81920
    s_nop 0
    buffer_load_dwordx4 v16, s[16:19], s32 offen offset:0 lds
    buffer_load_dwordx4 v17, s[16:19], s32 offen offset:1024 lds
    buffer_load_dwordx4 v18, s[16:19], s32 offen offset:2048 lds
    buffer_load_dwordx4 v19, s[16:19], s32 offen offset:3072 lds
    s_add_u32 s98, s98, 1
    s_cmp_eq_u32 s98, 10
    s_cselect_b32 s98, 0, s98
    s_waitcnt vmcnt(12)
    s_barrier
    s_barrier
    s_add_u32 m0, s34, 98304
    s_lshl_b32 s32, s98, 7
    buffer_load_dwordx4 v4, s[12:15], s32 offen offset:0 lds
    buffer_load_dwordx4 v5, s[12:15], s32 offen offset:1024 lds
    buffer_load_dwordx4 v6, s[12:15], s32 offen offset:2048 lds
    buffer_load_dwordx4 v7, s[12:15], s32 offen offset:3072 lds
    s_add_u32 m0, s34, 102400
    s_nop 0
    buffer_load_dwordx4 v12, s[12:15], s32 offen offset:0 lds
    buffer_load_dwordx4 v13, s[12:15], s32 offen offset:1024 lds
    buffer_load_dwordx4 v14, s[12:15], s32 offen offset:2048 lds
    buffer_load_dwordx4 v15, s[12:15], s32 offen offset:3072 lds
    s_add_u32 m0, s35, 131072
    s_nop 0
    buffer_load_dwordx4 v16, s[16:19], s32 offen offset:0 lds
    buffer_load_dwordx4 v17, s[16:19], s32 offen offset:1024 lds
    buffer_load_dwordx4 v18, s[16:19], s32 offen offset:2048 lds
    buffer_load_dwordx4 v19, s[16:19], s32 offen offset:3072 lds
    s_add_u32 s98, s98, 1
    s_cmp_eq_u32 s98, 10
    s_cselect_b32 s98, 0, s98
    s_load_dwordx2 s[4:5], s[0:1], 88
    s_sub_u32 s30, s25, 20
    s_and_b32 s31, s30, 1
    s_lshl_b32 s21, s24, 1
    s_add_u32 s21, s21, s31
    s_lshr_b32 s22, s30, 1
    v_lshrrev_b32 v3, 4, v2
    v_and_b32 v8, 15, v2
    v_lshlrev_b32 v9, 2, v3
    v_xor_b32 v8, v8, v9
    s_mul_i32 s30, s38, 80
    v_add_u32 v3, s30, v3
    v_mul_u32_u24 v3, 1280, v3
    v_lshl_add_u32 v176, v8, 4, v3
    s_lshl_b32 s30, s22, 8
    v_add_u32 v176, s30, v176
    v_add_u32 v177, 4096, v176
    v_add_u32 v178, 8192, v176
    v_add_u32 v179, 12288, v176
    v_add_u32 v180, 20480, v176
    s_lshl_b32 s30, s21, 2
    s_add_u32 s30, s30, s38
    s_mul_i32 s30, s30, 1280
    s_mov_b32 s31, 326400
    v_add_u32 v3, 0, v2
    v_mul_u32_u24 v9, 820, v3
    v_lshrrev_b32 v9, 16, v9
    v_mul_lo_u32 v9, v9, s31
    v_lshl_add_u32 v9, v3, 4, v9
    v_add_u32 v181, s30, v9
    v_add_u32 v3, 64, v2
    v_mul_u32_u24 v9, 820, v3
    v_lshrrev_b32 v9, 16, v9
    v_mul_lo_u32 v9, v9, s31
    v_lshl_add_u32 v9, v3, 4, v9
    v_add_u32 v182, s30, v9
    v_subrev_u32 v182, 1024, v182
    v_add_u32 v3, 128, v2
    v_mul_u32_u24 v9, 820, v3
    v_lshrrev_b32 v9, 16, v9
    v_mul_lo_u32 v9, v9, s31
    v_lshl_add_u32 v9, v3, 4, v9
    v_add_u32 v183, s30, v9
    v_subrev_u32 v183, 2048, v183
    v_add_u32 v3, 192, v2
    v_mul_u32_u24 v9, 820, v3
    v_lshrrev_b32 v9, 16, v9
    v_mul_lo_u32 v9, v9, s31
    v_lshl_add_u32 v9, v3, 4, v9
    v_add_u32 v184, s30, v9
    v_subrev_u32 v184, 3072, v184
    v_add_u32 v3, 256, v2
    v_mul_u32_u24 v9, 820, v3
    v_lshrrev_b32 v9, 16, v9
    v_mul_lo_u32 v9, v9, s31
    v_lshl_add_u32 v9, v3, 4, v9
    v_add_u32 v185, s30, v9
    s_mul_i32 s20, s38, 5120
    s_mul_i32 s23, s24, 8704
    s_add_u32 s23, s23, 217600
    s_waitcnt lgkmcnt(0)
    s_waitcnt vmcnt(12)
    s_barrier
    s_barrier
    s_add_u32 m0, s34, 0
    s_lshl_b32 s32, s98, 7
    buffer_load_dwordx4 v4, s[12:15], s32 offen offset:0 lds
    buffer_load_dwordx4 v5, s[12:15], s32 offen offset:1024 lds
    buffer_load_dwordx4 v6, s[12:15], s32 offen offset:2048 lds
    buffer_load_dwordx4 v7, s[12:15], s32 offen offset:3072 lds
    s_add_u32 m0, s34, 4096
    s_nop 0
    buffer_load_dwordx4 v12, s[12:15], s32 offen offset:0 lds
    buffer_load_dwordx4 v13, s[12:15], s32 offen offset:1024 lds
    buffer_load_dwordx4 v14, s[12:15], s32 offen offset:2048 lds
    buffer_load_dwordx4 v15, s[12:15], s32 offen offset:3072 lds
    s_add_u32 m0, s35, 32768
    s_nop 0
    buffer_load_dwordx4 v16, s[16:19], s32 offen offset:0 lds
    buffer_load_dwordx4 v17, s[16:19], s32 offen offset:1024 lds
    buffer_load_dwordx4 v18, s[16:19], s32 offen offset:2048 lds
    buffer_load_dwordx4 v19, s[16:19], s32 offen offset:3072 lds
    s_add_u32 s98, s98, 1
    s_cmp_eq_u32 s98, 10
    s_cselect_b32 s98, 0, s98
    s_mov_b32 s40, 0x000fffff
    s_mov_b32 s41, 0x000fffff
    v_bfe_u32 v8, v2, 4, 1
    v_mul_u32_u24 v8, 640, v8
    v_bfe_u32 v9, v2, 2, 2
    v_lshl_add_u32 v8, v9, 5, v8
    v_and_b32 v9, 1, v2
    v_lshl_add_u32 v8, v9, 4, v8
    v_bfe_u32 v9, v2, 1, 1
    v_lshl_add_u32 v8, v9, 3, v8
    v_add_u32 v121, 512, v8
    v_lshrrev_b32 v9, 5, v2
    v_mul_u32_u24 v10, 1280, v9
    v_add_u32 v105, v10, v121
    v_lshl_add_u32 v104, v9, 8, v8
    v_and_b32 v10, 31, v2
    v_lshlrev_b32 v11, 4, v9
    v_lshl_add_u32 v11, v10, 5, v11
    v_add_u32 v106, 10240, v11
    s_mul_i32 s30, s39, 81920
    s_lshl_b32 s31, s42, 3
    s_add_u32 s31, s31, s29
    s_mul_i32 s31, s31, 1280
    s_add_u32 s30, s30, s31
    v_lshlrev_b32 v11, 3, v9
    v_lshl_add_u32 v11, v10, 4, v11
    v_add_u32 v114, s30, v11
    v_lshlrev_b32 v11, 3, v10
    v_add_u32 v11, s30, v11
    v_mov_b32 v8, 0x7f000000
    v_cmp_gt_u32 vcc, 32, v2
    s_mul_i32 s30, s29, 1280
    s_add_u32 s30, s30, 147456
    v_cndmask_b32 v115, v8, v11, vcc
    v_add_u32 v120, s30, v104
    v_add_u32 v121, s30, v121
    s_mov_b32 s60, s8
    s_and_b32 s61, s9, 0xffff
    s_mov_b32 s62, 7864320
    s_mov_b32 s63, 0x00020000
    s_mul_i32 s73, s39, 81920
    s_cmp_lt_u32 s38, 2
    s_mov_b32 s30, 2621440
    s_cselect_b32 s30, s30, 5232640
    s_mul_i32 s74, s38, 5120
    s_add_u32 s75, s73, s30
    s_add_u32 s75, s75, s74
    v_lshlrev_b32 v107, 4, v2
    s_and_b32 s96, s42, 0
    s_mov_b32 s37, 48
    s_mul_i32 s30, s39, 20
    s_mul_i32 s31, s30, 2731
    s_add_u32 s33, s31, 51889
    s_lshr_b32 s31, s31, 19
    s_lshr_b32 s33, s33, 19
    s_sub_u32 s31, s33, s31
    s_lshl_b32 s31, s31, 4
    s_add_u32 s37, s37, s31
    s_add_u32 s30, s30, 640
    s_mul_i32 s31, s30, 2731
    s_add_u32 s33, s31, 51889
    s_lshr_b32 s31, s31, 19
    s_lshr_b32 s33, s33, 19
    s_sub_u32 s31, s33, s31
    s_lshl_b32 s31, s31, 4
    s_add_u32 s37, s37, s31
    s_add_u32 s30, s30, 640
    s_mul_i32 s31, s30, 2731
    s_add_u32 s33, s31, 51889
    s_lshr_b32 s31, s31, 19
    s_lshr_b32 s33, s33, 19
    s_sub_u32 s31, s33, s31
    s_lshl_b32 s31, s31, 4
    s_add_u32 s37, s37, s31
    s_mov_b32 s43, s37
    s_waitcnt vmcnt(12)
    s_barrier
    s_cmp_lg_u32 s29, 4
    s_cbranch_scc1 L_w4_2
    s_mov_b32 s72, 0
    v_readfirstlane_b32 s37, v25
    s_nop 3
    s_cmp_lg_u32 s37, 0
    s_cbranch_scc1 L_nonced_4
L_nonce_3:
    buffer_load_dword v25, off, s[48:51], 0 sc1
    s_waitcnt vmcnt(0)
    v_readfirstlane_b32 s37, v25
    s_add_u32 s72, s72, 1
    s_nop 2
    s_cmp_lg_u32 s37, 0
    s_cbranch_scc1 L_nonced_4
    s_sleep 1
    s_cmp_lt_u32 s72, 0x20000
    s_cbranch_scc1 L_nonce_3
L_nonced_4:
    s_mul_i32 s30, s39, 4352
    v_mov_b32 v23, 0
    s_mov_b64 exec, 1
    buffer_atomic_add v23, off, s[44:47], s30 sc0 sc1
    s_mov_b64 exec, -1
L_w4_2:
    s_waitcnt vmcnt(0)
    s_barrier
    s_cmp_lg_u32 s29, 4
    s_cbranch_scc1 L_w4_5
    s_mul_i32 s30, s39, 4352
    s_mov_b32 s72, 0
    s_branch L_chk_8
L_poll_6:
    v_mov_b32 v23, 0
    s_mov_b64 exec, 1
    buffer_atomic_add v23, off, s[44:47], s30 sc0 sc1
    s_mov_b64 exec, -1
    s_waitcnt vmcnt(0)
L_chk_8:
    v_readfirstlane_b32 s99, v23
    s_add_u32 s72, s72, 1
    s_nop 2
    s_cmp_eq_u32 s99, s43
    s_cbranch_scc1 L_polled_7
    s_sleep 1
    s_cmp_lt_u32 s72, 0x20000
    s_cbranch_scc1 L_poll_6
L_polled_7:
L_w4_5:
    s_barrier
    s_lshl_b32 s30, s42, 3
    s_lshl_b32 s31, s38, 1
    s_add_u32 s30, s30, s31
    s_mul_i32 s30, s30, 1280
    s_add_u32 s32, s73, s30
    s_mul_i32 s31, s38, 2560
    s_add_u32 m0, s31, 147456
    s_nop 0
    buffer_load_dwordx4 v107, s[60:63], s32 offen sc1 lds
    buffer_load_dwordx4 v107, s[60:63], s32 offen offset:1024 sc1 lds
    s_mov_b32 exec_hi, 0
    buffer_load_dwordx4 v107, s[60:63], s32 offen offset:2048 sc1 lds
    s_mov_b32 exec_hi, -1
    s_add_u32 s32, s96, 0
    s_and_b32 s32, s32, 7
    s_mul_i32 s32, s32, 10240
    s_add_u32 m0, s74, 0
    s_add_u32 s32, s32, s75
    buffer_load_dwordx4 v107, s[60:63], s32 offen offset:0 sc1 lds
    buffer_load_dwordx4 v107, s[60:63], s32 offen offset:1024 sc1 lds
    buffer_load_dwordx4 v107, s[60:63], s32 offen offset:2048 sc1 lds
    buffer_load_dwordx4 v107, s[60:63], s32 offen offset:3072 sc1 lds
    s_add_u32 m0, s74, 4096
    s_add_u32 s32, s32, 4096
    buffer_load_dwordx4 v107, s[60:63], s32 offen offset:0 sc1 lds
    v_and_b32 v116, 27, v2
    v_cmp_eq_u32 vcc, 24, v116
    v_mov_b32 v116, 0x3f803f80
    v_mov_b32 v40, 0
    v_mov_b32 v41, 0
    v_mov_b32 v42, 0
    v_mov_b32 v43, 0
    v_mov_b32 v44, 0
    v_mov_b32 v45, 0
    v_mov_b32 v46, 0
    v_mov_b32 v47, 0
    v_cndmask_b32 v92, 0, v116, vcc
    v_cndmask_b32 v93, 0, v116, vcc
    v_cndmask_b32 v94, 0, v116, vcc
    v_cndmask_b32 v95, 0, v116, vcc
    v_cndmask_b32 v108, 0, v116, vcc
    v_cndmask_b32 v109, 0, v116, vcc
    v_cndmask_b32 v110, 0, v116, vcc
    v_cndmask_b32 v111, 0, v116, vcc
    v_cndmask_b32 v96, 0, v116, vcc
    v_cndmask_b32 v97, 0, v116, vcc
    v_cndmask_b32 v98, 0, v116, vcc
    v_cndmask_b32 v99, 0, v116, vcc
    v_cndmask_b32 v12, 0, v116, vcc
    v_cndmask_b32 v13, 0, v116, vcc
    v_cndmask_b32 v14, 0, v116, vcc
    v_cndmask_b32 v15, 0, v116, vcc
    v_cndmask_b32 v100, 0, v116, vcc
    v_cndmask_b32 v101, 0, v116, vcc
    v_cndmask_b32 v102, 0, v116, vcc
    v_cndmask_b32 v103, 0, v116, vcc
    v_mov_b32 v48, 0
    v_mov_b32 v49, 0
    v_mov_b32 v50, 0
    v_mov_b32 v51, 0
    v_mov_b32 v52, 0
    v_mov_b32 v53, 0
    v_mov_b32 v54, 0
    v_mov_b32 v55, 0
    v_mov_b32 v56, 0
    v_mov_b32 v57, 0
    v_mov_b32 v58, 0
    v_mov_b32 v59, 0
    v_mov_b32 v60, 0
    v_mov_b32 v61, 0
    v_mov_b32 v62, 0
    v_mov_b32 v63, 0
    s_mov_b32 s43, 0
    s_mov_b32 s12, 10
    s_cmp_lt_u32 s29, 2
    s_cselect_b32 s13, 5, 1
    s_cmp_ge_u32 s29, 4
    s_cselect_b32 s13, 5, s13
    s_cselect_b32 s14, 0, 2
    s_cselect_b32 s15, 1, 0
    s_cmp_eq_u32 s36, 1
    s_cselect_b32 s14, s14, 0
    s_or_b32 s14, s14, s15
    s_cmp_eq_u32 s29, 4
    s_cselect_b32 s15, 4, 0
    s_or_b32 s14, s14, s15
    s_cmp_eq_u32 s36, 2
    s_cselect_b32 s15, 2, 0
    s_or_b32 s14, s14, s15
    s_cmp_ge_u32 s29, 4
    s_cselect_b32 s15, 8, 0
    s_cmp_eq_u32 s36, 0
    s_cselect_b32 s15, s15, 0
    s_or_b32 s14, s14, s15
    s_barrier
    s_cmp_lg_u32 s29, 4
    s_cbranch_scc1 L_w4_9
    v_lshlrev_b32 v3, 2, v2
    v_add_u32 v3, 143360, v3
    ds_read2st64_b32 v[132:133], v3 offset0:0 offset1:8
    ds_read2st64_b32 v[134:135], v3 offset0:1 offset1:9
    ds_read2st64_b32 v[136:137], v3 offset0:2 offset1:10
    ds_read2st64_b32 v[138:139], v3 offset0:3 offset1:11
    ds_read2st64_b32 v[140:141], v3 offset0:4 offset1:12
    ds_read2st64_b32 v[142:143], v3 offset0:5 offset1:13
    ds_read2st64_b32 v[144:145], v3 offset0:6 offset1:14
    ds_read2st64_b32 v[146:147], v3 offset0:7 offset1:15
    s_add_u32 s64, s8, 17891328
    s_addc_u32 s65, s9, 0
    s_and_b32 s65, s65, 0xffff
    s_mov_b32 s66, 81920
    s_mov_b32 s67, 0x00020000
    s_mul_i32 s30, s26, 10240
    s_lshl_b32 s31, s27, 10
    s_add_u32 s30, s30, s31
    v_lshl_add_u32 v7, v2, 4, s30
    v_mov_b32 v117, s37
    v_mov_b32 v119, s37
L_w4_9:
    s_waitcnt vmcnt(0)
    s_barrier
    s_cmp_lg_u32 s29, 4
    s_cbranch_scc1 L_w4_10
    s_waitcnt lgkmcnt(0)
    v_pk_fma_f32 v[36:37], v[128:129], v[132:133], v[134:135] op_sel:[0,0,0] op_sel_hi:[0,1,1]
    v_pk_fma_f32 v[36:37], v[128:129], v[132:133], v[36:37] op_sel:[1,1,0] op_sel_hi:[1,0,1] neg_lo:[1,0,0]
    v_pk_fma_f32 v[38:39], v[128:129], v[36:37], v[136:137] op_sel:[0,0,0] op_sel_hi:[0,1,1]
    v_pk_fma_f32 v[38:39], v[128:129], v[36:37], v[38:39] op_sel:[1,1,0] op_sel_hi:[1,0,1] neg_lo:[1,0,0]
    v_pk_fma_f32 v[36:37], v[128:129], v[38:39], v[138:139] op_sel:[0,0,0] op_sel_hi:[0,1,1]
    v_pk_fma_f32 v[36:37], v[128:129], v[38:39], v[36:37] op_sel:[1,1,0] op_sel_hi:[1,0,1] neg_lo:[1,0,0]
    v_pk_fma_f32 v[38:39], v[128:129], v[36:37], v[140:141] op_sel:[0,0,0] op_sel_hi:[0,1,1]
    v_pk_fma_f32 v[38:39], v[128:129], v[36:37], v[38:39] op_sel:[1,1,0] op_sel_hi:[1,0,1] neg_lo:[1,0,0]
    v_pk_fma_f32 v[36:37], v[128:129], v[38:39], v[142:143] op_sel:[0,0,0] op_sel_hi:[0,1,1]
    v_pk_fma_f32 v[36:37], v[128:129], v[38:39], v[36:37] op_sel:[1,1,0] op_sel_hi:[1,0,1] neg_lo:[1,0,0]
    v_pk_fma_f32 v[38:39], v[128:129], v[36:37], v[144:145] op_sel:[0,0,0] op_sel_hi:[0,1,1]
    v_pk_fma_f32 v[38:39], v[128:129], v[36:37], v[38:39] op_sel:[1,1,0] op_sel_hi:[1,0,1] neg_lo:[1,0,0]
    v_pk_fma_f32 v[36:37], v[128:129], v[38:39], v[146:147] op_sel:[0,0,0] op_sel_hi:[0,1,1]
    v_pk_fma_f32 v[36:37], v[128:129], v[38:39], v[36:37] op_sel:[1,1,0] op_sel_hi:[1,0,1] neg_lo:[1,0,0]
    v_mov_b32 v116, v36
    v_mov_b32 v118, v37
    buffer_store_dwordx4 v[116:119], v7, s[64:67], 0 offen sc0 sc1
L_w4_10:
    s_add_u32 s32, s96, 1
    s_and_b32 s32, s32, 7
    s_mul_i32 s32, s32, 10240
    s_add_u32 m0, s74, 20480
    s_add_u32 s32, s32, s75
    buffer_load_dwordx4 v107, s[60:63], s32 offen offset:0 sc1 lds
    buffer_load_dwordx4 v107, s[60:63], s32 offen offset:1024 sc1 lds
    buffer_load_dwordx4 v107, s[60:63], s32 offen offset:2048 sc1 lds
    buffer_load_dwordx4 v107, s[60:63], s32 offen offset:3072 sc1 lds
    s_add_u32 m0, s74, 24576
    s_add_u32 s32, s32, 4096
    buffer_load_dwordx4 v107, s[60:63], s32 offen offset:0 sc1 lds
    s_add_u32 s32, s96, 2
    s_and_b32 s32, s32, 7
    s_mul_i32 s32, s32, 10240
    s_add_u32 m0, s74, 40960
    s_add_u32 s32, s32, s75
    buffer_load_dwordx4 v107, s[60:63], s32 offen offset:0 sc1 lds
    buffer_load_dwordx4 v107, s[60:63], s32 offen offset:1024 sc1 lds
    buffer_load_dwordx4 v107, s[60:63], s32 offen offset:2048 sc1 lds
    buffer_load_dwordx4 v107, s[60:63], s32 offen offset:3072 sc1 lds
    s_add_u32 m0, s74, 45056
    s_add_u32 s32, s32, 4096
    buffer_load_dwordx4 v107, s[60:63], s32 offen offset:0 sc1 lds
    s_branch L_att
L_loadA:
    s_add_u32 s8, s50, 0
    s_addc_u32 s9, s51, 0
    s_and_b32 s49, s49, 0xffff
    s_mov_b32 s50, 256
    s_mov_b32 s51, 0x00020000
    s_add_u32 s44, s8, 18022400
    s_addc_u32 s45, s9, 0
    s_and_b32 s45, s45, 0xffff
    s_mov_b32 s46, 282884
    s_mov_b32 s47, 0x00020000
    v_mov_b32 v107, 0x7f000000
    v_mov_b32 v116, 0x7f000000
    v_mov_b32 v118, 0x7f000000
    v_mov_b32 v248, 0x7f000000
    v_mov_b32 v249, 0x7f000000
    v_mov_b32 v250, 0x7f000000
    v_mov_b32 v251, 0x7f000000
    s_lshl_b32 s39, s24, 2
    s_lshr_b32 s32, s25, 3
    s_add_u32 s39, s39, s32
    s_and_b32 s42, s25, 7
    s_mov_b32 s37, 0
    s_waitcnt vmcnt(10)
    s_barrier
    s_add_u32 m0, s34, 81920
    s_lshl_b32 s32, s98, 7
    buffer_load_dwordx4 v4, s[12:15], s32 offen offset:0 lds
    buffer_load_dwordx4 v5, s[12:15], s32 offen offset:1024 lds
    buffer_load_dwordx4 v6, s[12:15], s32 offen offset:2048 lds
    buffer_load_dwordx4 v7, s[12:15], s32 offen offset:3072 lds
    s_add_u32 m0, s35, 98304
    s_mul_i32 s33, s98, 245760
    buffer_load_dwordx4 v12, s[16:19], s33 offen offset:0 lds
    buffer_load_dwordx4 v13, s[16:19], s33 offen offset:1024 lds
    buffer_load_dwordx4 v14, s[16:19], s33 offen offset:2048 lds
    buffer_load_dwordx4 v15, s[16:19], s33 offen offset:3072 lds
    s_add_u32 m0, s35, 102400
    s_nop 0
    buffer_load_dwordx4 v16, s[16:19], s33 offen offset:0 lds
    buffer_load_dwordx4 v17, s[16:19], s33 offen offset:1024 lds
    s_add_u32 s98, s98, 1
    s_cmp_eq_u32 s98, 10
    s_cselect_b32 s98, 0, s98
    s_waitcnt vmcnt(10)
    s_barrier
    s_add_u32 m0, s34, 122880
    s_lshl_b32 s32, s98, 7
    buffer_load_dwordx4 v4, s[12:15], s32 offen offset:0 lds
    buffer_load_dwordx4 v5, s[12:15], s32 offen offset:1024 lds
    buffer_load_dwordx4 v6, s[12:15], s32 offen offset:2048 lds
    buffer_load_dwordx4 v7, s[12:15], s32 offen offset:3072 lds
    s_add_u32 m0, s35, 139264
    s_mul_i32 s33, s98, 245760
    buffer_load_dwordx4 v12, s[16:19], s33 offen offset:0 lds
    buffer_load_dwordx4 v13, s[16:19], s33 offen offset:1024 lds
    buffer_load_dwordx4 v14, s[16:19], s33 offen offset:2048 lds
    buffer_load_dwordx4 v15, s[16:19], s33 offen offset:3072 lds
    s_add_u32 m0, s35, 143360
    s_nop 0
    buffer_load_dwordx4 v16, s[16:19], s33 offen offset:0 lds
    buffer_load_dwordx4 v17, s[16:19], s33 offen offset:1024 lds
    s_add_u32 s98, s98, 1
    s_cmp_eq_u32 s98, 10
    s_cselect_b32 s98, 0, s98
    s_waitcnt vmcnt(10)
    s_barrier
    s_add_u32 m0, s34, 0
    s_lshl_b32 s32, s98, 7
    buffer_load_dwordx4 v4, s[12:15], s32 offen offset:0 lds
    buffer_load_dwordx4 v5, s[12:15], s32 offen offset:1024 lds
    buffer_load_dwordx4 v6, s[12:15], s32 offen offset:2048 lds
    buffer_load_dwordx4 v7, s[12:15], s32 offen offset:3072 lds
    s_add_u32 m0, s35, 16384
    s_mul_i32 s33, s98, 245760
    buffer_load_dwordx4 v12, s[16:19], s33 offen offset:0 lds
    buffer_load_dwordx4 v13, s[16:19], s33 offen offset:1024 lds
    buffer_load_dwordx4 v14, s[16:19], s33 offen offset:2048 lds
    buffer_load_dwordx4 v15, s[16:19], s33 offen offset:3072 lds
    s_add_u32 m0, s35, 20480
    s_nop 0
    buffer_load_dwordx4 v16, s[16:19], s33 offen offset:0 lds
    buffer_load_dwordx4 v17, s[16:19], s33 offen offset:1024 lds
    s_add_u32 s98, s98, 1
    s_cmp_eq_u32 s98, 10
    s_cselect_b32 s98, 0, s98
    s_waitcnt vmcnt(10)
    s_barrier
    s_add_u32 m0, s34, 40960
    s_lshl_b32 s32, s98, 7
    buffer_load_dwordx4 v4, s[12:15], s32 offen offset:0 lds
    buffer_load_dwordx4 v5, s[12:15], s32 offen offset:1024 lds
    buffer_load_dwordx4 v6, s[12:15], s32 offen offset:2048 lds
    buffer_load_dwordx4 v7, s[12:15], s32 offen offset:3072 lds
    s_add_u32 m0, s35, 57344
    s_mul_i32 s33, s98, 245760
    buffer_load_dwordx4 v12, s[16:19], s33 offen offset:0 lds
    buffer_load_dwordx4 v13, s[16:19], s33 offen offset:1024 lds
    buffer_load_dwordx4 v14, s[16:19], s33 offen offset:2048 lds
    buffer_load_dwordx4 v15, s[16:19], s33 offen offset:3072 lds
    s_add_u32 m0, s35, 61440
    s_nop 0
    buffer_load_dwordx4 v16, s[16:19], s33 offen offset:0 lds
    buffer_load_dwordx4 v17, s[16:19], s33 offen offset:1024 lds
    s_add_u32 s98, s98, 1
    s_cmp_eq_u32 s98, 10
    s_cselect_b32 s98, 0, s98
    s_waitcnt vmcnt(10)
    s_barrier
    s_cmp_lg_u32 s29, 4
    s_cbranch_scc1 L_w4_11
    buffer_load_dword v25, off, s[48:51], 0 sc1
L_w4_11:
    s_add_u32 m0, s34, 81920
    s_lshl_b32 s32, s98, 7
    buffer_load_dwordx4 v4, s[12:15], s32 offen offset:0 lds
    buffer_load_dwordx4 v5, s[12:15], s32 offen offset:1024 lds
    buffer_load_dwordx4 v6, s[12:15], s32 offen offset:2048 lds
    buffer_load_dwordx4 v7, s[12:15], s32 offen offset:3072 lds
    s_add_u32 m0, s35, 98304
    s_mul_i32 s33, s98, 245760
    buffer_load_dwordx4 v12, s[16:19], s33 offen offset:0 lds
    buffer_load_dwordx4 v13, s[16:19], s33 offen offset:1024 lds
    buffer_load_dwordx4 v14, s[16:19], s33 offen offset:2048 lds
    buffer_load_dwordx4 v15, s[16:19], s33 offen offset:3072 lds
    s_add_u32 m0, s35, 102400
    s_nop 0
    buffer_load_dwordx4 v16, s[16:19], s33 offen offset:0 lds
    buffer_load_dwordx4 v17, s[16:19], s33 offen offset:1024 lds
    s_add_u32 s98, s98, 1
    s_cmp_eq_u32 s98, 10
    s_cselect_b32 s98, 0, s98
    s_waitcnt vmcnt(10)
    s_barrier
    s_add_u32 m0, s34, 122880
    s_lshl_b32 s32, s98, 7
    buffer_load_dwordx4 v4, s[12:15], s32 offen offset:0 lds
    buffer_load_dwordx4 v5, s[12:15], s32 offen offset:1024 lds
    buffer_load_dwordx4 v6, s[12:15], s32 offen offset:2048 lds
    buffer_load_dwordx4 v7, s[12:15], s32 offen offset:3072 lds
    s_add_u32 m0, s35, 139264
    s_mul_i32 s33, s98, 245760
    buffer_load_dwordx4 v12, s[16:19], s33 offen offset:0 lds
    buffer_load_dwordx4 v13, s[16:19], s33 offen offset:1024 lds
    buffer_load_dwordx4 v14, s[16:19], s33 offen offset:2048 lds
    buffer_load_dwordx4 v15, s[16:19], s33 offen offset:3072 lds
    s_add_u32 m0, s35, 143360
    s_nop 0
    buffer_load_dwordx4 v16, s[16:19], s33 offen offset:0 lds
    buffer_load_dwordx4 v17, s[16:19], s33 offen offset:1024 lds
    s_add_u32 s98, s98, 1
    s_cmp_eq_u32 s98, 10
    s_cselect_b32 s98, 0, s98
    s_waitcnt vmcnt(10)
    s_barrier
    s_add_u32 m0, s34, 0
    s_lshl_b32 s32, s98, 7
    buffer_load_dwordx4 v4, s[12:15], s32 offen offset:0 lds
    buffer_load_dwordx4 v5, s[12:15], s32 offen offset:1024 lds
    buffer_load_dwordx4 v6, s[12:15], s32 offen offset:2048 lds
    buffer_load_dwordx4 v7, s[12:15], s32 offen offset:3072 lds
    s_add_u32 m0, s35, 16384
    s_mul_i32 s33, s98, 245760
    buffer_load_dwordx4 v12, s[16:19], s33 offen offset:0 lds
    buffer_load_dwordx4 v13, s[16:19], s33 offen offset:1024 lds
    buffer_load_dwordx4 v14, s[16:19], s33 offen offset:2048 lds
    buffer_load_dwordx4 v15, s[16:19], s33 offen offset:3072 lds
    s_add_u32 m0, s35, 20480
    s_nop 0
    buffer_load_dwordx4 v16, s[16:19], s33 offen offset:0 lds
    buffer_load_dwordx4 v17, s[16:19], s33 offen offset:1024 lds
    s_add_u32 s98, s98, 1
    s_cmp_eq_u32 s98, 10
    s_cselect_b32 s98, 0, s98
    s_waitcnt vmcnt(10)
    s_barrier
    s_add_u32 m0, s34, 40960
    s_lshl_b32 s32, s98, 7
    buffer_load_dwordx4 v4, s[12:15], s32 offen offset:0 lds
    buffer_load_dwordx4 v5, s[12:15], s32 offen offset:1024 lds
    buffer_load_dwordx4 v6, s[12:15], s32 offen offset:2048 lds
    buffer_load_dwordx4 v7, s[12:15], s32 offen offset:3072 lds
    s_add_u32 m0, s35, 57344
    s_mul_i32 s33, s98, 245760
    buffer_load_dwordx4 v12, s[16:19], s33 offen offset:0 lds
    buffer_load_dwordx4 v13, s[16:19], s33 offen offset:1024 lds
    buffer_load_dwordx4 v14, s[16:19], s33 offen offset:2048 lds
    buffer_load_dwordx4 v15, s[16:19], s33 offen offset:3072 lds
    s_add_u32 m0, s35, 61440
    s_nop 0
    buffer_load_dwordx4 v16, s[16:19], s33 offen offset:0 lds
    buffer_load_dwordx4 v17, s[16:19], s33 offen offset:1024 lds
    s_add_u32 s98, s98, 1
    s_cmp_eq_u32 s98, 10
    s_cselect_b32 s98, 0, s98
    s_waitcnt vmcnt(10)
    s_barrier
    s_waitcnt vmcnt(0)
    s_barrier
    s_barrier
    s_mov_b32 s40, 0x000fffff
    s_mov_b32 s41, 0x000fffff
    v_bfe_u32 v8, v2, 4, 1
    v_mul_u32_u24 v8, 640, v8
    v_bfe_u32 v9, v2, 2, 2
    v_lshl_add_u32 v8, v9, 5, v8
    v_and_b32 v9, 1, v2
    v_lshl_add_u32 v8, v9, 4, v8
    v_bfe_u32 v9, v2, 1, 1
    v_lshl_add_u32 v8, v9, 3, v8
    v_add_u32 v121, 512, v8
    v_lshrrev_b32 v9, 5, v2
    v_mul_u32_u24 v10, 1280, v9
    v_add_u32 v105, v10, v121
    v_lshl_add_u32 v104, v9, 8, v8
    v_and_b32 v10, 31, v2
    v_lshlrev_b32 v11, 4, v9
    v_lshl_add_u32 v11, v10, 5, v11
    v_add_u32 v106, 10240, v11
    s_mul_i32 s30, s39, 81920
    s_lshl_b32 s31, s42, 3
    s_add_u32 s31, s31, s29
    s_mul_i32 s31, s31, 1280
    s_add_u32 s30, s30, s31
    v_lshlrev_b32 v11, 3, v9
    v_lshl_add_u32 v11, v10, 4, v11
    v_add_u32 v114, s30, v11
    v_lshlrev_b32 v11, 3, v10
    v_add_u32 v11, s30, v11
    v_mov_b32 v8, 0x7f000000
    v_cmp_gt_u32 vcc, 32, v2
    s_mul_i32 s30, s29, 1280
    s_add_u32 s30, s30, 147456
    v_cndmask_b32 v115, v8, v11, vcc
    v_add_u32 v120, s30, v104
    v_add_u32 v121, s30, v121
    s_load_dwordx2 s[4:5], s[0:1], 0
    v_lshrrev_b32 v3, 3, v2
    v_and_b32 v8, 7, v2
    v_lshrrev_b32 v9, 1, v3
    v_xor_b32 v10, v8, v9
    v_xor_b32 v11, 4, v10
    s_lshl_b32 s30, s26, 7
    s_lshl_b32 s31, s38, 5
    s_add_u32 s35, s30, s31
    v_add_u32 v9, s35, v3
    v_mul_u32_u24 v9, 1280, v9
    v_lshl_add_u32 v182, v10, 4, v9
    v_lshl_add_u32 v183, v11, 4, v9
    v_add_u32 v183, 9216, v183
    v_lshl_add_u32 v184, v10, 4, v9
    v_add_u32 v184, 18432, v184
    v_lshl_add_u32 v185, v11, 4, v9
    v_add_u32 v185, 27648, v185
    s_lshl_b32 s30, s27, 6
    s_lshl_b32 s31, s38, 4
    s_add_u32 s35, s30, s31
    v_add_u32 v9, s35, v3
    v_mul_u32_u24 v9, 2816, v9
    v_lshl_add_u32 v180, v10, 4, v9
    v_lshl_add_u32 v181, v11, 4, v9
    v_add_u32 v181, 21504, v181
    s_lshl_b32 s30, s26, 14
    s_lshl_b32 s34, s38, 12
    s_add_u32 s30, s30, s34
    v_xor_b32 v8, 0, v2
    v_lshl_add_u32 v176, v8, 4, s30
    v_xor_b32 v8, 4, v2
    v_lshl_add_u32 v177, v8, 4, s30
    v_xor_b32 v8, 8, v2
    v_lshl_add_u32 v178, v8, 4, s30
    v_xor_b32 v8, 12, v2
    v_lshl_add_u32 v179, v8, 4, s30
    s_lshl_b32 s35, s38, 11
    s_mov_b32 s98, 0
    s_bfe_u32 s30, s25, 0x30002
    s_mul_i32 s30, s30, 4
    s_add_u32 s98, s98, s30
    s_bfe_u32 s30, s25, 0x20000
    s_mul_i32 s30, s30, 5
    s_add_u32 s98, s98, s30
    s_mul_i32 s30, s98, 3277
    s_lshr_b32 s30, s30, 16
    s_mul_i32 s30, s30, 20
    s_sub_u32 s98, s98, s30
    s_and_b32 s28, s27, 1
    s_lshl_b32 s28, s28, 7
    s_add_u32 s28, s28, 2560
    s_waitcnt lgkmcnt(0)
L_load_tail:
    s_mov_b32 s60, s8
    s_and_b32 s61, s9, 0xffff
    s_mov_b32 s62, 7864320
    s_mov_b32 s63, 0x00020000
    s_mul_i32 s73, s39, 81920
    s_cmp_lt_u32 s38, 2
    s_mov_b32 s30, 2621440
    s_cselect_b32 s30, s30, 5232640
    s_mul_i32 s74, s38, 5120
    s_add_u32 s75, s73, s30
    s_add_u32 s75, s75, s74
    v_lshlrev_b32 v107, 4, v2
    s_and_b32 s96, s42, 0
    s_mov_b32 s37, 48
    s_mul_i32 s30, s39, 20
    s_mul_i32 s31, s30, 2731
    s_add_u32 s33, s31, 51889
    s_lshr_b32 s31, s31, 19
    s_lshr_b32 s33, s33, 19
    s_sub_u32 s31, s33, s31
    s_lshl_b32 s31, s31, 4
    s_add_u32 s37, s37, s31
    s_add_u32 s30, s30, 640
    s_mul_i32 s31, s30, 2731
    s_add_u32 s33, s31, 51889
    s_lshr_b32 s31, s31, 19
    s_lshr_b32 s33, s33, 19
    s_sub_u32 s31, s33, s31
    s_lshl_b32 s31, s31, 4
    s_add_u32 s37, s37, s31
    s_add_u32 s30, s30, 640
    s_mul_i32 s31, s30, 2731
    s_add_u32 s33, s31, 51889
    s_lshr_b32 s31, s31, 19
    s_lshr_b32 s33, s33, 19
    s_sub_u32 s31, s33, s31
    s_lshl_b32 s31, s31, 4
    s_add_u32 s37, s37, s31
    s_mov_b32 s43, s37
    s_cmp_lg_u32 s29, 4
    s_cbranch_scc1 L_w4_12
L_w4_12:
    s_cmp_lg_u32 s29, 4
    s_cbranch_scc1 L_w4_13
    s_mov_b32 s72, 0
    v_readfirstlane_b32 s37, v25
    s_nop 3
    s_cmp_lg_u32 s37, 0
    s_cbranch_scc1 L_nonced_15
L_nonce_14:
    buffer_load_dword v25, off, s[48:51], 0 sc1
    s_waitcnt vmcnt(0)
    v_readfirstlane_b32 s37, v25
    s_add_u32 s72, s72, 1
    s_nop 2
    s_cmp_lg_u32 s37, 0
    s_cbranch_scc1 L_nonced_15
    s_sleep 1
    s_cmp_lt_u32 s72, 0x20000
    s_cbranch_scc1 L_nonce_14
L_nonced_15:
    s_mul_i32 s30, s39, 4352
    v_mov_b32 v23, 0
    s_mov_b64 exec, 1
    buffer_atomic_add v23, off, s[44:47], s30 sc0 sc1
    s_mov_b64 exec, -1
L_w4_13:
    s_waitcnt vmcnt(0)
    s_cmp_lg_u32 s29, 4
    s_cbranch_scc1 L_w4_16
    s_mul_i32 s30, s39, 4352
    s_mov_b32 s72, 0
    s_branch L_chk_19
L_poll_17:
    v_mov_b32 v23, 0
    s_mov_b64 exec, 1
    buffer_atomic_add v23, off, s[44:47], s30 sc0 sc1
    s_mov_b64 exec, -1
    s_waitcnt vmcnt(0)
L_chk_19:
    v_readfirstlane_b32 s99, v23
    s_add_u32 s72, s72, 1
    s_nop 2
    s_cmp_eq_u32 s99, s43
    s_cbranch_scc1 L_polled_18
    s_sleep 1
    s_cmp_lt_u32 s72, 0x20000
    s_cbranch_scc1 L_poll_17
L_polled_18:
L_w4_16:
    s_barrier
    s_lshl_b32 s30, s42, 3
    s_lshl_b32 s31, s38, 1
    s_add_u32 s30, s30, s31
    s_mul_i32 s30, s30, 1280
    s_add_u32 s32, s73, s30
    s_mul_i32 s31, s38, 2560
    s_add_u32 m0, s31, 147456
    s_nop 0
    buffer_load_dwordx4 v107, s[60:63], s32 offen sc1 lds
    buffer_load_dwordx4 v107, s[60:63], s32 offen offset:1024 sc1 lds
    s_mov_b32 exec_hi, 0
    buffer_load_dwordx4 v107, s[60:63], s32 offen offset:2048 sc1 lds
    s_mov_b32 exec_hi, -1
    s_add_u32 s32, s96, 0
    s_and_b32 s32, s32, 7
    s_mul_i32 s32, s32, 10240
    s_add_u32 m0, s74, 0
    s_add_u32 s32, s32, s75
    buffer_load_dwordx4 v107, s[60:63], s32 offen offset:0 sc1 lds
    buffer_load_dwordx4 v107, s[60:63], s32 offen offset:1024 sc1 lds
    buffer_load_dwordx4 v107, s[60:63], s32 offen offset:2048 sc1 lds
    buffer_load_dwordx4 v107, s[60:63], s32 offen offset:3072 sc1 lds
    s_add_u32 m0, s74, 4096
    s_add_u32 s32, s32, 4096
    buffer_load_dwordx4 v107, s[60:63], s32 offen offset:0 sc1 lds
    v_and_b32 v116, 27, v2
    v_cmp_eq_u32 vcc, 24, v116
    v_mov_b32 v116, 0x3f803f80
    v_mov_b32 v40, 0
    v_mov_b32 v41, 0
    v_mov_b32 v42, 0
    v_mov_b32 v43, 0
    v_mov_b32 v44, 0
    v_mov_b32 v45, 0
    v_mov_b32 v46, 0
    v_mov_b32 v47, 0
    v_cndmask_b32 v92, 0, v116, vcc
    v_cndmask_b32 v93, 0, v116, vcc
    v_cndmask_b32 v94, 0, v116, vcc
    v_cndmask_b32 v95, 0, v116, vcc
    v_cndmask_b32 v108, 0, v116, vcc
    v_cndmask_b32 v109, 0, v116, vcc
    v_cndmask_b32 v110, 0, v116, vcc
    v_cndmask_b32 v111, 0, v116, vcc
    v_cndmask_b32 v96, 0, v116, vcc
    v_cndmask_b32 v97, 0, v116, vcc
    v_cndmask_b32 v98, 0, v116, vcc
    v_cndmask_b32 v99, 0, v116, vcc
    v_cndmask_b32 v12, 0, v116, vcc
    v_cndmask_b32 v13, 0, v116, vcc
    v_cndmask_b32 v14, 0, v116, vcc
    v_cndmask_b32 v15, 0, v116, vcc
    v_cndmask_b32 v100, 0, v116, vcc
    v_cndmask_b32 v101, 0, v116, vcc
    v_cndmask_b32 v102, 0, v116, vcc
    v_cndmask_b32 v103, 0, v116, vcc
    v_mov_b32 v48, 0
    v_mov_b32 v49, 0
    v_mov_b32 v50, 0
    v_mov_b32 v51, 0
    v_mov_b32 v52, 0
    v_mov_b32 v53, 0
    v_mov_b32 v54, 0
    v_mov_b32 v55, 0
    v_mov_b32 v56, 0
    v_mov_b32 v57, 0
    v_mov_b32 v58, 0
    v_mov_b32 v59, 0
    v_mov_b32 v60, 0
    v_mov_b32 v61, 0
    v_mov_b32 v62, 0
    v_mov_b32 v63, 0
    s_mov_b32 s43, 0
    s_mov_b32 s12, 10
    s_cmp_lt_u32 s29, 2
    s_cselect_b32 s13, 5, 1
    s_cmp_ge_u32 s29, 4
    s_cselect_b32 s13, 5, s13
    s_cselect_b32 s14, 0, 2
    s_cselect_b32 s15, 1, 0
    s_cmp_eq_u32 s36, 1
    s_cselect_b32 s14, s14, 0
    s_or_b32 s14, s14, s15
    s_cmp_eq_u32 s29, 4
    s_cselect_b32 s15, 4, 0
    s_or_b32 s14, s14, s15
    s_cmp_eq_u32 s36, 2
    s_cselect_b32 s15, 2, 0
    s_or_b32 s14, s14, s15
    s_cmp_ge_u32 s29, 4
    s_cselect_b32 s15, 8, 0
    s_cmp_eq_u32 s36, 0
    s_cselect_b32 s15, s15, 0
    s_or_b32 s14, s14, s15
    s_waitcnt vmcnt(0)
    s_barrier
    s_add_u32 s32, s96, 1
    s_and_b32 s32, s32, 7
    s_mul_i32 s32, s32, 10240
    s_add_u32 m0, s74, 20480
    s_add_u32 s32, s32, s75
    buffer_load_dwordx4 v107, s[60:63], s32 offen offset:0 sc1 lds
    buffer_load_dwordx4 v107, s[60:63], s32 offen offset:1024 sc1 lds
    buffer_load_dwordx4 v107, s[60:63], s32 offen offset:2048 sc1 lds
    buffer_load_dwordx4 v107, s[60:63], s32 offen offset:3072 sc1 lds
    s_add_u32 m0, s74, 24576
    s_add_u32 s32, s32, 4096
    buffer_load_dwordx4 v107, s[60:63], s32 offen offset:0 sc1 lds
    s_add_u32 s32, s96, 2
    s_and_b32 s32, s32, 7
    s_mul_i32 s32, s32, 10240
    s_add_u32 m0, s74, 40960
    s_add_u32 s32, s32, s75
    buffer_load_dwordx4 v107, s[60:63], s32 offen offset:0 sc1 lds
    buffer_load_dwordx4 v107, s[60:63], s32 offen offset:1024 sc1 lds
    buffer_load_dwordx4 v107, s[60:63], s32 offen offset:2048 sc1 lds
    buffer_load_dwordx4 v107, s[60:63], s32 offen offset:3072 sc1 lds
    s_add_u32 m0, s74, 45056
    s_add_u32 s32, s32, 4096
    buffer_load_dwordx4 v107, s[60:63], s32 offen offset:0 sc1 lds
    s_branch L_att
L_P:
    s_mov_b32 s36, 2
    v_mov_b32 v6, 0x7f000000
    v_mov_b32 v7, 0x7f000000
    s_waitcnt lgkmcnt(0)
    s_add_u32 s8, s50, 0
    s_addc_u32 s9, s51, 0
    s_and_b32 s49, s49, 0xffff
    s_mov_b32 s50, 256
    s_mov_b32 s51, 0x00020000
    s_add_u32 s44, s8, 18022400
    s_addc_u32 s45, s9, 0
    s_and_b32 s45, s45, 0xffff
    s_mov_b32 s46, 282884
    s_mov_b32 s47, 0x00020000
    v_mov_b32 v107, 0x7f000000
    v_mov_b32 v116, 0x7f000000
    v_mov_b32 v118, 0x7f000000
    v_mov_b32 v248, 0x7f000000
    v_mov_b32 v249, 0x7f000000
    v_mov_b32 v250, 0x7f000000
    v_mov_b32 v251, 0x7f000000
    s_lshl_b32 s39, s24, 2
    s_lshr_b32 s32, s25, 3
    s_add_u32 s39, s39, s32
    s_and_b32 s42, s25, 7
    s_mov_b32 s37, 0
    s_branch L_prep
L_comp:
    s_cmp_lg_u32 s29, 1
    s_cbranch_scc1 L_w4_20
    s_getpc_b64 s[30:31]
L_pca:
    s_sub_u32 s30, s30, L_pca - concat_heads__ssm_conv_s5__mha_block__prompt_kernel
    s_subb_u32 s31, s31, 0
    s_lshl_b32 s32, s25, 11
    v_lshlrev_b32 v3, 7, v2
    v_add_u32 v3, s32, v3
    v_cmp_gt_u32 vcc, L_end - concat_heads__ssm_conv_s5__mha_block__prompt_kernel, v3
    s_and_b32 vcc_lo, vcc_lo, 0xffff
    s_mov_b32 vcc_hi, 0
    s_and_saveexec_b64 s[32:33], vcc
    s_cbranch_execz L_pcxa
    global_load_dword v127, v3, s[30:31]
L_pcxa:
    s_mov_b64 exec, s[32:33]
L_w4_20:
    v_mov_b32 v6, 0x7f000000
    v_mov_b32 v7, 0x7f000000
    s_waitcnt lgkmcnt(0)
    s_add_u32 s8, s50, 0
    s_addc_u32 s9, s51, 0
    s_and_b32 s49, s49, 0xffff
    s_mov_b32 s50, 256
    s_mov_b32 s51, 0x00020000
    s_add_u32 s44, s8, 18022400
    s_addc_u32 s45, s9, 0
    s_and_b32 s45, s45, 0xffff
    s_mov_b32 s46, 282884
    s_mov_b32 s47, 0x00020000
    v_mov_b32 v107, 0x7f000000
    v_mov_b32 v116, 0x7f000000
    v_mov_b32 v118, 0x7f000000
    v_mov_b32 v248, 0x7f000000
    v_mov_b32 v249, 0x7f000000
    v_mov_b32 v250, 0x7f000000
    v_mov_b32 v251, 0x7f000000
    s_lshl_b32 s39, s24, 2
    s_lshr_b32 s32, s25, 3
    s_add_u32 s39, s39, s32
    s_and_b32 s42, s25, 7
    s_mov_b32 s37, 0
    s_cmp_eq_u32 s28, 0
    s_cbranch_scc1 L_compA
    s_and_b32 s31, s29, 1
    s_lshl_b32 s33, s31, 5
    v_bfe_u32 v3, v2, 2, 1
    v_lshlrev_b32 v3, 6, v3
    v_and_b32 v8, 1, v2
    v_lshl_add_u32 v3, v8, 5, v3
    v_bfe_u32 v8, v2, 1, 1
    v_add_u32 v3, v3, v8
    v_bfe_u32 v8, v2, 3, 2
    v_lshl_add_u32 v3, v8, 1, v3
    s_lshr_b32 s32, s29, 1
    s_lshl_b32 s35, s32, 7
    v_add_u32 v3, s35, v3
    v_lshrrev_b32 v9, 5, v2
    v_bfe_u32 v8, v3, 1, 3
    v_bfe_u32 v10, v3, 5, 1
    v_lshlrev_b32 v10, 2, v10
    v_xor_b32 v8, v8, v10
    v_xor_b32 v8, v8, v9
    v_xor_b32 v10, 0, v8
    v_lshlrev_b32 v10, 4, v10
    v_lshl_add_u32 v88, v3, 7, v10
    v_xor_b32 v10, 2, v8
    v_lshlrev_b32 v10, 4, v10
    v_lshl_add_u32 v89, v3, 7, v10
    v_xor_b32 v10, 4, v8
    v_lshlrev_b32 v10, 4, v10
    v_lshl_add_u32 v90, v3, 7, v10
    v_xor_b32 v10, 6, v8
    v_lshlrev_b32 v10, 4, v10
    v_lshl_add_u32 v91, v3, 7, v10
    v_and_b32 v11, 31, v2
    v_add_u32 v3, s33, v11
    v_bfe_u32 v8, v3, 1, 3
    v_xor_b32 v8, v8, v9
    v_xor_b32 v10, 0, v8
    v_lshlrev_b32 v10, 4, v10
    v_lshl_add_u32 v92, v3, 7, v10
    v_add_u32 v92, 32768, v92
    v_xor_b32 v10, 2, v8
    v_lshlrev_b32 v10, 4, v10
    v_lshl_add_u32 v93, v3, 7, v10
    v_add_u32 v93, 32768, v93
    v_xor_b32 v10, 4, v8
    v_lshlrev_b32 v10, 4, v10
    v_lshl_add_u32 v94, v3, 7, v10
    v_add_u32 v94, 32768, v94
    v_xor_b32 v10, 6, v8
    v_lshlrev_b32 v10, 4, v10
    v_lshl_add_u32 v95, v3, 7, v10
    v_add_u32 v95, 32768, v95
    v_add_u32 v96, 49152, v88
    v_add_u32 v97, 49152, v89
    v_add_u32 v98, 49152, v90
    v_add_u32 v99, 49152, v91
    v_add_u32 v100, 49152, v92
    v_add_u32 v101, 49152, v93
    v_add_u32 v102, 49152, v94
    v_add_u32 v103, 49152, v95
    v_add_u32 v104, 98304, v88
    v_add_u32 v105, 98304, v89
    v_add_u32 v106, 98304, v90
    v_add_u32 v107, 98304, v91
    v_add_u32 v108, 98304, v92
    v_add_u32 v109, 98304, v93
    v_add_u32 v110, 98304, v94
    v_add_u32 v111, 98304, v95
    s_lshl_b32 s30, s27, 6
    s_add_u32 s30, s30, s33
    v_add_u32 v12, s30, v11
    s_load_dwordx4 s[4:7], s[0:1], 8
    s_load_dwordx2 s[10:11], s[0:1], 56
    v_lshlrev_b32 v12, 1, v12
    s_waitcnt lgkmcnt(0)
    s_mov_b32 s64, s4
    s_and_b32 s65, s5, 0xffff
    s_mov_b32 s66, 1280
    s_mov_b32 s67, 0x00020000
    buffer_load_ushort v13, v12, s[64:67], 0 offen
    s_mov_b32 s64, s6
    s_and_b32 s65, s7, 0xffff
    s_mov_b32 s66, 1280
    s_mov_b32 s67, 0x00020000
    buffer_load_ushort v14, v12, s[64:67], 0 offen
    s_mov_b32 s64, s10
    s_and_b32 s65, s11, 0xffff
    s_mov_b32 s66, 1280
    s_mov_b32 s67, 0x00020000
    buffer_load_ushort v15, v12, s[64:67], 0 offen
    s_lshl_b32 s30, s27, 1
    s_add_u32 s30, s30, s31
    s_lshl_b32 s30, s30, 18
    s_lshl_b32 s31, s26, 15
    s_add_u32 s30, s30, s31
    s_lshl_b32 s31, s32, 14
    s_add_u32 s30, s30, s31
    v_lshl_add_u32 v8, v9, 13, s30
    v_lshl_add_u32 v6, v11, 4, v8
    s_lshl_b32 s30, s32, 2
    v_lshl_add_u32 v8, v9, 1, s30
    v_lshlrev_b32 v8, 8, v8
    v_lshl_add_u32 v8, v3, 2, v8
    v_add_u32 v7, 143360, v8
    s_barrier
    ds_read_b128 v[40:43], v88 offset:0
    ds_read_b128 v[56:59], v92
    ds_read_b128 v[44:47], v90 offset:1024
    ds_read_b128 v[60:63], v92 offset:8192
    ds_read_b128 v[48:51], v88 offset:2048
    ds_read_b128 v[52:55], v90 offset:3072
    s_waitcnt lgkmcnt(4)
    v_mfma_f32_32x32x16_bf16 v[128:143], v[40:43], v[56:59], 0
    ds_read_b128 v[64:67], v89 offset:0
    ds_read_b128 v[80:83], v93
    s_waitcnt lgkmcnt(5)
    v_mfma_f32_32x32x16_bf16 v[160:175], v[44:47], v[56:59], 0
    ds_read_b128 v[68:71], v91 offset:1024
    ds_read_b128 v[84:87], v93 offset:8192
    s_waitcnt lgkmcnt(6)
    v_mfma_f32_32x32x16_bf16 v[144:159], v[40:43], v[60:63], 0
    ds_read_b128 v[72:75], v89 offset:2048
    v_mfma_f32_32x32x16_bf16 v[176:191], v[44:47], v[60:63], 0
    ds_read_b128 v[76:79], v91 offset:3072
    s_waitcnt lgkmcnt(7)
    v_mfma_f32_32x32x16_bf16 v[192:207], v[48:51], v[56:59], 0
    v_mfma_f32_32x32x16_bf16 v[208:223], v[48:51], v[60:63], 0
    s_waitcnt lgkmcnt(6)
    v_mfma_f32_32x32x16_bf16 v[224:239], v[52:55], v[56:59], 0
    v_mfma_f32_32x32x16_bf16 v[240:255], v[52:55], v[60:63], 0
    s_waitcnt lgkmcnt(4)
    v_mfma_f32_32x32x16_bf16 v[128:143], v[64:67], v[80:83], v[128:143]
    ds_read_b128 v[40:43], v90 offset:0
    ds_read_b128 v[56:59], v94
    s_waitcnt lgkmcnt(5)
    v_mfma_f32_32x32x16_bf16 v[160:175], v[68:71], v[80:83], v[160:175]
    ds_read_b128 v[44:47], v88 offset:1024
    ds_read_b128 v[60:63], v94 offset:8192
    s_waitcnt lgkmcnt(6)
    v_mfma_f32_32x32x16_bf16 v[144:159], v[64:67], v[84:87], v[144:159]
    ds_read_b128 v[48:51], v90 offset:2048
    v_mfma_f32_32x32x16_bf16 v[176:191], v[68:71], v[84:87], v[176:191]
    ds_read_b128 v[52:55], v88 offset:3072
    s_waitcnt lgkmcnt(7)
    v_mfma_f32_32x32x16_bf16 v[192:207], v[72:75], v[80:83], v[192:207]
    v_mfma_f32_32x32x16_bf16 v[208:223], v[72:75], v[84:87], v[208:223]
    s_waitcnt lgkmcnt(6)
    v_mfma_f32_32x32x16_bf16 v[224:239], v[76:79], v[80:83], v[224:239]
    v_mfma_f32_32x32x16_bf16 v[240:255], v[76:79], v[84:87], v[240:255]
    s_waitcnt lgkmcnt(4)
    v_mfma_f32_32x32x16_bf16 v[128:143], v[40:43], v[56:59], v[128:143]
    ds_read_b128 v[64:67], v91 offset:0
    ds_read_b128 v[80:83], v95
    s_waitcnt lgkmcnt(5)
    v_mfma_f32_32x32x16_bf16 v[160:175], v[44:47], v[56:59], v[160:175]
    ds_read_b128 v[68:71], v89 offset:1024
    ds_read_b128 v[84:87], v95 offset:8192
    s_waitcnt lgkmcnt(6)
    v_mfma_f32_32x32x16_bf16 v[144:159], v[40:43], v[60:63], v[144:159]
    ds_read_b128 v[72:75], v91 offset:2048
    v_mfma_f32_32x32x16_bf16 v[176:191], v[44:47], v[60:63], v[176:191]
    ds_read_b128 v[76:79], v89 offset:3072
    s_waitcnt lgkmcnt(7)
    v_mfma_f32_32x32x16_bf16 v[192:207], v[48:51], v[56:59], v[192:207]
    v_mfma_f32_32x32x16_bf16 v[208:223], v[48:51], v[60:63], v[208:223]
    s_waitcnt lgkmcnt(6)
    v_mfma_f32_32x32x16_bf16 v[224:239], v[52:55], v[56:59], v[224:239]
    v_mfma_f32_32x32x16_bf16 v[240:255], v[52:55], v[60:63], v[240:255]
    s_waitcnt lgkmcnt(4)
    v_mfma_f32_32x32x16_bf16 v[128:143], v[64:67], v[80:83], v[128:143]
    s_waitcnt lgkmcnt(3)
    v_mfma_f32_32x32x16_bf16 v[160:175], v[68:71], v[80:83], v[160:175]
    s_barrier
    s_waitcnt lgkmcnt(2)
    v_mfma_f32_32x32x16_bf16 v[144:159], v[64:67], v[84:87], v[144:159]
    ds_read_b128 v[40:43], v96 offset:0
    ds_read_b128 v[56:59], v100
    v_mfma_f32_32x32x16_bf16 v[176:191], v[68:71], v[84:87], v[176:191]
    ds_read_b128 v[44:47], v98 offset:1024
    ds_read_b128 v[60:63], v100 offset:8192
    s_waitcnt lgkmcnt(5)
    v_mfma_f32_32x32x16_bf16 v[192:207], v[72:75], v[80:83], v[192:207]
    ds_read_b128 v[48:51], v96 offset:2048
    v_mfma_f32_32x32x16_bf16 v[208:223], v[72:75], v[84:87], v[208:223]
    ds_read_b128 v[52:55], v98 offset:3072
    s_waitcnt lgkmcnt(6)
    v_mfma_f32_32x32x16_bf16 v[224:239], v[76:79], v[80:83], v[224:239]
    v_mfma_f32_32x32x16_bf16 v[240:255], v[76:79], v[84:87], v[240:255]
    s_barrier
    s_waitcnt lgkmcnt(4)
    v_mfma_f32_32x32x16_bf16 v[128:143], v[40:43], v[56:59], v[128:143]
    ds_read_b128 v[64:67], v97 offset:0
    ds_read_b128 v[80:83], v101
    s_waitcnt lgkmcnt(5)
    v_mfma_f32_32x32x16_bf16 v[160:175], v[44:47], v[56:59], v[160:175]
    ds_read_b128 v[68:71], v99 offset:1024
    ds_read_b128 v[84:87], v101 offset:8192
    s_waitcnt lgkmcnt(6)
    v_mfma_f32_32x32x16_bf16 v[144:159], v[40:43], v[60:63], v[144:159]
    ds_read_b128 v[72:75], v97 offset:2048
    v_mfma_f32_32x32x16_bf16 v[176:191], v[44:47], v[60:63], v[176:191]
    ds_read_b128 v[76:79], v99 offset:3072
    s_waitcnt lgkmcnt(7)
    v_mfma_f32_32x32x16_bf16 v[192:207], v[48:51], v[56:59], v[192:207]
    v_mfma_f32_32x32x16_bf16 v[208:223], v[48:51], v[60:63], v[208:223]
    s_waitcnt lgkmcnt(6)
    v_mfma_f32_32x32x16_bf16 v[224:239], v[52:55], v[56:59], v[224:239]
    v_mfma_f32_32x32x16_bf16 v[240:255], v[52:55], v[60:63], v[240:255]
    s_waitcnt lgkmcnt(4)
    v_mfma_f32_32x32x16_bf16 v[128:143], v[64:67], v[80:83], v[128:143]
    ds_read_b128 v[40:43], v98 offset:0
    ds_read_b128 v[56:59], v102
    s_waitcnt lgkmcnt(5)
    v_mfma_f32_32x32x16_bf16 v[160:175], v[68:71], v[80:83], v[160:175]
    ds_read_b128 v[44:47], v96 offset:1024
    ds_read_b128 v[60:63], v102 offset:8192
    s_waitcnt lgkmcnt(6)
    v_mfma_f32_32x32x16_bf16 v[144:159], v[64:67], v[84:87], v[144:159]
    ds_read_b128 v[48:51], v98 offset:2048
    v_mfma_f32_32x32x16_bf16 v[176:191], v[68:71], v[84:87], v[176:191]
    ds_read_b128 v[52:55], v96 offset:3072
    s_waitcnt lgkmcnt(7)
    v_mfma_f32_32x32x16_bf16 v[192:207], v[72:75], v[80:83], v[192:207]
    v_mfma_f32_32x32x16_bf16 v[208:223], v[72:75], v[84:87], v[208:223]
    s_waitcnt lgkmcnt(6)
    v_mfma_f32_32x32x16_bf16 v[224:239], v[76:79], v[80:83], v[224:239]
    v_mfma_f32_32x32x16_bf16 v[240:255], v[76:79], v[84:87], v[240:255]
    s_waitcnt lgkmcnt(4)
    v_mfma_f32_32x32x16_bf16 v[128:143], v[40:43], v[56:59], v[128:143]
    ds_read_b128 v[64:67], v99 offset:0
    ds_read_b128 v[80:83], v103
    s_waitcnt lgkmcnt(5)
    v_mfma_f32_32x32x16_bf16 v[160:175], v[44:47], v[56:59], v[160:175]
    ds_read_b128 v[68:71], v97 offset:1024
    ds_read_b128 v[84:87], v103 offset:8192
    s_waitcnt lgkmcnt(6)
    v_mfma_f32_32x32x16_bf16 v[144:159], v[40:43], v[60:63], v[144:159]
    ds_read_b128 v[72:75], v99 offset:2048
    v_mfma_f32_32x32x16_bf16 v[176:191], v[44:47], v[60:63], v[176:191]
    ds_read_b128 v[76:79], v97 offset:3072
    s_waitcnt lgkmcnt(7)
    v_mfma_f32_32x32x16_bf16 v[192:207], v[48:51], v[56:59], v[192:207]
    v_mfma_f32_32x32x16_bf16 v[208:223], v[48:51], v[60:63], v[208:223]
    s_waitcnt lgkmcnt(6)
    v_mfma_f32_32x32x16_bf16 v[224:239], v[52:55], v[56:59], v[224:239]
    v_mfma_f32_32x32x16_bf16 v[240:255], v[52:55], v[60:63], v[240:255]
    s_waitcnt lgkmcnt(4)
    v_mfma_f32_32x32x16_bf16 v[128:143], v[64:67], v[80:83], v[128:143]
    s_waitcnt lgkmcnt(3)
    v_mfma_f32_32x32x16_bf16 v[160:175], v[68:71], v[80:83], v[160:175]
    s_barrier
    s_waitcnt lgkmcnt(2)
    v_mfma_f32_32x32x16_bf16 v[144:159], v[64:67], v[84:87], v[144:159]
    ds_read_b128 v[40:43], v104 offset:0
    ds_read_b128 v[56:59], v108
    v_mfma_f32_32x32x16_bf16 v[176:191], v[68:71], v[84:87], v[176:191]
    ds_read_b128 v[44:47], v106 offset:1024
    ds_read_b128 v[60:63], v108 offset:8192
    s_waitcnt lgkmcnt(5)
    v_mfma_f32_32x32x16_bf16 v[192:207], v[72:75], v[80:83], v[192:207]
    ds_read_b128 v[48:51], v104 offset:2048
    v_mfma_f32_32x32x16_bf16 v[208:223], v[72:75], v[84:87], v[208:223]
    ds_read_b128 v[52:55], v106 offset:3072
    s_waitcnt lgkmcnt(6)
    v_mfma_f32_32x32x16_bf16 v[224:239], v[76:79], v[80:83], v[224:239]
    v_mfma_f32_32x32x16_bf16 v[240:255], v[76:79], v[84:87], v[240:255]
    s_barrier
    s_waitcnt lgkmcnt(4)
    v_mfma_f32_32x32x16_bf16 v[128:143], v[40:43], v[56:59], v[128:143]
    ds_read_b128 v[64:67], v105 offset:0
    ds_read_b128 v[80:83], v109
    s_waitcnt lgkmcnt(5)
    v_mfma_f32_32x32x16_bf16 v[160:175], v[44:47], v[56:59], v[160:175]
    ds_read_b128 v[68:71], v107 offset:1024
    ds_read_b128 v[84:87], v109 offset:8192
    s_waitcnt lgkmcnt(6)
    v_mfma_f32_32x32x16_bf16 v[144:159], v[40:43], v[60:63], v[144:159]
    ds_read_b128 v[72:75], v105 offset:2048
    v_mfma_f32_32x32x16_bf16 v[176:191], v[44:47], v[60:63], v[176:191]
    ds_read_b128 v[76:79], v107 offset:3072
    s_waitcnt lgkmcnt(7)
    v_mfma_f32_32x32x16_bf16 v[192:207], v[48:51], v[56:59], v[192:207]
    v_mfma_f32_32x32x16_bf16 v[208:223], v[48:51], v[60:63], v[208:223]
    s_waitcnt lgkmcnt(6)
    v_mfma_f32_32x32x16_bf16 v[224:239], v[52:55], v[56:59], v[224:239]
    v_mfma_f32_32x32x16_bf16 v[240:255], v[52:55], v[60:63], v[240:255]
    s_waitcnt lgkmcnt(4)
    v_mfma_f32_32x32x16_bf16 v[128:143], v[64:67], v[80:83], v[128:143]
    ds_read_b128 v[40:43], v106 offset:0
    ds_read_b128 v[56:59], v110
    s_waitcnt lgkmcnt(5)
    v_mfma_f32_32x32x16_bf16 v[160:175], v[68:71], v[80:83], v[160:175]
    ds_read_b128 v[44:47], v104 offset:1024
    ds_read_b128 v[60:63], v110 offset:8192
    s_waitcnt lgkmcnt(6)
    v_mfma_f32_32x32x16_bf16 v[144:159], v[64:67], v[84:87], v[144:159]
    ds_read_b128 v[48:51], v106 offset:2048
    v_mfma_f32_32x32x16_bf16 v[176:191], v[68:71], v[84:87], v[176:191]
    ds_read_b128 v[52:55], v104 offset:3072
    s_waitcnt lgkmcnt(7)
    v_mfma_f32_32x32x16_bf16 v[192:207], v[72:75], v[80:83], v[192:207]
    v_mfma_f32_32x32x16_bf16 v[208:223], v[72:75], v[84:87], v[208:223]
    s_waitcnt lgkmcnt(6)
    v_mfma_f32_32x32x16_bf16 v[224:239], v[76:79], v[80:83], v[224:239]
    v_mfma_f32_32x32x16_bf16 v[240:255], v[76:79], v[84:87], v[240:255]
    s_waitcnt lgkmcnt(4)
    v_mfma_f32_32x32x16_bf16 v[128:143], v[40:43], v[56:59], v[128:143]
    ds_read_b128 v[64:67], v107 offset:0
    ds_read_b128 v[80:83], v111
    s_waitcnt lgkmcnt(5)
    v_mfma_f32_32x32x16_bf16 v[160:175], v[44:47], v[56:59], v[160:175]
    ds_read_b128 v[68:71], v105 offset:1024
    ds_read_b128 v[84:87], v111 offset:8192
    s_waitcnt lgkmcnt(6)
    v_mfma_f32_32x32x16_bf16 v[144:159], v[40:43], v[60:63], v[144:159]
    ds_read_b128 v[72:75], v107 offset:2048
    v_mfma_f32_32x32x16_bf16 v[176:191], v[44:47], v[60:63], v[176:191]
    ds_read_b128 v[76:79], v105 offset:3072
    s_waitcnt lgkmcnt(7)
    v_mfma_f32_32x32x16_bf16 v[192:207], v[48:51], v[56:59], v[192:207]
    v_mfma_f32_32x32x16_bf16 v[208:223], v[48:51], v[60:63], v[208:223]
    s_waitcnt lgkmcnt(6)
    v_mfma_f32_32x32x16_bf16 v[224:239], v[52:55], v[56:59], v[224:239]
    v_mfma_f32_32x32x16_bf16 v[240:255], v[52:55], v[60:63], v[240:255]
    s_waitcnt lgkmcnt(4)
    v_mfma_f32_32x32x16_bf16 v[128:143], v[64:67], v[80:83], v[128:143]
    s_waitcnt lgkmcnt(3)
    v_mfma_f32_32x32x16_bf16 v[160:175], v[68:71], v[80:83], v[160:175]
    s_barrier
    s_waitcnt lgkmcnt(2)
    v_mfma_f32_32x32x16_bf16 v[144:159], v[64:67], v[84:87], v[144:159]
    ds_read_b128 v[40:43], v88 offset:0
    ds_read_b128 v[56:59], v92
    v_mfma_f32_32x32x16_bf16 v[176:191], v[68:71], v[84:87], v[176:191]
    ds_read_b128 v[44:47], v90 offset:1024
    ds_read_b128 v[60:63], v92 offset:8192
    s_waitcnt lgkmcnt(5)
    v_mfma_f32_32x32x16_bf16 v[192:207], v[72:75], v[80:83], v[192:207]
    ds_read_b128 v[48:51], v88 offset:2048
    v_mfma_f32_32x32x16_bf16 v[208:223], v[72:75], v[84:87], v[208:223]
    ds_read_b128 v[52:55], v90 offset:3072
    s_waitcnt lgkmcnt(6)
    v_mfma_f32_32x32x16_bf16 v[224:239], v[76:79], v[80:83], v[224:239]
    v_mfma_f32_32x32x16_bf16 v[240:255], v[76:79], v[84:87], v[240:255]
    s_barrier
    s_waitcnt lgkmcnt(4)
    v_mfma_f32_32x32x16_bf16 v[128:143], v[40:43], v[56:59], v[128:143]
    ds_read_b128 v[64:67], v89 offset:0
    ds_read_b128 v[80:83], v93
    s_waitcnt lgkmcnt(5)
    v_mfma_f32_32x32x16_bf16 v[160:175], v[44:47], v[56:59], v[160:175]
    ds_read_b128 v[68:71], v91 offset:1024
    ds_read_b128 v[84:87], v93 offset:8192
    s_waitcnt lgkmcnt(6)
    v_mfma_f32_32x32x16_bf16 v[144:159], v[40:43], v[60:63], v[144:159]
    ds_read_b128 v[72:75], v89 offset:2048
    v_mfma_f32_32x32x16_bf16 v[176:191], v[44:47], v[60:63], v[176:191]
    ds_read_b128 v[76:79], v91 offset:3072
    s_waitcnt lgkmcnt(7)
    v_mfma_f32_32x32x16_bf16 v[192:207], v[48:51], v[56:59], v[192:207]
    v_mfma_f32_32x32x16_bf16 v[208:223], v[48:51], v[60:63], v[208:223]
    s_waitcnt lgkmcnt(6)
    v_mfma_f32_32x32x16_bf16 v[224:239], v[52:55], v[56:59], v[224:239]
    v_mfma_f32_32x32x16_bf16 v[240:255], v[52:55], v[60:63], v[240:255]
    s_waitcnt lgkmcnt(4)
    v_mfma_f32_32x32x16_bf16 v[128:143], v[64:67], v[80:83], v[128:143]
    ds_read_b128 v[40:43], v90 offset:0
    ds_read_b128 v[56:59], v94
    s_waitcnt lgkmcnt(5)
    v_mfma_f32_32x32x16_bf16 v[160:175], v[68:71], v[80:83], v[160:175]
    ds_read_b128 v[44:47], v88 offset:1024
    ds_read_b128 v[60:63], v94 offset:8192
    s_waitcnt lgkmcnt(6)
    v_mfma_f32_32x32x16_bf16 v[144:159], v[64:67], v[84:87], v[144:159]
    ds_read_b128 v[48:51], v90 offset:2048
    v_mfma_f32_32x32x16_bf16 v[176:191], v[68:71], v[84:87], v[176:191]
    ds_read_b128 v[52:55], v88 offset:3072
    s_waitcnt lgkmcnt(7)
    v_mfma_f32_32x32x16_bf16 v[192:207], v[72:75], v[80:83], v[192:207]
    v_mfma_f32_32x32x16_bf16 v[208:223], v[72:75], v[84:87], v[208:223]
    s_waitcnt lgkmcnt(6)
    v_mfma_f32_32x32x16_bf16 v[224:239], v[76:79], v[80:83], v[224:239]
    v_mfma_f32_32x32x16_bf16 v[240:255], v[76:79], v[84:87], v[240:255]
    s_waitcnt lgkmcnt(4)
    v_mfma_f32_32x32x16_bf16 v[128:143], v[40:43], v[56:59], v[128:143]
    ds_read_b128 v[64:67], v91 offset:0
    ds_read_b128 v[80:83], v95
    s_waitcnt lgkmcnt(5)
    v_mfma_f32_32x32x16_bf16 v[160:175], v[44:47], v[56:59], v[160:175]
    ds_read_b128 v[68:71], v89 offset:1024
    ds_read_b128 v[84:87], v95 offset:8192
    s_waitcnt lgkmcnt(6)
    v_mfma_f32_32x32x16_bf16 v[144:159], v[40:43], v[60:63], v[144:159]
    ds_read_b128 v[72:75], v91 offset:2048
    v_mfma_f32_32x32x16_bf16 v[176:191], v[44:47], v[60:63], v[176:191]
    ds_read_b128 v[76:79], v89 offset:3072
    s_waitcnt lgkmcnt(7)
    v_mfma_f32_32x32x16_bf16 v[192:207], v[48:51], v[56:59], v[192:207]
    v_mfma_f32_32x32x16_bf16 v[208:223], v[48:51], v[60:63], v[208:223]
    s_waitcnt lgkmcnt(6)
    v_mfma_f32_32x32x16_bf16 v[224:239], v[52:55], v[56:59], v[224:239]
    v_mfma_f32_32x32x16_bf16 v[240:255], v[52:55], v[60:63], v[240:255]
    s_waitcnt lgkmcnt(4)
    v_mfma_f32_32x32x16_bf16 v[128:143], v[64:67], v[80:83], v[128:143]
    s_waitcnt lgkmcnt(3)
    v_mfma_f32_32x32x16_bf16 v[160:175], v[68:71], v[80:83], v[160:175]
    s_barrier
    s_waitcnt lgkmcnt(2)
    v_mfma_f32_32x32x16_bf16 v[144:159], v[64:67], v[84:87], v[144:159]
    ds_read_b128 v[40:43], v96 offset:0
    ds_read_b128 v[56:59], v100
    v_mfma_f32_32x32x16_bf16 v[176:191], v[68:71], v[84:87], v[176:191]
    ds_read_b128 v[44:47], v98 offset:1024
    ds_read_b128 v[60:63], v100 offset:8192
    s_waitcnt lgkmcnt(5)
    v_mfma_f32_32x32x16_bf16 v[192:207], v[72:75], v[80:83], v[192:207]
    ds_read_b128 v[48:51], v96 offset:2048
    v_mfma_f32_32x32x16_bf16 v[208:223], v[72:75], v[84:87], v[208:223]
    ds_read_b128 v[52:55], v98 offset:3072
    s_waitcnt lgkmcnt(6)
    v_mfma_f32_32x32x16_bf16 v[224:239], v[76:79], v[80:83], v[224:239]
    v_mfma_f32_32x32x16_bf16 v[240:255], v[76:79], v[84:87], v[240:255]
    s_barrier
    s_waitcnt lgkmcnt(4)
    v_mfma_f32_32x32x16_bf16 v[128:143], v[40:43], v[56:59], v[128:143]
    ds_read_b128 v[64:67], v97 offset:0
    ds_read_b128 v[80:83], v101
    s_waitcnt lgkmcnt(5)
    v_mfma_f32_32x32x16_bf16 v[160:175], v[44:47], v[56:59], v[160:175]
    ds_read_b128 v[68:71], v99 offset:1024
    ds_read_b128 v[84:87], v101 offset:8192
    s_waitcnt lgkmcnt(6)
    v_mfma_f32_32x32x16_bf16 v[144:159], v[40:43], v[60:63], v[144:159]
    ds_read_b128 v[72:75], v97 offset:2048
    v_mfma_f32_32x32x16_bf16 v[176:191], v[44:47], v[60:63], v[176:191]
    ds_read_b128 v[76:79], v99 offset:3072
    s_waitcnt lgkmcnt(7)
    v_mfma_f32_32x32x16_bf16 v[192:207], v[48:51], v[56:59], v[192:207]
    v_mfma_f32_32x32x16_bf16 v[208:223], v[48:51], v[60:63], v[208:223]
    s_waitcnt lgkmcnt(6)
    v_mfma_f32_32x32x16_bf16 v[224:239], v[52:55], v[56:59], v[224:239]
    v_mfma_f32_32x32x16_bf16 v[240:255], v[52:55], v[60:63], v[240:255]
    s_waitcnt lgkmcnt(4)
    v_mfma_f32_32x32x16_bf16 v[128:143], v[64:67], v[80:83], v[128:143]
    ds_read_b128 v[40:43], v98 offset:0
    ds_read_b128 v[56:59], v102
    s_waitcnt lgkmcnt(5)
    v_mfma_f32_32x32x16_bf16 v[160:175], v[68:71], v[80:83], v[160:175]
    ds_read_b128 v[44:47], v96 offset:1024
    ds_read_b128 v[60:63], v102 offset:8192
    s_waitcnt lgkmcnt(6)
    v_mfma_f32_32x32x16_bf16 v[144:159], v[64:67], v[84:87], v[144:159]
    ds_read_b128 v[48:51], v98 offset:2048
    v_mfma_f32_32x32x16_bf16 v[176:191], v[68:71], v[84:87], v[176:191]
    ds_read_b128 v[52:55], v96 offset:3072
    s_waitcnt lgkmcnt(7)
    v_mfma_f32_32x32x16_bf16 v[192:207], v[72:75], v[80:83], v[192:207]
    v_mfma_f32_32x32x16_bf16 v[208:223], v[72:75], v[84:87], v[208:223]
    s_waitcnt lgkmcnt(6)
    v_mfma_f32_32x32x16_bf16 v[224:239], v[76:79], v[80:83], v[224:239]
    v_mfma_f32_32x32x16_bf16 v[240:255], v[76:79], v[84:87], v[240:255]
    s_waitcnt lgkmcnt(4)
    v_mfma_f32_32x32x16_bf16 v[128:143], v[40:43], v[56:59], v[128:143]
    ds_read_b128 v[64:67], v99 offset:0
    ds_read_b128 v[80:83], v103
    s_waitcnt lgkmcnt(5)
    v_mfma_f32_32x32x16_bf16 v[160:175], v[44:47], v[56:59], v[160:175]
    ds_read_b128 v[68:71], v97 offset:1024
    ds_read_b128 v[84:87], v103 offset:8192
    s_waitcnt lgkmcnt(6)
    v_mfma_f32_32x32x16_bf16 v[144:159], v[40:43], v[60:63], v[144:159]
    ds_read_b128 v[72:75], v99 offset:2048
    v_mfma_f32_32x32x16_bf16 v[176:191], v[44:47], v[60:63], v[176:191]
    ds_read_b128 v[76:79], v97 offset:3072
    s_waitcnt lgkmcnt(7)
    v_mfma_f32_32x32x16_bf16 v[192:207], v[48:51], v[56:59], v[192:207]
    v_mfma_f32_32x32x16_bf16 v[208:223], v[48:51], v[60:63], v[208:223]
    s_waitcnt lgkmcnt(6)
    v_mfma_f32_32x32x16_bf16 v[224:239], v[52:55], v[56:59], v[224:239]
    v_mfma_f32_32x32x16_bf16 v[240:255], v[52:55], v[60:63], v[240:255]
    s_waitcnt lgkmcnt(4)
    v_mfma_f32_32x32x16_bf16 v[128:143], v[64:67], v[80:83], v[128:143]
    s_waitcnt lgkmcnt(3)
    v_mfma_f32_32x32x16_bf16 v[160:175], v[68:71], v[80:83], v[160:175]
    buffer_load_dword v12, off, s[48:51], 0 sc1
    s_barrier
    s_waitcnt lgkmcnt(2)
    v_mfma_f32_32x32x16_bf16 v[144:159], v[64:67], v[84:87], v[144:159]
    ds_read_b128 v[40:43], v104 offset:0
    ds_read_b128 v[56:59], v108
    v_mfma_f32_32x32x16_bf16 v[176:191], v[68:71], v[84:87], v[176:191]
    ds_read_b128 v[44:47], v106 offset:1024
    ds_read_b128 v[60:63], v108 offset:8192
    s_waitcnt lgkmcnt(5)
    v_mfma_f32_32x32x16_bf16 v[192:207], v[72:75], v[80:83], v[192:207]
    ds_read_b128 v[48:51], v104 offset:2048
    v_mfma_f32_32x32x16_bf16 v[208:223], v[72:75], v[84:87], v[208:223]
    ds_read_b128 v[52:55], v106 offset:3072
    s_waitcnt lgkmcnt(6)
    v_mfma_f32_32x32x16_bf16 v[224:239], v[76:79], v[80:83], v[224:239]
    v_mfma_f32_32x32x16_bf16 v[240:255], v[76:79], v[84:87], v[240:255]
    s_barrier
    s_waitcnt lgkmcnt(4)
    v_mfma_f32_32x32x16_bf16 v[128:143], v[40:43], v[56:59], v[128:143]
    ds_read_b128 v[64:67], v105 offset:0
    ds_read_b128 v[80:83], v109
    s_waitcnt lgkmcnt(5)
    v_mfma_f32_32x32x16_bf16 v[160:175], v[44:47], v[56:59], v[160:175]
    ds_read_b128 v[68:71], v107 offset:1024
    ds_read_b128 v[84:87], v109 offset:8192
    s_waitcnt lgkmcnt(6)
    v_mfma_f32_32x32x16_bf16 v[144:159], v[40:43], v[60:63], v[144:159]
    ds_read_b128 v[72:75], v105 offset:2048
    v_mfma_f32_32x32x16_bf16 v[176:191], v[44:47], v[60:63], v[176:191]
    ds_read_b128 v[76:79], v107 offset:3072
    s_waitcnt lgkmcnt(7)
    v_mfma_f32_32x32x16_bf16 v[192:207], v[48:51], v[56:59], v[192:207]
    v_mfma_f32_32x32x16_bf16 v[208:223], v[48:51], v[60:63], v[208:223]
    s_waitcnt lgkmcnt(6)
    v_mfma_f32_32x32x16_bf16 v[224:239], v[52:55], v[56:59], v[224:239]
    v_mfma_f32_32x32x16_bf16 v[240:255], v[52:55], v[60:63], v[240:255]
    s_waitcnt lgkmcnt(4)
    v_mfma_f32_32x32x16_bf16 v[128:143], v[64:67], v[80:83], v[128:143]
    ds_read_b128 v[40:43], v106 offset:0
    ds_read_b128 v[56:59], v110
    s_waitcnt lgkmcnt(5)
    v_mfma_f32_32x32x16_bf16 v[160:175], v[68:71], v[80:83], v[160:175]
    ds_read_b128 v[44:47], v104 offset:1024
    ds_read_b128 v[60:63], v110 offset:8192
    s_waitcnt lgkmcnt(6)
    v_mfma_f32_32x32x16_bf16 v[144:159], v[64:67], v[84:87], v[144:159]
    ds_read_b128 v[48:51], v106 offset:2048
    v_mfma_f32_32x32x16_bf16 v[176:191], v[68:71], v[84:87], v[176:191]
    ds_read_b128 v[52:55], v104 offset:3072
    s_waitcnt lgkmcnt(7)
    v_mfma_f32_32x32x16_bf16 v[192:207], v[72:75], v[80:83], v[192:207]
    v_mfma_f32_32x32x16_bf16 v[208:223], v[72:75], v[84:87], v[208:223]
    s_waitcnt lgkmcnt(6)
    v_mfma_f32_32x32x16_bf16 v[224:239], v[76:79], v[80:83], v[224:239]
    v_mfma_f32_32x32x16_bf16 v[240:255], v[76:79], v[84:87], v[240:255]
    s_waitcnt lgkmcnt(4)
    v_mfma_f32_32x32x16_bf16 v[128:143], v[40:43], v[56:59], v[128:143]
    ds_read_b128 v[64:67], v107 offset:0
    ds_read_b128 v[80:83], v111
    s_waitcnt lgkmcnt(5)
    v_mfma_f32_32x32x16_bf16 v[160:175], v[44:47], v[56:59], v[160:175]
    ds_read_b128 v[68:71], v105 offset:1024
    ds_read_b128 v[84:87], v111 offset:8192
    s_waitcnt lgkmcnt(6)
    v_mfma_f32_32x32x16_bf16 v[144:159], v[40:43], v[60:63], v[144:159]
    ds_read_b128 v[72:75], v107 offset:2048
    v_mfma_f32_32x32x16_bf16 v[176:191], v[44:47], v[60:63], v[176:191]
    ds_read_b128 v[76:79], v105 offset:3072
    s_waitcnt lgkmcnt(7)
    v_mfma_f32_32x32x16_bf16 v[192:207], v[48:51], v[56:59], v[192:207]
    v_mfma_f32_32x32x16_bf16 v[208:223], v[48:51], v[60:63], v[208:223]
    s_waitcnt lgkmcnt(6)
    v_mfma_f32_32x32x16_bf16 v[224:239], v[52:55], v[56:59], v[224:239]
    v_mfma_f32_32x32x16_bf16 v[240:255], v[52:55], v[60:63], v[240:255]
    s_waitcnt lgkmcnt(4)
    v_mfma_f32_32x32x16_bf16 v[128:143], v[64:67], v[80:83], v[128:143]
    s_waitcnt lgkmcnt(3)
    v_mfma_f32_32x32x16_bf16 v[160:175], v[68:71], v[80:83], v[160:175]
    s_barrier
    s_waitcnt lgkmcnt(2)
    v_mfma_f32_32x32x16_bf16 v[144:159], v[64:67], v[84:87], v[144:159]
    ds_read_b128 v[40:43], v88 offset:0
    ds_read_b128 v[56:59], v92
    v_mfma_f32_32x32x16_bf16 v[176:191], v[68:71], v[84:87], v[176:191]
    ds_read_b128 v[44:47], v90 offset:1024
    ds_read_b128 v[60:63], v92 offset:8192
    s_waitcnt lgkmcnt(5)
    v_mfma_f32_32x32x16_bf16 v[192:207], v[72:75], v[80:83], v[192:207]
    ds_read_b128 v[48:51], v88 offset:2048
    v_mfma_f32_32x32x16_bf16 v[208:223], v[72:75], v[84:87], v[208:223]
    ds_read_b128 v[52:55], v90 offset:3072
    s_waitcnt lgkmcnt(6)
    v_mfma_f32_32x32x16_bf16 v[224:239], v[76:79], v[80:83], v[224:239]
    v_mfma_f32_32x32x16_bf16 v[240:255], v[76:79], v[84:87], v[240:255]
    s_barrier
    s_waitcnt lgkmcnt(4)
    v_mfma_f32_32x32x16_bf16 v[128:143], v[40:43], v[56:59], v[128:143]
    ds_read_b128 v[64:67], v89 offset:0
    ds_read_b128 v[80:83], v93
    s_waitcnt lgkmcnt(5)
    v_mfma_f32_32x32x16_bf16 v[160:175], v[44:47], v[56:59], v[160:175]
    ds_read_b128 v[68:71], v91 offset:1024
    ds_read_b128 v[84:87], v93 offset:8192
    s_waitcnt lgkmcnt(6)
    v_mfma_f32_32x32x16_bf16 v[144:159], v[40:43], v[60:63], v[144:159]
    ds_read_b128 v[72:75], v89 offset:2048
    v_mfma_f32_32x32x16_bf16 v[176:191], v[44:47], v[60:63], v[176:191]
    ds_read_b128 v[76:79], v91 offset:3072
    s_waitcnt lgkmcnt(7)
    v_mfma_f32_32x32x16_bf16 v[192:207], v[48:51], v[56:59], v[192:207]
    v_mfma_f32_32x32x16_bf16 v[208:223], v[48:51], v[60:63], v[208:223]
    s_waitcnt lgkmcnt(6)
    v_mfma_f32_32x32x16_bf16 v[224:239], v[52:55], v[56:59], v[224:239]
    v_mfma_f32_32x32x16_bf16 v[240:255], v[52:55], v[60:63], v[240:255]
    s_waitcnt lgkmcnt(4)
    v_mfma_f32_32x32x16_bf16 v[128:143], v[64:67], v[80:83], v[128:143]
    ds_read_b128 v[40:43], v90 offset:0
    ds_read_b128 v[56:59], v94
    s_waitcnt lgkmcnt(5)
    v_mfma_f32_32x32x16_bf16 v[160:175], v[68:71], v[80:83], v[160:175]
    ds_read_b128 v[44:47], v88 offset:1024
    ds_read_b128 v[60:63], v94 offset:8192
    s_waitcnt lgkmcnt(6)
    v_mfma_f32_32x32x16_bf16 v[144:159], v[64:67], v[84:87], v[144:159]
    ds_read_b128 v[48:51], v90 offset:2048
    v_mfma_f32_32x32x16_bf16 v[176:191], v[68:71], v[84:87], v[176:191]
    ds_read_b128 v[52:55], v88 offset:3072
    s_waitcnt lgkmcnt(7)
    v_mfma_f32_32x32x16_bf16 v[192:207], v[72:75], v[80:83], v[192:207]
    v_mfma_f32_32x32x16_bf16 v[208:223], v[72:75], v[84:87], v[208:223]
    s_waitcnt lgkmcnt(6)
    v_mfma_f32_32x32x16_bf16 v[224:239], v[76:79], v[80:83], v[224:239]
    v_mfma_f32_32x32x16_bf16 v[240:255], v[76:79], v[84:87], v[240:255]
    s_waitcnt lgkmcnt(4)
    v_mfma_f32_32x32x16_bf16 v[128:143], v[40:43], v[56:59], v[128:143]
    ds_read_b128 v[64:67], v91 offset:0
    ds_read_b128 v[80:83], v95
    s_waitcnt lgkmcnt(5)
    v_mfma_f32_32x32x16_bf16 v[160:175], v[44:47], v[56:59], v[160:175]
    ds_read_b128 v[68:71], v89 offset:1024
    ds_read_b128 v[84:87], v95 offset:8192
    s_waitcnt lgkmcnt(6)
    v_mfma_f32_32x32x16_bf16 v[144:159], v[40:43], v[60:63], v[144:159]
    ds_read_b128 v[72:75], v91 offset:2048
    v_mfma_f32_32x32x16_bf16 v[176:191], v[44:47], v[60:63], v[176:191]
    ds_read_b128 v[76:79], v89 offset:3072
    s_waitcnt lgkmcnt(7)
    v_mfma_f32_32x32x16_bf16 v[192:207], v[48:51], v[56:59], v[192:207]
    v_mfma_f32_32x32x16_bf16 v[208:223], v[48:51], v[60:63], v[208:223]
    s_waitcnt lgkmcnt(6)
    v_mfma_f32_32x32x16_bf16 v[224:239], v[52:55], v[56:59], v[224:239]
    v_mfma_f32_32x32x16_bf16 v[240:255], v[52:55], v[60:63], v[240:255]
    s_waitcnt lgkmcnt(4)
    v_mfma_f32_32x32x16_bf16 v[128:143], v[64:67], v[80:83], v[128:143]
    s_waitcnt lgkmcnt(3)
    v_mfma_f32_32x32x16_bf16 v[160:175], v[68:71], v[80:83], v[160:175]
    s_barrier
    s_waitcnt lgkmcnt(2)
    v_mfma_f32_32x32x16_bf16 v[144:159], v[64:67], v[84:87], v[144:159]
    ds_read_b128 v[40:43], v96 offset:0
    ds_read_b128 v[56:59], v100
    v_mfma_f32_32x32x16_bf16 v[176:191], v[68:71], v[84:87], v[176:191]
    ds_read_b128 v[44:47], v98 offset:1024
    ds_read_b128 v[60:63], v100 offset:8192
    s_waitcnt lgkmcnt(5)
    v_mfma_f32_32x32x16_bf16 v[192:207], v[72:75], v[80:83], v[192:207]
    ds_read_b128 v[48:51], v96 offset:2048
    v_mfma_f32_32x32x16_bf16 v[208:223], v[72:75], v[84:87], v[208:223]
    ds_read_b128 v[52:55], v98 offset:3072
    s_waitcnt lgkmcnt(6)
    v_mfma_f32_32x32x16_bf16 v[224:239], v[76:79], v[80:83], v[224:239]
    v_mfma_f32_32x32x16_bf16 v[240:255], v[76:79], v[84:87], v[240:255]
    s_barrier
    s_waitcnt lgkmcnt(4)
    v_mfma_f32_32x32x16_bf16 v[128:143], v[40:43], v[56:59], v[128:143]
    ds_read_b128 v[64:67], v97 offset:0
    ds_read_b128 v[80:83], v101
    s_waitcnt lgkmcnt(5)
    v_mfma_f32_32x32x16_bf16 v[160:175], v[44:47], v[56:59], v[160:175]
    ds_read_b128 v[68:71], v99 offset:1024
    ds_read_b128 v[84:87], v101 offset:8192
    s_waitcnt lgkmcnt(6)
    v_mfma_f32_32x32x16_bf16 v[144:159], v[40:43], v[60:63], v[144:159]
    ds_read_b128 v[72:75], v97 offset:2048
    v_mfma_f32_32x32x16_bf16 v[176:191], v[44:47], v[60:63], v[176:191]
    ds_read_b128 v[76:79], v99 offset:3072
    s_waitcnt lgkmcnt(7)
    v_mfma_f32_32x32x16_bf16 v[192:207], v[48:51], v[56:59], v[192:207]
    v_mfma_f32_32x32x16_bf16 v[208:223], v[48:51], v[60:63], v[208:223]
    s_waitcnt lgkmcnt(6)
    v_mfma_f32_32x32x16_bf16 v[224:239], v[52:55], v[56:59], v[224:239]
    v_mfma_f32_32x32x16_bf16 v[240:255], v[52:55], v[60:63], v[240:255]
    s_waitcnt lgkmcnt(4)
    v_mfma_f32_32x32x16_bf16 v[128:143], v[64:67], v[80:83], v[128:143]
    ds_read_b128 v[40:43], v98 offset:0
    ds_read_b128 v[56:59], v102
    s_waitcnt lgkmcnt(5)
    v_mfma_f32_32x32x16_bf16 v[160:175], v[68:71], v[80:83], v[160:175]
    ds_read_b128 v[44:47], v96 offset:1024
    ds_read_b128 v[60:63], v102 offset:8192
    s_waitcnt lgkmcnt(6)
    v_mfma_f32_32x32x16_bf16 v[144:159], v[64:67], v[84:87], v[144:159]
    ds_read_b128 v[48:51], v98 offset:2048
    v_mfma_f32_32x32x16_bf16 v[176:191], v[68:71], v[84:87], v[176:191]
    ds_read_b128 v[52:55], v96 offset:3072
    s_waitcnt lgkmcnt(7)
    v_mfma_f32_32x32x16_bf16 v[192:207], v[72:75], v[80:83], v[192:207]
    v_mfma_f32_32x32x16_bf16 v[208:223], v[72:75], v[84:87], v[208:223]
    s_waitcnt lgkmcnt(6)
    v_mfma_f32_32x32x16_bf16 v[224:239], v[76:79], v[80:83], v[224:239]
    v_mfma_f32_32x32x16_bf16 v[240:255], v[76:79], v[84:87], v[240:255]
    s_waitcnt lgkmcnt(4)
    v_mfma_f32_32x32x16_bf16 v[128:143], v[40:43], v[56:59], v[128:143]
    ds_read_b128 v[64:67], v99 offset:0
    ds_read_b128 v[80:83], v103
    s_waitcnt lgkmcnt(5)
    v_mfma_f32_32x32x16_bf16 v[160:175], v[44:47], v[56:59], v[160:175]
    ds_read_b128 v[68:71], v97 offset:1024
    ds_read_b128 v[84:87], v103 offset:8192
    s_waitcnt lgkmcnt(6)
    v_mfma_f32_32x32x16_bf16 v[144:159], v[40:43], v[60:63], v[144:159]
    ds_read_b128 v[72:75], v99 offset:2048
    v_mfma_f32_32x32x16_bf16 v[176:191], v[44:47], v[60:63], v[176:191]
    ds_read_b128 v[76:79], v97 offset:3072
    s_waitcnt lgkmcnt(7)
    v_mfma_f32_32x32x16_bf16 v[192:207], v[48:51], v[56:59], v[192:207]
    v_mfma_f32_32x32x16_bf16 v[208:223], v[48:51], v[60:63], v[208:223]
    s_waitcnt lgkmcnt(6)
    v_mfma_f32_32x32x16_bf16 v[224:239], v[52:55], v[56:59], v[224:239]
    v_mfma_f32_32x32x16_bf16 v[240:255], v[52:55], v[60:63], v[240:255]
    s_waitcnt lgkmcnt(4)
    v_mfma_f32_32x32x16_bf16 v[128:143], v[64:67], v[80:83], v[128:143]
    s_waitcnt lgkmcnt(3)
    v_mfma_f32_32x32x16_bf16 v[160:175], v[68:71], v[80:83], v[160:175]
    s_waitcnt vmcnt(0)
    s_mov_b32 s72, 0
    v_readfirstlane_b32 s37, v12
    s_nop 3
    s_cmp_lg_u32 s37, 0
    s_cbranch_scc1 L_nonced_22
L_nonce_21:
    buffer_load_dword v12, off, s[48:51], 0 sc1
    s_waitcnt vmcnt(0)
    v_readfirstlane_b32 s37, v12
    s_add_u32 s72, s72, 1
    s_nop 2
    s_cmp_lg_u32 s37, 0
    s_cbranch_scc1 L_nonced_22
    s_sleep 1
    s_cmp_lt_u32 s72, 0x20000
    s_cbranch_scc1 L_nonce_21
L_nonced_22:
    v_lshlrev_b32 v13, 16, v13
    v_lshlrev_b32 v14, 16, v14
    v_lshlrev_b32 v15, 16, v15
    v_mul_f32 v15, 1069066811, v15
    v_exp_f32 v15, v15
    s_nop 0
    v_cvt_pk_bf16_f32 v15, v15, v15
    v_lshlrev_b32 v15, 16, v15
    v_mul_f32 v8, v15, v13
    v_mul_f32 v9, v15, v14
    v_mul_f32 v8, 1069066811, v8
    v_mul_f32 v9, 1042479491, v9
    v_exp_f32 v8, v8
    v_fract_f32 v9, v9
    v_cos_f32 v10, v9
    v_sin_f32 v11, v9
    s_nop 0
    v_mul_f32 v4, v8, v10
    v_mul_f32 v5, v8, v11
    s_barrier
    s_waitcnt lgkmcnt(2)
    v_mfma_f32_32x32x16_bf16 v[144:159], v[64:67], v[84:87], v[144:159]
    ds_read_b128 v[40:43], v104 offset:0
    ds_read_b128 v[56:59], v108
    v_mfma_f32_32x32x16_bf16 v[176:191], v[68:71], v[84:87], v[176:191]
    ds_read_b128 v[44:47], v106 offset:1024
    ds_read_b128 v[60:63], v108 offset:8192
    s_waitcnt lgkmcnt(5)
    v_mfma_f32_32x32x16_bf16 v[192:207], v[72:75], v[80:83], v[192:207]
    ds_read_b128 v[48:51], v104 offset:2048
    v_mfma_f32_32x32x16_bf16 v[208:223], v[72:75], v[84:87], v[208:223]
    ds_read_b128 v[52:55], v106 offset:3072
    s_waitcnt lgkmcnt(6)
    v_mfma_f32_32x32x16_bf16 v[224:239], v[76:79], v[80:83], v[224:239]
    v_mfma_f32_32x32x16_bf16 v[240:255], v[76:79], v[84:87], v[240:255]
    s_waitcnt lgkmcnt(4)
    v_mfma_f32_32x32x16_bf16 v[128:143], v[40:43], v[56:59], v[128:143]
    ds_read_b128 v[64:67], v105 offset:0
    ds_read_b128 v[80:83], v109
    s_waitcnt lgkmcnt(5)
    v_mfma_f32_32x32x16_bf16 v[160:175], v[44:47], v[56:59], v[160:175]
    ds_read_b128 v[68:71], v107 offset:1024
    ds_read_b128 v[84:87], v109 offset:8192
    s_waitcnt lgkmcnt(6)
    v_mfma_f32_32x32x16_bf16 v[144:159], v[40:43], v[60:63], v[144:159]
    ds_read_b128 v[72:75], v105 offset:2048
    v_mfma_f32_32x32x16_bf16 v[176:191], v[44:47], v[60:63], v[176:191]
    ds_read_b128 v[76:79], v107 offset:3072
    s_waitcnt lgkmcnt(7)
    v_mfma_f32_32x32x16_bf16 v[192:207], v[48:51], v[56:59], v[192:207]
    v_mfma_f32_32x32x16_bf16 v[208:223], v[48:51], v[60:63], v[208:223]
    s_waitcnt lgkmcnt(6)
    v_mfma_f32_32x32x16_bf16 v[224:239], v[52:55], v[56:59], v[224:239]
    v_mfma_f32_32x32x16_bf16 v[240:255], v[52:55], v[60:63], v[240:255]
    s_waitcnt lgkmcnt(4)
    v_mfma_f32_32x32x16_bf16 v[128:143], v[64:67], v[80:83], v[128:143]
    ds_read_b128 v[40:43], v106 offset:0
    ds_read_b128 v[56:59], v110
    s_waitcnt lgkmcnt(5)
    v_mfma_f32_32x32x16_bf16 v[160:175], v[68:71], v[80:83], v[160:175]
    ds_read_b128 v[44:47], v104 offset:1024
    ds_read_b128 v[60:63], v110 offset:8192
    s_waitcnt lgkmcnt(6)
    v_mfma_f32_32x32x16_bf16 v[144:159], v[64:67], v[84:87], v[144:159]
    ds_read_b128 v[48:51], v106 offset:2048
    v_mfma_f32_32x32x16_bf16 v[176:191], v[68:71], v[84:87], v[176:191]
    ds_read_b128 v[52:55], v104 offset:3072
    s_waitcnt lgkmcnt(7)
    v_mfma_f32_32x32x16_bf16 v[192:207], v[72:75], v[80:83], v[192:207]
    v_mfma_f32_32x32x16_bf16 v[208:223], v[72:75], v[84:87], v[208:223]
    s_waitcnt lgkmcnt(6)
    v_mfma_f32_32x32x16_bf16 v[224:239], v[76:79], v[80:83], v[224:239]
    v_mfma_f32_32x32x16_bf16 v[240:255], v[76:79], v[84:87], v[240:255]
    s_waitcnt lgkmcnt(4)
    v_mfma_f32_32x32x16_bf16 v[128:143], v[40:43], v[56:59], v[128:143]
    ds_read_b128 v[64:67], v107 offset:0
    ds_read_b128 v[80:83], v111
    s_waitcnt lgkmcnt(5)
    v_mfma_f32_32x32x16_bf16 v[160:175], v[44:47], v[56:59], v[160:175]
    ds_read_b128 v[68:71], v105 offset:1024
    ds_read_b128 v[84:87], v111 offset:8192
    s_waitcnt lgkmcnt(6)
    v_mfma_f32_32x32x16_bf16 v[144:159], v[40:43], v[60:63], v[144:159]
    ds_read_b128 v[72:75], v107 offset:2048
    v_mfma_f32_32x32x16_bf16 v[176:191], v[44:47], v[60:63], v[176:191]
    ds_read_b128 v[76:79], v105 offset:3072
    s_waitcnt lgkmcnt(7)
    v_mfma_f32_32x32x16_bf16 v[192:207], v[48:51], v[56:59], v[192:207]
    v_mfma_f32_32x32x16_bf16 v[208:223], v[48:51], v[60:63], v[208:223]
    s_waitcnt lgkmcnt(6)
    v_mfma_f32_32x32x16_bf16 v[224:239], v[52:55], v[56:59], v[224:239]
    v_mfma_f32_32x32x16_bf16 v[240:255], v[52:55], v[60:63], v[240:255]
    s_waitcnt lgkmcnt(4)
    v_mfma_f32_32x32x16_bf16 v[128:143], v[64:67], v[80:83], v[128:143]
    s_waitcnt lgkmcnt(3)
    v_mfma_f32_32x32x16_bf16 v[160:175], v[68:71], v[80:83], v[160:175]
    s_barrier
    s_waitcnt lgkmcnt(2)
    v_mfma_f32_32x32x16_bf16 v[144:159], v[64:67], v[84:87], v[144:159]
    ds_read_b128 v[40:43], v88 offset:0
    ds_read_b128 v[56:59], v92
    v_mfma_f32_32x32x16_bf16 v[176:191], v[68:71], v[84:87], v[176:191]
    ds_read_b128 v[44:47], v90 offset:1024
    ds_read_b128 v[60:63], v92 offset:8192
    s_waitcnt lgkmcnt(5)
    v_mfma_f32_32x32x16_bf16 v[192:207], v[72:75], v[80:83], v[192:207]
    ds_read_b128 v[48:51], v88 offset:2048
    v_mfma_f32_32x32x16_bf16 v[208:223], v[72:75], v[84:87], v[208:223]
    ds_read_b128 v[52:55], v90 offset:3072
    s_waitcnt lgkmcnt(6)
    v_mfma_f32_32x32x16_bf16 v[224:239], v[76:79], v[80:83], v[224:239]
    v_mfma_f32_32x32x16_bf16 v[240:255], v[76:79], v[84:87], v[240:255]
    s_waitcnt lgkmcnt(4)
    v_mfma_f32_32x32x16_bf16 v[128:143], v[40:43], v[56:59], v[128:143]
    ds_read_b128 v[64:67], v89 offset:0
    ds_read_b128 v[80:83], v93
    s_waitcnt lgkmcnt(5)
    v_mfma_f32_32x32x16_bf16 v[160:175], v[44:47], v[56:59], v[160:175]
    ds_read_b128 v[68:71], v91 offset:1024
    ds_read_b128 v[84:87], v93 offset:8192
    s_waitcnt lgkmcnt(6)
    v_mfma_f32_32x32x16_bf16 v[144:159], v[40:43], v[60:63], v[144:159]
    ds_read_b128 v[72:75], v89 offset:2048
    v_mfma_f32_32x32x16_bf16 v[176:191], v[44:47], v[60:63], v[176:191]
    ds_read_b128 v[76:79], v91 offset:3072
    s_waitcnt lgkmcnt(7)
    v_mfma_f32_32x32x16_bf16 v[192:207], v[48:51], v[56:59], v[192:207]
    v_mfma_f32_32x32x16_bf16 v[208:223], v[48:51], v[60:63], v[208:223]
    s_waitcnt lgkmcnt(6)
    v_mfma_f32_32x32x16_bf16 v[224:239], v[52:55], v[56:59], v[224:239]
    v_mfma_f32_32x32x16_bf16 v[240:255], v[52:55], v[60:63], v[240:255]
    s_waitcnt lgkmcnt(4)
    v_mfma_f32_32x32x16_bf16 v[128:143], v[64:67], v[80:83], v[128:143]
    ds_read_b128 v[40:43], v90 offset:0
    ds_read_b128 v[56:59], v94
    s_waitcnt lgkmcnt(5)
    v_mfma_f32_32x32x16_bf16 v[160:175], v[68:71], v[80:83], v[160:175]
    ds_read_b128 v[44:47], v88 offset:1024
    ds_read_b128 v[60:63], v94 offset:8192
    s_waitcnt lgkmcnt(6)
    v_mfma_f32_32x32x16_bf16 v[144:159], v[64:67], v[84:87], v[144:159]
    ds_read_b128 v[48:51], v90 offset:2048
    v_mfma_f32_32x32x16_bf16 v[176:191], v[68:71], v[84:87], v[176:191]
    ds_read_b128 v[52:55], v88 offset:3072
    s_waitcnt lgkmcnt(7)
    v_mfma_f32_32x32x16_bf16 v[192:207], v[72:75], v[80:83], v[192:207]
    v_mfma_f32_32x32x16_bf16 v[208:223], v[72:75], v[84:87], v[208:223]
    s_waitcnt lgkmcnt(6)
    v_mfma_f32_32x32x16_bf16 v[224:239], v[76:79], v[80:83], v[224:239]
    v_mfma_f32_32x32x16_bf16 v[240:255], v[76:79], v[84:87], v[240:255]
    s_waitcnt lgkmcnt(4)
    v_mfma_f32_32x32x16_bf16 v[128:143], v[40:43], v[56:59], v[128:143]
    ds_read_b128 v[64:67], v91 offset:0
    ds_read_b128 v[80:83], v95
    s_waitcnt lgkmcnt(5)
    v_mfma_f32_32x32x16_bf16 v[160:175], v[44:47], v[56:59], v[160:175]
    ds_read_b128 v[68:71], v89 offset:1024
    ds_read_b128 v[84:87], v95 offset:8192
    s_waitcnt lgkmcnt(6)
    v_mfma_f32_32x32x16_bf16 v[144:159], v[40:43], v[60:63], v[144:159]
    ds_read_b128 v[72:75], v91 offset:2048
    v_mfma_f32_32x32x16_bf16 v[176:191], v[44:47], v[60:63], v[176:191]
    ds_read_b128 v[76:79], v89 offset:3072
    s_waitcnt lgkmcnt(7)
    v_mfma_f32_32x32x16_bf16 v[192:207], v[48:51], v[56:59], v[192:207]
    v_mfma_f32_32x32x16_bf16 v[208:223], v[48:51], v[60:63], v[208:223]
    s_waitcnt lgkmcnt(6)
    v_mfma_f32_32x32x16_bf16 v[224:239], v[52:55], v[56:59], v[224:239]
    v_mfma_f32_32x32x16_bf16 v[240:255], v[52:55], v[60:63], v[240:255]
    s_waitcnt lgkmcnt(4)
    v_mfma_f32_32x32x16_bf16 v[128:143], v[64:67], v[80:83], v[128:143]
    s_waitcnt lgkmcnt(3)
    v_mfma_f32_32x32x16_bf16 v[160:175], v[68:71], v[80:83], v[160:175]
    s_waitcnt lgkmcnt(2)
    v_mfma_f32_32x32x16_bf16 v[144:159], v[64:67], v[84:87], v[144:159]
    v_mfma_f32_32x32x16_bf16 v[176:191], v[68:71], v[84:87], v[176:191]
    s_waitcnt lgkmcnt(1)
    v_mfma_f32_32x32x16_bf16 v[192:207], v[72:75], v[80:83], v[192:207]
    v_mfma_f32_32x32x16_bf16 v[208:223], v[72:75], v[84:87], v[208:223]
    s_waitcnt lgkmcnt(0)
    v_mfma_f32_32x32x16_bf16 v[224:239], v[76:79], v[80:83], v[224:239]
    v_mfma_f32_32x32x16_bf16 v[240:255], v[76:79], v[84:87], v[240:255]
    s_barrier
    s_nop 9
    v_pk_fma_f32 v[16:17], v[4:5], v[128:129], v[130:131] op_sel:[0,0,0] op_sel_hi:[0,1,1]
    s_mov_b32 s40, 0x000fffff
    v_pk_fma_f32 v[18:19], v[4:5], v[144:145], v[146:147] op_sel:[0,0,0] op_sel_hi:[0,1,1]
    s_mov_b32 s41, 0x000fffff
    v_pk_fma_f32 v[16:17], v[4:5], v[144:145], v[16:17] op_sel:[1,0,0] op_sel_hi:[1,1,1] neg_lo:[1,0,0] neg_hi:[1,0,0]
    v_bfe_u32 v8, v2, 4, 1
    v_pk_fma_f32 v[18:19], v[4:5], v[128:129], v[18:19] op_sel:[1,0,0] op_sel_hi:[1,1,1]
    v_mul_u32_u24 v8, 640, v8
    v_pk_fma_f32 v[20:21], v[4:5], v[16:17], v[132:133] op_sel:[0,0,0] op_sel_hi:[0,1,1]
    v_bfe_u32 v9, v2, 2, 2
    v_pk_fma_f32 v[22:23], v[4:5], v[18:19], v[148:149] op_sel:[0,0,0] op_sel_hi:[0,1,1]
    v_lshl_add_u32 v8, v9, 5, v8
    v_pk_fma_f32 v[20:21], v[4:5], v[18:19], v[20:21] op_sel:[1,0,0] op_sel_hi:[1,1,1] neg_lo:[1,0,0] neg_hi:[1,0,0]
    v_and_b32 v9, 1, v2
    v_pk_fma_f32 v[22:23], v[4:5], v[16:17], v[22:23] op_sel:[1,0,0] op_sel_hi:[1,1,1]
    v_lshl_add_u32 v8, v9, 4, v8
    v_pk_fma_f32 v[16:17], v[4:5], v[20:21], v[134:135] op_sel:[0,0,0] op_sel_hi:[0,1,1]
    v_bfe_u32 v9, v2, 1, 1
    v_pk_fma_f32 v[18:19], v[4:5], v[22:23], v[150:151] op_sel:[0,0,0] op_sel_hi:[0,1,1]
    v_lshl_add_u32 v8, v9, 3, v8
    v_pk_fma_f32 v[16:17], v[4:5], v[22:23], v[16:17] op_sel:[1,0,0] op_sel_hi:[1,1,1] neg_lo:[1,0,0] neg_hi:[1,0,0]
    v_add_u32 v121, 512, v8
    v_pk_fma_f32 v[18:19], v[4:5], v[20:21], v[18:19] op_sel:[1,0,0] op_sel_hi:[1,1,1]
    v_lshrrev_b32 v9, 5, v2
    v_pk_fma_f32 v[20:21], v[4:5], v[16:17], v[136:137] op_sel:[0,0,0] op_sel_hi:[0,1,1]
    v_mul_u32_u24 v10, 1280, v9
    v_pk_fma_f32 v[22:23], v[4:5], v[18:19], v[152:153] op_sel:[0,0,0] op_sel_hi:[0,1,1]
    v_add_u32 v105, v10, v121
    v_pk_fma_f32 v[20:21], v[4:5], v[18:19], v[20:21] op_sel:[1,0,0] op_sel_hi:[1,1,1] neg_lo:[1,0,0] neg_hi:[1,0,0]
    v_lshl_add_u32 v104, v9, 8, v8
    v_pk_fma_f32 v[22:23], v[4:5], v[16:17], v[22:23] op_sel:[1,0,0] op_sel_hi:[1,1,1]
    v_and_b32 v10, 31, v2
    v_pk_fma_f32 v[16:17], v[4:5], v[20:21], v[138:139] op_sel:[0,0,0] op_sel_hi:[0,1,1]
    v_lshlrev_b32 v11, 4, v9
    v_pk_fma_f32 v[18:19], v[4:5], v[22:23], v[154:155] op_sel:[0,0,0] op_sel_hi:[0,1,1]
    v_lshl_add_u32 v11, v10, 5, v11
    v_pk_fma_f32 v[16:17], v[4:5], v[22:23], v[16:17] op_sel:[1,0,0] op_sel_hi:[1,1,1] neg_lo:[1,0,0] neg_hi:[1,0,0]
    v_add_u32 v106, 10240, v11
    v_pk_fma_f32 v[18:19], v[4:5], v[20:21], v[18:19] op_sel:[1,0,0] op_sel_hi:[1,1,1]
    s_mul_i32 s30, s39, 81920
    v_pk_fma_f32 v[20:21], v[4:5], v[16:17], v[140:141] op_sel:[0,0,0] op_sel_hi:[0,1,1]
    s_lshl_b32 s31, s42, 3
    v_pk_fma_f32 v[22:23], v[4:5], v[18:19], v[156:157] op_sel:[0,0,0] op_sel_hi:[0,1,1]
    s_add_u32 s31, s31, s29
    v_pk_fma_f32 v[20:21], v[4:5], v[18:19], v[20:21] op_sel:[1,0,0] op_sel_hi:[1,1,1] neg_lo:[1,0,0] neg_hi:[1,0,0]
    s_mul_i32 s31, s31, 1280
    v_pk_fma_f32 v[22:23], v[4:5], v[16:17], v[22:23] op_sel:[1,0,0] op_sel_hi:[1,1,1]
    s_add_u32 s30, s30, s31
    v_pk_fma_f32 v[16:17], v[4:5], v[20:21], v[142:143] op_sel:[0,0,0] op_sel_hi:[0,1,1]
    v_lshlrev_b32 v11, 3, v9
    v_pk_fma_f32 v[18:19], v[4:5], v[22:23], v[158:159] op_sel:[0,0,0] op_sel_hi:[0,1,1]
    v_lshl_add_u32 v11, v10, 4, v11
    v_pk_fma_f32 v[16:17], v[4:5], v[22:23], v[16:17] op_sel:[1,0,0] op_sel_hi:[1,1,1] neg_lo:[1,0,0] neg_hi:[1,0,0]
    v_add_u32 v114, s30, v11
    v_pk_fma_f32 v[18:19], v[4:5], v[20:21], v[18:19] op_sel:[1,0,0] op_sel_hi:[1,1,1]
    v_lshlrev_b32 v11, 3, v10
    v_pk_fma_f32 v[20:21], v[4:5], v[16:17], v[160:161] op_sel:[0,0,0] op_sel_hi:[0,1,1]
    v_add_u32 v11, s30, v11
    v_pk_fma_f32 v[22:23], v[4:5], v[18:19], v[176:177] op_sel:[0,0,0] op_sel_hi:[0,1,1]
    v_mov_b32 v8, 0x7f000000
    v_pk_fma_f32 v[20:21], v[4:5], v[18:19], v[20:21] op_sel:[1,0,0] op_sel_hi:[1,1,1] neg_lo:[1,0,0] neg_hi:[1,0,0]
    v_cmp_gt_u32 vcc, 32, v2
    v_pk_fma_f32 v[22:23], v[4:5], v[16:17], v[22:23] op_sel:[1,0,0] op_sel_hi:[1,1,1]
    s_mul_i32 s30, s29, 1280
    v_pk_fma_f32 v[16:17], v[4:5], v[20:21], v[162:163] op_sel:[0,0,0] op_sel_hi:[0,1,1]
    s_add_u32 s30, s30, 147456
    v_pk_fma_f32 v[18:19], v[4:5], v[22:23], v[178:179] op_sel:[0,0,0] op_sel_hi:[0,1,1]
    v_cndmask_b32 v115, v8, v11, vcc
    v_pk_fma_f32 v[16:17], v[4:5], v[22:23], v[16:17] op_sel:[1,0,0] op_sel_hi:[1,1,1] neg_lo:[1,0,0] neg_hi:[1,0,0]
    v_add_u32 v120, s30, v104
    v_pk_fma_f32 v[18:19], v[4:5], v[20:21], v[18:19] op_sel:[1,0,0] op_sel_hi:[1,1,1]
    v_add_u32 v121, s30, v121
    v_pk_fma_f32 v[20:21], v[4:5], v[16:17], v[164:165] op_sel:[0,0,0] op_sel_hi:[0,1,1]
    v_and_b32 v116, 27, v2
    v_pk_fma_f32 v[22:23], v[4:5], v[18:19], v[180:181] op_sel:[0,0,0] op_sel_hi:[0,1,1]
    v_cmp_eq_u32 vcc, 24, v116
    v_pk_fma_f32 v[20:21], v[4:5], v[18:19], v[20:21] op_sel:[1,0,0] op_sel_hi:[1,1,1] neg_lo:[1,0,0] neg_hi:[1,0,0]
    v_mov_b32 v116, 0x3f803f80
    v_pk_fma_f32 v[22:23], v[4:5], v[16:17], v[22:23] op_sel:[1,0,0] op_sel_hi:[1,1,1]
    v_mov_b32 v40, 0
    v_pk_fma_f32 v[16:17], v[4:5], v[20:21], v[166:167] op_sel:[0,0,0] op_sel_hi:[0,1,1]
    v_mov_b32 v41, 0
    v_pk_fma_f32 v[18:19], v[4:5], v[22:23], v[182:183] op_sel:[0,0,0] op_sel_hi:[0,1,1]
    v_mov_b32 v42, 0
    v_pk_fma_f32 v[16:17], v[4:5], v[22:23], v[16:17] op_sel:[1,0,0] op_sel_hi:[1,1,1] neg_lo:[1,0,0] neg_hi:[1,0,0]
    v_mov_b32 v43, 0
    v_pk_fma_f32 v[18:19], v[4:5], v[20:21], v[18:19] op_sel:[1,0,0] op_sel_hi:[1,1,1]
    v_mov_b32 v44, 0
    v_pk_fma_f32 v[20:21], v[4:5], v[16:17], v[168:169] op_sel:[0,0,0] op_sel_hi:[0,1,1]
    v_mov_b32 v45, 0
    v_pk_fma_f32 v[22:23], v[4:5], v[18:19], v[184:185] op_sel:[0,0,0] op_sel_hi:[0,1,1]
    v_mov_b32 v46, 0
    v_pk_fma_f32 v[20:21], v[4:5], v[18:19], v[20:21] op_sel:[1,0,0] op_sel_hi:[1,1,1] neg_lo:[1,0,0] neg_hi:[1,0,0]
    v_mov_b32 v47, 0
    v_pk_fma_f32 v[22:23], v[4:5], v[16:17], v[22:23] op_sel:[1,0,0] op_sel_hi:[1,1,1]
    v_cndmask_b32 v92, 0, v116, vcc
    v_pk_fma_f32 v[16:17], v[4:5], v[20:21], v[170:171] op_sel:[0,0,0] op_sel_hi:[0,1,1]
    v_cndmask_b32 v93, 0, v116, vcc
    v_pk_fma_f32 v[18:19], v[4:5], v[22:23], v[186:187] op_sel:[0,0,0] op_sel_hi:[0,1,1]
    v_cndmask_b32 v94, 0, v116, vcc
    v_pk_fma_f32 v[16:17], v[4:5], v[22:23], v[16:17] op_sel:[1,0,0] op_sel_hi:[1,1,1] neg_lo:[1,0,0] neg_hi:[1,0,0]
    v_cndmask_b32 v95, 0, v116, vcc
    v_pk_fma_f32 v[18:19], v[4:5], v[20:21], v[18:19] op_sel:[1,0,0] op_sel_hi:[1,1,1]
    v_cndmask_b32 v108, 0, v116, vcc
    v_pk_fma_f32 v[20:21], v[4:5], v[16:17], v[172:173] op_sel:[0,0,0] op_sel_hi:[0,1,1]
    v_cndmask_b32 v109, 0, v116, vcc
    v_pk_fma_f32 v[22:23], v[4:5], v[18:19], v[188:189] op_sel:[0,0,0] op_sel_hi:[0,1,1]
    v_cndmask_b32 v110, 0, v116, vcc
    v_pk_fma_f32 v[20:21], v[4:5], v[18:19], v[20:21] op_sel:[1,0,0] op_sel_hi:[1,1,1] neg_lo:[1,0,0] neg_hi:[1,0,0]
    v_cndmask_b32 v111, 0, v116, vcc
    v_pk_fma_f32 v[22:23], v[4:5], v[16:17], v[22:23] op_sel:[1,0,0] op_sel_hi:[1,1,1]
    v_cndmask_b32 v96, 0, v116, vcc
    v_pk_fma_f32 v[16:17], v[4:5], v[20:21], v[174:175] op_sel:[0,0,0] op_sel_hi:[0,1,1]
    v_cndmask_b32 v97, 0, v116, vcc
    v_pk_fma_f32 v[18:19], v[4:5], v[22:23], v[190:191] op_sel:[0,0,0] op_sel_hi:[0,1,1]
    v_cndmask_b32 v98, 0, v116, vcc
    v_pk_fma_f32 v[16:17], v[4:5], v[22:23], v[16:17] op_sel:[1,0,0] op_sel_hi:[1,1,1] neg_lo:[1,0,0] neg_hi:[1,0,0]
    v_cndmask_b32 v99, 0, v116, vcc
    v_pk_fma_f32 v[18:19], v[4:5], v[20:21], v[18:19] op_sel:[1,0,0] op_sel_hi:[1,1,1]
    v_cndmask_b32 v12, 0, v116, vcc
    v_pk_fma_f32 v[20:21], v[4:5], v[16:17], v[192:193] op_sel:[0,0,0] op_sel_hi:[0,1,1]
    v_cndmask_b32 v13, 0, v116, vcc
    v_pk_fma_f32 v[22:23], v[4:5], v[18:19], v[208:209] op_sel:[0,0,0] op_sel_hi:[0,1,1]
    v_cndmask_b32 v14, 0, v116, vcc
    v_pk_fma_f32 v[20:21], v[4:5], v[18:19], v[20:21] op_sel:[1,0,0] op_sel_hi:[1,1,1] neg_lo:[1,0,0] neg_hi:[1,0,0]
    v_cndmask_b32 v15, 0, v116, vcc
    v_pk_fma_f32 v[22:23], v[4:5], v[16:17], v[22:23] op_sel:[1,0,0] op_sel_hi:[1,1,1]
    v_cndmask_b32 v100, 0, v116, vcc
    v_pk_fma_f32 v[16:17], v[4:5], v[20:21], v[194:195] op_sel:[0,0,0] op_sel_hi:[0,1,1]
    v_cndmask_b32 v101, 0, v116, vcc
    v_pk_fma_f32 v[18:19], v[4:5], v[22:23], v[210:211] op_sel:[0,0,0] op_sel_hi:[0,1,1]
    v_cndmask_b32 v102, 0, v116, vcc
    v_pk_fma_f32 v[16:17], v[4:5], v[22:23], v[16:17] op_sel:[1,0,0] op_sel_hi:[1,1,1] neg_lo:[1,0,0] neg_hi:[1,0,0]
    v_cndmask_b32 v103, 0, v116, vcc
    v_pk_fma_f32 v[18:19], v[4:5], v[20:21], v[18:19] op_sel:[1,0,0] op_sel_hi:[1,1,1]
    v_mov_b32 v48, 0
    v_pk_fma_f32 v[20:21], v[4:5], v[16:17], v[196:197] op_sel:[0,0,0] op_sel_hi:[0,1,1]
    v_mov_b32 v49, 0
    v_pk_fma_f32 v[22:23], v[4:5], v[18:19], v[212:213] op_sel:[0,0,0] op_sel_hi:[0,1,1]
    v_mov_b32 v50, 0
    v_pk_fma_f32 v[20:21], v[4:5], v[18:19], v[20:21] op_sel:[1,0,0] op_sel_hi:[1,1,1] neg_lo:[1,0,0] neg_hi:[1,0,0]
    v_mov_b32 v51, 0
    v_pk_fma_f32 v[22:23], v[4:5], v[16:17], v[22:23] op_sel:[1,0,0] op_sel_hi:[1,1,1]
    v_mov_b32 v52, 0
    v_pk_fma_f32 v[16:17], v[4:5], v[20:21], v[198:199] op_sel:[0,0,0] op_sel_hi:[0,1,1]
    v_mov_b32 v53, 0
    v_pk_fma_f32 v[18:19], v[4:5], v[22:23], v[214:215] op_sel:[0,0,0] op_sel_hi:[0,1,1]
    v_mov_b32 v54, 0
    v_pk_fma_f32 v[16:17], v[4:5], v[22:23], v[16:17] op_sel:[1,0,0] op_sel_hi:[1,1,1] neg_lo:[1,0,0] neg_hi:[1,0,0]
    v_mov_b32 v55, 0
    v_pk_fma_f32 v[18:19], v[4:5], v[20:21], v[18:19] op_sel:[1,0,0] op_sel_hi:[1,1,1]
    v_mov_b32 v56, 0
    v_pk_fma_f32 v[20:21], v[4:5], v[16:17], v[200:201] op_sel:[0,0,0] op_sel_hi:[0,1,1]
    v_mov_b32 v57, 0
    v_pk_fma_f32 v[22:23], v[4:5], v[18:19], v[216:217] op_sel:[0,0,0] op_sel_hi:[0,1,1]
    v_mov_b32 v58, 0
    v_pk_fma_f32 v[20:21], v[4:5], v[18:19], v[20:21] op_sel:[1,0,0] op_sel_hi:[1,1,1] neg_lo:[1,0,0] neg_hi:[1,0,0]
    v_mov_b32 v59, 0
    v_pk_fma_f32 v[22:23], v[4:5], v[16:17], v[22:23] op_sel:[1,0,0] op_sel_hi:[1,1,1]
    v_mov_b32 v60, 0
    v_pk_fma_f32 v[16:17], v[4:5], v[20:21], v[202:203] op_sel:[0,0,0] op_sel_hi:[0,1,1]
    v_mov_b32 v61, 0
    v_pk_fma_f32 v[18:19], v[4:5], v[22:23], v[218:219] op_sel:[0,0,0] op_sel_hi:[0,1,1]
    v_mov_b32 v62, 0
    v_pk_fma_f32 v[16:17], v[4:5], v[22:23], v[16:17] op_sel:[1,0,0] op_sel_hi:[1,1,1] neg_lo:[1,0,0] neg_hi:[1,0,0]
    v_mov_b32 v63, 0
    v_pk_fma_f32 v[18:19], v[4:5], v[20:21], v[18:19] op_sel:[1,0,0] op_sel_hi:[1,1,1]
    s_mov_b32 s43, 0
    v_pk_fma_f32 v[20:21], v[4:5], v[16:17], v[204:205] op_sel:[0,0,0] op_sel_hi:[0,1,1]
    s_mov_b32 s12, 10
    v_pk_fma_f32 v[22:23], v[4:5], v[18:19], v[220:221] op_sel:[0,0,0] op_sel_hi:[0,1,1]
    s_cmp_lt_u32 s29, 2
    v_pk_fma_f32 v[20:21], v[4:5], v[18:19], v[20:21] op_sel:[1,0,0] op_sel_hi:[1,1,1] neg_lo:[1,0,0] neg_hi:[1,0,0]
    s_cselect_b32 s13, 5, 1
    v_pk_fma_f32 v[22:23], v[4:5], v[16:17], v[22:23] op_sel:[1,0,0] op_sel_hi:[1,1,1]
    s_cmp_ge_u32 s29, 4
    v_pk_fma_f32 v[16:17], v[4:5], v[20:21], v[206:207] op_sel:[0,0,0] op_sel_hi:[0,1,1]
    s_cselect_b32 s13, 5, s13
    v_pk_fma_f32 v[18:19], v[4:5], v[22:23], v[222:223] op_sel:[0,0,0] op_sel_hi:[0,1,1]
    s_cselect_b32 s14, 0, 2
    v_pk_fma_f32 v[16:17], v[4:5], v[22:23], v[16:17] op_sel:[1,0,0] op_sel_hi:[1,1,1] neg_lo:[1,0,0] neg_hi:[1,0,0]
    s_cselect_b32 s15, 1, 0
    v_pk_fma_f32 v[18:19], v[4:5], v[20:21], v[18:19] op_sel:[1,0,0] op_sel_hi:[1,1,1]
    s_cmp_eq_u32 s36, 1
    v_pk_fma_f32 v[20:21], v[4:5], v[16:17], v[224:225] op_sel:[0,0,0] op_sel_hi:[0,1,1]
    s_cselect_b32 s14, s14, 0
    v_pk_fma_f32 v[22:23], v[4:5], v[18:19], v[240:241] op_sel:[0,0,0] op_sel_hi:[0,1,1]
    s_or_b32 s14, s14, s15
    v_pk_fma_f32 v[20:21], v[4:5], v[18:19], v[20:21] op_sel:[1,0,0] op_sel_hi:[1,1,1] neg_lo:[1,0,0] neg_hi:[1,0,0]
    s_cmp_eq_u32 s29, 4
    v_pk_fma_f32 v[22:23], v[4:5], v[16:17], v[22:23] op_sel:[1,0,0] op_sel_hi:[1,1,1]
    s_cselect_b32 s15, 4, 0
    v_pk_fma_f32 v[16:17], v[4:5], v[20:21], v[226:227] op_sel:[0,0,0] op_sel_hi:[0,1,1]
    s_or_b32 s14, s14, s15
    v_pk_fma_f32 v[18:19], v[4:5], v[22:23], v[242:243] op_sel:[0,0,0] op_sel_hi:[0,1,1]
    s_cmp_eq_u32 s36, 2
    v_pk_fma_f32 v[16:17], v[4:5], v[22:23], v[16:17] op_sel:[1,0,0] op_sel_hi:[1,1,1] neg_lo:[1,0,0] neg_hi:[1,0,0]
    s_cselect_b32 s15, 2, 0
    v_pk_fma_f32 v[18:19], v[4:5], v[20:21], v[18:19] op_sel:[1,0,0] op_sel_hi:[1,1,1]
    s_or_b32 s14, s14, s15
    v_pk_fma_f32 v[20:21], v[4:5], v[16:17], v[228:229] op_sel:[0,0,0] op_sel_hi:[0,1,1]
    s_cmp_ge_u32 s29, 4
    v_pk_fma_f32 v[22:23], v[4:5], v[18:19], v[244:245] op_sel:[0,0,0] op_sel_hi:[0,1,1]
    s_cselect_b32 s15, 8, 0
    v_pk_fma_f32 v[20:21], v[4:5], v[18:19], v[20:21] op_sel:[1,0,0] op_sel_hi:[1,1,1] neg_lo:[1,0,0] neg_hi:[1,0,0]
    s_cmp_eq_u32 s36, 0
    v_pk_fma_f32 v[22:23], v[4:5], v[16:17], v[22:23] op_sel:[1,0,0] op_sel_hi:[1,1,1]
    s_cselect_b32 s15, s15, 0
    v_pk_fma_f32 v[16:17], v[4:5], v[20:21], v[230:231] op_sel:[0,0,0] op_sel_hi:[0,1,1]
    s_or_b32 s14, s14, s15
    v_pk_fma_f32 v[18:19], v[4:5], v[22:23], v[246:247] op_sel:[0,0,0] op_sel_hi:[0,1,1]
    v_pk_fma_f32 v[16:17], v[4:5], v[22:23], v[16:17] op_sel:[1,0,0] op_sel_hi:[1,1,1] neg_lo:[1,0,0] neg_hi:[1,0,0]
    v_pk_fma_f32 v[18:19], v[4:5], v[20:21], v[18:19] op_sel:[1,0,0] op_sel_hi:[1,1,1]
    v_pk_fma_f32 v[20:21], v[4:5], v[16:17], v[232:233] op_sel:[0,0,0] op_sel_hi:[0,1,1]
    v_pk_fma_f32 v[22:23], v[4:5], v[18:19], v[248:249] op_sel:[0,0,0] op_sel_hi:[0,1,1]
    v_pk_fma_f32 v[20:21], v[4:5], v[18:19], v[20:21] op_sel:[1,0,0] op_sel_hi:[1,1,1] neg_lo:[1,0,0] neg_hi:[1,0,0]
    v_pk_fma_f32 v[22:23], v[4:5], v[16:17], v[22:23] op_sel:[1,0,0] op_sel_hi:[1,1,1]
    v_pk_fma_f32 v[16:17], v[4:5], v[20:21], v[234:235] op_sel:[0,0,0] op_sel_hi:[0,1,1]
    v_pk_fma_f32 v[18:19], v[4:5], v[22:23], v[250:251] op_sel:[0,0,0] op_sel_hi:[0,1,1]
    v_pk_fma_f32 v[16:17], v[4:5], v[22:23], v[16:17] op_sel:[1,0,0] op_sel_hi:[1,1,1] neg_lo:[1,0,0] neg_hi:[1,0,0]
    v_pk_fma_f32 v[18:19], v[4:5], v[20:21], v[18:19] op_sel:[1,0,0] op_sel_hi:[1,1,1]
    v_pk_fma_f32 v[20:21], v[4:5], v[16:17], v[236:237] op_sel:[0,0,0] op_sel_hi:[0,1,1]
    v_pk_fma_f32 v[22:23], v[4:5], v[18:19], v[252:253] op_sel:[0,0,0] op_sel_hi:[0,1,1]
    v_pk_fma_f32 v[20:21], v[4:5], v[18:19], v[20:21] op_sel:[1,0,0] op_sel_hi:[1,1,1] neg_lo:[1,0,0] neg_hi:[1,0,0]
    v_pk_fma_f32 v[22:23], v[4:5], v[16:17], v[22:23] op_sel:[1,0,0] op_sel_hi:[1,1,1]
    v_pk_fma_f32 v[16:17], v[4:5], v[20:21], v[238:239] op_sel:[0,0,0] op_sel_hi:[0,1,1]
    v_pk_fma_f32 v[18:19], v[4:5], v[22:23], v[254:255] op_sel:[0,0,0] op_sel_hi:[0,1,1]
    v_pk_fma_f32 v[16:17], v[4:5], v[22:23], v[16:17] op_sel:[1,0,0] op_sel_hi:[1,1,1] neg_lo:[1,0,0] neg_hi:[1,0,0]
    v_pk_fma_f32 v[18:19], v[4:5], v[20:21], v[18:19] op_sel:[1,0,0] op_sel_hi:[1,1,1]
    ds_write2st64_b32 v7, v16, v17 offset0:0 offset1:1
    ds_write2st64_b32 v7, v18, v19 offset0:8 offset1:9
    s_waitcnt lgkmcnt(0)
    s_barrier
    s_branch L_comp_tail2
L_compA:
    s_or_b32 s30, s2, s29
    s_cmp_lg_u32 s30, 0
    s_cbranch_scc1 L_nononce_23
    v_mul_u32_u24 v3, 4352, v2
    v_add_u32 v8, 278528, v3
    v_mov_b32 v9, 0
    buffer_store_dword v9, v3, s[44:47], 0 offen sc0 sc1
    buffer_store_dword v9, v8, s[44:47], 0 offen sc0 sc1
    s_memrealtime s[30:31]
    s_waitcnt lgkmcnt(0)
    s_or_b32 s30, s30, 1
    v_mov_b32 v3, s30
    s_waitcnt vmcnt(0)
    s_mov_b64 exec, 1
    buffer_store_dword v3, off, s[48:51], 0 sc0 sc1
    s_mov_b64 exec, -1
L_nononce_23:
    v_and_b32 v3, 7, v2
    v_bfe_u32 v8, v2, 3, 1
    v_lshl_add_u32 v3, v8, 4, v3
    v_lshlrev_b32 v8, 2, v8
    v_bfe_u32 v10, v2, 1, 2
    v_xor_b32 v8, v8, v10
    v_lshrrev_b32 v9, 4, v2
    v_xor_b32 v8, v8, v9
    s_lshr_b32 s30, s29, 1
    s_lshl_b32 s30, s30, 13
    v_lshlrev_b32 v3, 7, v3
    v_lshl_add_u32 v3, v8, 4, v3
    v_add_u32 v20, s30, v3
    v_xor_b32 v21, 64, v20
    v_bfe_u32 v3, v2, 2, 2
    v_lshl_add_u32 v8, v9, 3, v3
    v_mul_u32_u24 v8, 384, v8
    v_and_b32 v10, 3, v2
    v_lshl_add_u32 v8, v10, 3, v8
    v_add_u32 v8, 16384, v8
    v_and_b32 v3, 2, v3
    v_and_b32 v10, 1, v9
    v_or_b32 v3, v3, v10
    s_and_b32 s31, s29, 1
    s_lshl_b32 s30, s31, 7
    s_lshl_b32 s31, s31, 1
    v_add_u32 v8, s30, v8
    s_add_u32 s32, s31, 0
    s_and_b32 s33, s32, 3
    s_and_b32 s32, s32, 4
    s_lshl_b32 s32, s32, 5
    v_xor_b32 v10, s33, v3
    v_lshl_add_u32 v10, v10, 5, v8
    v_add_u32 v22, s32, v10
    s_add_u32 s32, s31, 1
    s_and_b32 s33, s32, 3
    s_and_b32 s32, s32, 4
    s_lshl_b32 s32, s32, 5
    v_xor_b32 v10, s33, v3
    v_lshl_add_u32 v10, v10, 5, v8
    v_add_u32 v23, s32, v10
    s_add_u32 s32, s31, 2
    s_and_b32 s33, s32, 3
    s_and_b32 s32, s32, 4
    s_lshl_b32 s32, s32, 5
    v_xor_b32 v10, s33, v3
    v_lshl_add_u32 v10, v10, 5, v8
    v_add_u32 v24, s32, v10
    s_add_u32 s32, s31, 3
    s_and_b32 s33, s32, 3
    s_and_b32 s32, s32, 4
    s_lshl_b32 s32, s32, 5
    v_xor_b32 v10, s33, v3
    v_lshl_add_u32 v10, v10, 5, v8
    v_add_u32 v25, s32, v10
    v_add_u32 v26, 81920, v20
    v_add_u32 v27, 81920, v21
    v_add_u32 v28, 81920, v22
    v_add_u32 v29, 81920, v23
    v_add_u32 v30, 81920, v24
    v_add_u32 v31, 81920, v25
    s_lshr_b32 s32, s29, 1
    s_lshl_b32 s32, s32, 2
    s_lshl_b32 s33, s26, 3
    s_add_u32 s32, s32, s33
    s_mul_i32 s32, s32, 640
    v_lshrrev_b32 v8, 1, v9
    v_mul_u32_u24 v8, 640, v8
    v_and_b32 v9, 1, v9
    v_lshl_add_u32 v9, v9, 4, v8
    v_add_u32 v9, s32, v9
    v_and_b32 v3, 15, v2
    s_mul_i32 s31, s27, 12
    s_and_b32 s30, s29, 1
    s_mul_i32 s30, s30, 6
    s_add_u32 s31, s31, s30
    s_mov_b32 s33, 81920
    s_add_u32 s30, s31, 0
    s_mul_i32 s32, s30, 205
    s_lshr_b32 s32, s32, 13
    s_mov_b32 s52, s32
    s_mul_i32 s43, s32, 40
    s_sub_u32 s30, s30, s43
    s_lshl_b32 s30, s30, 4
    s_mul_i32 s32, s32, 2621440
    v_add_u32 v11, s30, v3
    v_mul_u32_u24 v8, 3277, v11
    v_lshrrev_b32 v8, 16, v8
    v_mul_u32_u24 v10, 20, v8
    v_sub_u32 v10, v11, v10
    v_mul_lo_u32 v8, v8, s33
    v_lshl_add_u32 v10, v10, 5, v9
    v_add3_u32 v224, v8, v10, s32
    s_add_u32 s30, s31, 1
    s_mul_i32 s32, s30, 205
    s_lshr_b32 s32, s32, 13
    s_mov_b32 s53, s32
    s_mul_i32 s43, s32, 40
    s_sub_u32 s30, s30, s43
    s_lshl_b32 s30, s30, 4
    s_mul_i32 s32, s32, 2621440
    v_add_u32 v11, s30, v3
    v_mul_u32_u24 v8, 3277, v11
    v_lshrrev_b32 v8, 16, v8
    v_mul_u32_u24 v10, 20, v8
    v_sub_u32 v10, v11, v10
    v_mul_lo_u32 v8, v8, s33
    v_lshl_add_u32 v10, v10, 5, v9
    v_add3_u32 v225, v8, v10, s32
    s_add_u32 s30, s31, 2
    s_mul_i32 s32, s30, 205
    s_lshr_b32 s32, s32, 13
    s_mov_b32 s54, s32
    s_mul_i32 s43, s32, 40
    s_sub_u32 s30, s30, s43
    s_lshl_b32 s30, s30, 4
    s_mul_i32 s32, s32, 2621440
    v_add_u32 v11, s30, v3
    v_mul_u32_u24 v8, 3277, v11
    v_lshrrev_b32 v8, 16, v8
    v_mul_u32_u24 v10, 20, v8
    v_sub_u32 v10, v11, v10
    v_mul_lo_u32 v8, v8, s33
    v_lshl_add_u32 v10, v10, 5, v9
    v_add3_u32 v226, v8, v10, s32
    s_add_u32 s30, s31, 3
    s_mul_i32 s32, s30, 205
    s_lshr_b32 s32, s32, 13
    s_mov_b32 s55, s32
    s_mul_i32 s43, s32, 40
    s_sub_u32 s30, s30, s43
    s_lshl_b32 s30, s30, 4
    s_mul_i32 s32, s32, 2621440
    v_add_u32 v11, s30, v3
    v_mul_u32_u24 v8, 3277, v11
    v_lshrrev_b32 v8, 16, v8
    v_mul_u32_u24 v10, 20, v8
    v_sub_u32 v10, v11, v10
    v_mul_lo_u32 v8, v8, s33
    v_lshl_add_u32 v10, v10, 5, v9
    v_add3_u32 v227, v8, v10, s32
    s_add_u32 s30, s31, 4
    s_mul_i32 s32, s30, 205
    s_lshr_b32 s32, s32, 13
    s_mov_b32 s56, s32
    s_mul_i32 s43, s32, 40
    s_sub_u32 s30, s30, s43
    s_lshl_b32 s30, s30, 4
    s_mul_i32 s32, s32, 2621440
    v_add_u32 v11, s30, v3
    v_mul_u32_u24 v8, 3277, v11
    v_lshrrev_b32 v8, 16, v8
    v_mul_u32_u24 v10, 20, v8
    v_sub_u32 v10, v11, v10
    v_mul_lo_u32 v8, v8, s33
    v_lshl_add_u32 v10, v10, 5, v9
    v_add3_u32 v228, v8, v10, s32
    s_add_u32 s30, s31, 5
    s_mul_i32 s32, s30, 205
    s_lshr_b32 s32, s32, 13
    s_mov_b32 s57, s32
    s_mul_i32 s43, s32, 40
    s_sub_u32 s30, s30, s43
    s_lshl_b32 s30, s30, 4
    s_mul_i32 s32, s32, 2621440
    v_add_u32 v11, s30, v3
    v_mul_u32_u24 v8, 3277, v11
    v_lshrrev_b32 v8, 16, v8
    v_mul_u32_u24 v10, 20, v8
    v_sub_u32 v10, v11, v10
    v_mul_lo_u32 v8, v8, s33
    v_lshl_add_u32 v10, v10, 5, v9
    v_add3_u32 v229, v8, v10, s32
    s_mov_b32 s20, s8
    s_and_b32 s21, s9, 0xffff
    s_mov_b32 s22, 7864320
    s_mov_b32 s23, 0x00020000
    s_mov_b32 s58, 1051011932
    s_mov_b32 s59, 1051011932
    s_barrier
    ds_read_b128 v[40:43], v20 offset:0
    ds_read_b64_tr_b16 v[56:57], v22 offset:0
    ds_read_b64_tr_b16 v[58:59], v22 offset:1536
    ds_read_b128 v[44:47], v21 offset:1024
    ds_read_b128 v[48:51], v20 offset:4096
    ds_read_b128 v[52:55], v21 offset:5120
    ds_read_b64_tr_b16 v[60:61], v23 offset:0
    ds_read_b64_tr_b16 v[62:63], v23 offset:1536
    ds_read_b64_tr_b16 v[64:65], v24 offset:0
    ds_read_b64_tr_b16 v[66:67], v24 offset:1536
    ds_read_b64_tr_b16 v[68:69], v25 offset:0
    ds_read_b64_tr_b16 v[70:71], v25 offset:1536
    ds_read_b64_tr_b16 v[72:73], v22 offset:128
    ds_read_b64_tr_b16 v[74:75], v22 offset:1664
    ds_read_b64_tr_b16 v[76:77], v23 offset:128
    ds_read_b64_tr_b16 v[78:79], v23 offset:1664
    s_waitcnt lgkmcnt(13)
    v_mfma_f32_16x16x32_bf16 v[128:131], v[40:43], v[56:59], 0
    s_waitcnt lgkmcnt(12)
    v_mfma_f32_16x16x32_bf16 v[132:135], v[44:47], v[56:59], 0
    s_waitcnt lgkmcnt(11)
    v_mfma_f32_16x16x32_bf16 v[136:139], v[48:51], v[56:59], 0
    s_waitcnt lgkmcnt(10)
    v_mfma_f32_16x16x32_bf16 v[140:143], v[52:55], v[56:59], 0
    s_waitcnt lgkmcnt(8)
    v_mfma_f32_16x16x32_bf16 v[144:147], v[40:43], v[60:63], 0
    v_mfma_f32_16x16x32_bf16 v[148:151], v[44:47], v[60:63], 0
    ds_read_b128 v[80:83], v21 offset:0
    v_mfma_f32_16x16x32_bf16 v[152:155], v[48:51], v[60:63], 0
    ds_read_b64_tr_b16 v[96:97], v22 offset:12288
    v_mfma_f32_16x16x32_bf16 v[156:159], v[52:55], v[60:63], 0
    ds_read_b64_tr_b16 v[98:99], v22 offset:13824
    s_waitcnt lgkmcnt(9)
    v_mfma_f32_16x16x32_bf16 v[160:163], v[40:43], v[64:67], 0
    ds_read_b128 v[84:87], v20 offset:1024
    v_mfma_f32_16x16x32_bf16 v[164:167], v[44:47], v[64:67], 0
    ds_read_b128 v[88:91], v21 offset:4096
    v_mfma_f32_16x16x32_bf16 v[168:171], v[48:51], v[64:67], 0
    ds_read_b128 v[92:95], v20 offset:5120
    v_mfma_f32_16x16x32_bf16 v[172:175], v[52:55], v[64:67], 0
    ds_read_b64_tr_b16 v[100:101], v23 offset:12288
    s_waitcnt lgkmcnt(11)
    v_mfma_f32_16x16x32_bf16 v[176:179], v[40:43], v[68:71], 0
    ds_read_b64_tr_b16 v[102:103], v23 offset:13824
    v_mfma_f32_16x16x32_bf16 v[180:183], v[44:47], v[68:71], 0
    ds_read_b64_tr_b16 v[104:105], v24 offset:12288
    v_mfma_f32_16x16x32_bf16 v[184:187], v[48:51], v[68:71], 0
    ds_read_b64_tr_b16 v[106:107], v24 offset:13824
    v_mfma_f32_16x16x32_bf16 v[188:191], v[52:55], v[68:71], 0
    ds_read_b64_tr_b16 v[108:109], v25 offset:12288
    s_waitcnt lgkmcnt(13)
    v_mfma_f32_16x16x32_bf16 v[192:195], v[40:43], v[72:75], 0
    ds_read_b64_tr_b16 v[110:111], v25 offset:13824
    v_mfma_f32_16x16x32_bf16 v[196:199], v[44:47], v[72:75], 0
    ds_read_b64_tr_b16 v[112:113], v22 offset:12416
    v_mfma_f32_16x16x32_bf16 v[200:203], v[48:51], v[72:75], 0
    ds_read_b64_tr_b16 v[114:115], v22 offset:13952
    v_mfma_f32_16x16x32_bf16 v[204:207], v[52:55], v[72:75], 0
    ds_read_b64_tr_b16 v[116:117], v23 offset:12416
    s_waitcnt lgkmcnt(15)
    v_mfma_f32_16x16x32_bf16 v[208:211], v[40:43], v[76:79], 0
    ds_read_b64_tr_b16 v[118:119], v23 offset:13952
    v_mfma_f32_16x16x32_bf16 v[212:215], v[44:47], v[76:79], 0
    v_mfma_f32_16x16x32_bf16 v[216:219], v[48:51], v[76:79], 0
    v_mfma_f32_16x16x32_bf16 v[220:223], v[52:55], v[76:79], 0
    s_waitcnt lgkmcnt(13)
    v_mfma_f32_16x16x32_bf16 v[128:131], v[80:83], v[96:99], v[128:131]
    s_waitcnt lgkmcnt(12)
    v_mfma_f32_16x16x32_bf16 v[132:135], v[84:87], v[96:99], v[132:135]
    s_waitcnt lgkmcnt(11)
    v_mfma_f32_16x16x32_bf16 v[136:139], v[88:91], v[96:99], v[136:139]
    s_waitcnt lgkmcnt(10)
    v_mfma_f32_16x16x32_bf16 v[140:143], v[92:95], v[96:99], v[140:143]
    s_waitcnt lgkmcnt(8)
    v_mfma_f32_16x16x32_bf16 v[144:147], v[80:83], v[100:103], v[144:147]
    v_mfma_f32_16x16x32_bf16 v[148:151], v[84:87], v[100:103], v[148:151]
    v_mfma_f32_16x16x32_bf16 v[152:155], v[88:91], v[100:103], v[152:155]
    v_mfma_f32_16x16x32_bf16 v[156:159], v[92:95], v[100:103], v[156:159]
    s_waitcnt lgkmcnt(6)
    v_mfma_f32_16x16x32_bf16 v[160:163], v[80:83], v[104:107], v[160:163]
    v_mfma_f32_16x16x32_bf16 v[164:167], v[84:87], v[104:107], v[164:167]
    v_mfma_f32_16x16x32_bf16 v[168:171], v[88:91], v[104:107], v[168:171]
    v_mfma_f32_16x16x32_bf16 v[172:175], v[92:95], v[104:107], v[172:175]
    s_waitcnt lgkmcnt(4)
    v_mfma_f32_16x16x32_bf16 v[176:179], v[80:83], v[108:111], v[176:179]
    v_mfma_f32_16x16x32_bf16 v[180:183], v[84:87], v[108:111], v[180:183]
    s_barrier
    v_mfma_f32_16x16x32_bf16 v[184:187], v[88:91], v[108:111], v[184:187]
    ds_read_b128 v[40:43], v20 offset:40960
    ds_read_b64_tr_b16 v[56:57], v22 offset:40960
    v_mfma_f32_16x16x32_bf16 v[188:191], v[92:95], v[108:111], v[188:191]
    ds_read_b64_tr_b16 v[58:59], v22 offset:42496
    ds_read_b128 v[44:47], v21 offset:41984
    s_waitcnt lgkmcnt(6)
    v_mfma_f32_16x16x32_bf16 v[192:195], v[80:83], v[112:115], v[192:195]
    ds_read_b128 v[48:51], v20 offset:45056
    ds_read_b128 v[52:55], v21 offset:46080
    v_mfma_f32_16x16x32_bf16 v[196:199], v[84:87], v[112:115], v[196:199]
    ds_read_b64_tr_b16 v[60:61], v23 offset:40960
    ds_read_b64_tr_b16 v[62:63], v23 offset:42496
    v_mfma_f32_16x16x32_bf16 v[200:203], v[88:91], v[112:115], v[200:203]
    ds_read_b64_tr_b16 v[64:65], v24 offset:40960
    ds_read_b64_tr_b16 v[66:67], v24 offset:42496
    v_mfma_f32_16x16x32_bf16 v[204:207], v[92:95], v[112:115], v[204:207]
    ds_read_b64_tr_b16 v[68:69], v25 offset:40960
    ds_read_b64_tr_b16 v[70:71], v25 offset:42496
    s_waitcnt lgkmcnt(12)
    v_mfma_f32_16x16x32_bf16 v[208:211], v[80:83], v[116:119], v[208:211]
    ds_read_b64_tr_b16 v[72:73], v22 offset:41088
    ds_read_b64_tr_b16 v[74:75], v22 offset:42624
    v_mfma_f32_16x16x32_bf16 v[212:215], v[84:87], v[116:119], v[212:215]
    ds_read_b64_tr_b16 v[76:77], v23 offset:41088
    v_mfma_f32_16x16x32_bf16 v[216:219], v[88:91], v[116:119], v[216:219]
    ds_read_b64_tr_b16 v[78:79], v23 offset:42624
    v_mfma_f32_16x16x32_bf16 v[220:223], v[92:95], v[116:119], v[220:223]
    s_waitcnt lgkmcnt(13)
    v_mfma_f32_16x16x32_bf16 v[128:131], v[40:43], v[56:59], v[128:131]
    s_waitcnt lgkmcnt(12)
    v_mfma_f32_16x16x32_bf16 v[132:135], v[44:47], v[56:59], v[132:135]
    s_waitcnt lgkmcnt(11)
    v_mfma_f32_16x16x32_bf16 v[136:139], v[48:51], v[56:59], v[136:139]
    s_waitcnt lgkmcnt(10)
    v_mfma_f32_16x16x32_bf16 v[140:143], v[52:55], v[56:59], v[140:143]
    s_waitcnt lgkmcnt(8)
    v_mfma_f32_16x16x32_bf16 v[144:147], v[40:43], v[60:63], v[144:147]
    v_mfma_f32_16x16x32_bf16 v[148:151], v[44:47], v[60:63], v[148:151]
    ds_read_b128 v[80:83], v21 offset:40960
    v_mfma_f32_16x16x32_bf16 v[152:155], v[48:51], v[60:63], v[152:155]
    ds_read_b64_tr_b16 v[96:97], v22 offset:53248
    v_mfma_f32_16x16x32_bf16 v[156:159], v[52:55], v[60:63], v[156:159]
    ds_read_b64_tr_b16 v[98:99], v22 offset:54784
    s_waitcnt lgkmcnt(9)
    v_mfma_f32_16x16x32_bf16 v[160:163], v[40:43], v[64:67], v[160:163]
    ds_read_b128 v[84:87], v20 offset:41984
    v_mfma_f32_16x16x32_bf16 v[164:167], v[44:47], v[64:67], v[164:167]
    ds_read_b128 v[88:91], v21 offset:45056
    v_mfma_f32_16x16x32_bf16 v[168:171], v[48:51], v[64:67], v[168:171]
    ds_read_b128 v[92:95], v20 offset:46080
    v_mfma_f32_16x16x32_bf16 v[172:175], v[52:55], v[64:67], v[172:175]
    ds_read_b64_tr_b16 v[100:101], v23 offset:53248
    s_waitcnt lgkmcnt(11)
    v_mfma_f32_16x16x32_bf16 v[176:179], v[40:43], v[68:71], v[176:179]
    ds_read_b64_tr_b16 v[102:103], v23 offset:54784
    v_mfma_f32_16x16x32_bf16 v[180:183], v[44:47], v[68:71], v[180:183]
    ds_read_b64_tr_b16 v[104:105], v24 offset:53248
    v_mfma_f32_16x16x32_bf16 v[184:187], v[48:51], v[68:71], v[184:187]
    ds_read_b64_tr_b16 v[106:107], v24 offset:54784
    v_mfma_f32_16x16x32_bf16 v[188:191], v[52:55], v[68:71], v[188:191]
    ds_read_b64_tr_b16 v[108:109], v25 offset:53248
    s_waitcnt lgkmcnt(13)
    v_mfma_f32_16x16x32_bf16 v[192:195], v[40:43], v[72:75], v[192:195]
    ds_read_b64_tr_b16 v[110:111], v25 offset:54784
    v_mfma_f32_16x16x32_bf16 v[196:199], v[44:47], v[72:75], v[196:199]
    ds_read_b64_tr_b16 v[112:113], v22 offset:53376
    v_mfma_f32_16x16x32_bf16 v[200:203], v[48:51], v[72:75], v[200:203]
    ds_read_b64_tr_b16 v[114:115], v22 offset:54912
    v_mfma_f32_16x16x32_bf16 v[204:207], v[52:55], v[72:75], v[204:207]
    ds_read_b64_tr_b16 v[116:117], v23 offset:53376
    s_waitcnt lgkmcnt(15)
    v_mfma_f32_16x16x32_bf16 v[208:211], v[40:43], v[76:79], v[208:211]
    ds_read_b64_tr_b16 v[118:119], v23 offset:54912
    v_mfma_f32_16x16x32_bf16 v[212:215], v[44:47], v[76:79], v[212:215]
    v_mfma_f32_16x16x32_bf16 v[216:219], v[48:51], v[76:79], v[216:219]
    v_mfma_f32_16x16x32_bf16 v[220:223], v[52:55], v[76:79], v[220:223]
    s_waitcnt lgkmcnt(13)
    v_mfma_f32_16x16x32_bf16 v[128:131], v[80:83], v[96:99], v[128:131]
    s_waitcnt lgkmcnt(12)
    v_mfma_f32_16x16x32_bf16 v[132:135], v[84:87], v[96:99], v[132:135]
    s_waitcnt lgkmcnt(11)
    v_mfma_f32_16x16x32_bf16 v[136:139], v[88:91], v[96:99], v[136:139]
    s_waitcnt lgkmcnt(10)
    v_mfma_f32_16x16x32_bf16 v[140:143], v[92:95], v[96:99], v[140:143]
    s_waitcnt lgkmcnt(8)
    v_mfma_f32_16x16x32_bf16 v[144:147], v[80:83], v[100:103], v[144:147]
    v_mfma_f32_16x16x32_bf16 v[148:151], v[84:87], v[100:103], v[148:151]
    v_mfma_f32_16x16x32_bf16 v[152:155], v[88:91], v[100:103], v[152:155]
    v_mfma_f32_16x16x32_bf16 v[156:159], v[92:95], v[100:103], v[156:159]
    s_waitcnt lgkmcnt(6)
    v_mfma_f32_16x16x32_bf16 v[160:163], v[80:83], v[104:107], v[160:163]
    v_mfma_f32_16x16x32_bf16 v[164:167], v[84:87], v[104:107], v[164:167]
    v_mfma_f32_16x16x32_bf16 v[168:171], v[88:91], v[104:107], v[168:171]
    v_mfma_f32_16x16x32_bf16 v[172:175], v[92:95], v[104:107], v[172:175]
    s_waitcnt lgkmcnt(4)
    v_mfma_f32_16x16x32_bf16 v[176:179], v[80:83], v[108:111], v[176:179]
    v_mfma_f32_16x16x32_bf16 v[180:183], v[84:87], v[108:111], v[180:183]
    s_barrier
    v_mfma_f32_16x16x32_bf16 v[184:187], v[88:91], v[108:111], v[184:187]
    ds_read_b128 v[40:43], v26 offset:0
    ds_read_b64_tr_b16 v[56:57], v28 offset:0
    v_mfma_f32_16x16x32_bf16 v[188:191], v[92:95], v[108:111], v[188:191]
    ds_read_b64_tr_b16 v[58:59], v28 offset:1536
    ds_read_b128 v[44:47], v27 offset:1024
    s_waitcnt lgkmcnt(6)
    v_mfma_f32_16x16x32_bf16 v[192:195], v[80:83], v[112:115], v[192:195]
    ds_read_b128 v[48:51], v26 offset:4096
    ds_read_b128 v[52:55], v27 offset:5120
    v_mfma_f32_16x16x32_bf16 v[196:199], v[84:87], v[112:115], v[196:199]
    ds_read_b64_tr_b16 v[60:61], v29 offset:0
    ds_read_b64_tr_b16 v[62:63], v29 offset:1536
    v_mfma_f32_16x16x32_bf16 v[200:203], v[88:91], v[112:115], v[200:203]
    ds_read_b64_tr_b16 v[64:65], v30 offset:0
    ds_read_b64_tr_b16 v[66:67], v30 offset:1536
    v_mfma_f32_16x16x32_bf16 v[204:207], v[92:95], v[112:115], v[204:207]
    ds_read_b64_tr_b16 v[68:69], v31 offset:0
    ds_read_b64_tr_b16 v[70:71], v31 offset:1536
    s_waitcnt lgkmcnt(12)
    v_mfma_f32_16x16x32_bf16 v[208:211], v[80:83], v[116:119], v[208:211]
    ds_read_b64_tr_b16 v[72:73], v28 offset:128
    ds_read_b64_tr_b16 v[74:75], v28 offset:1664
    v_mfma_f32_16x16x32_bf16 v[212:215], v[84:87], v[116:119], v[212:215]
    ds_read_b64_tr_b16 v[76:77], v29 offset:128
    v_mfma_f32_16x16x32_bf16 v[216:219], v[88:91], v[116:119], v[216:219]
    ds_read_b64_tr_b16 v[78:79], v29 offset:1664
    v_mfma_f32_16x16x32_bf16 v[220:223], v[92:95], v[116:119], v[220:223]
    s_waitcnt lgkmcnt(13)
    v_mfma_f32_16x16x32_bf16 v[128:131], v[40:43], v[56:59], v[128:131]
    s_waitcnt lgkmcnt(12)
    v_mfma_f32_16x16x32_bf16 v[132:135], v[44:47], v[56:59], v[132:135]
    s_waitcnt lgkmcnt(11)
    v_mfma_f32_16x16x32_bf16 v[136:139], v[48:51], v[56:59], v[136:139]
    s_waitcnt lgkmcnt(10)
    v_mfma_f32_16x16x32_bf16 v[140:143], v[52:55], v[56:59], v[140:143]
    s_waitcnt lgkmcnt(8)
    v_mfma_f32_16x16x32_bf16 v[144:147], v[40:43], v[60:63], v[144:147]
    v_mfma_f32_16x16x32_bf16 v[148:151], v[44:47], v[60:63], v[148:151]
    ds_read_b128 v[80:83], v27 offset:0
    v_mfma_f32_16x16x32_bf16 v[152:155], v[48:51], v[60:63], v[152:155]
    ds_read_b64_tr_b16 v[96:97], v28 offset:12288
    v_mfma_f32_16x16x32_bf16 v[156:159], v[52:55], v[60:63], v[156:159]
    ds_read_b64_tr_b16 v[98:99], v28 offset:13824
    s_waitcnt lgkmcnt(9)
    v_mfma_f32_16x16x32_bf16 v[160:163], v[40:43], v[64:67], v[160:163]
    ds_read_b128 v[84:87], v26 offset:1024
    v_mfma_f32_16x16x32_bf16 v[164:167], v[44:47], v[64:67], v[164:167]
    ds_read_b128 v[88:91], v27 offset:4096
    v_mfma_f32_16x16x32_bf16 v[168:171], v[48:51], v[64:67], v[168:171]
    ds_read_b128 v[92:95], v26 offset:5120
    v_mfma_f32_16x16x32_bf16 v[172:175], v[52:55], v[64:67], v[172:175]
    ds_read_b64_tr_b16 v[100:101], v29 offset:12288
    s_waitcnt lgkmcnt(11)
    v_mfma_f32_16x16x32_bf16 v[176:179], v[40:43], v[68:71], v[176:179]
    ds_read_b64_tr_b16 v[102:103], v29 offset:13824
    v_mfma_f32_16x16x32_bf16 v[180:183], v[44:47], v[68:71], v[180:183]
    ds_read_b64_tr_b16 v[104:105], v30 offset:12288
    v_mfma_f32_16x16x32_bf16 v[184:187], v[48:51], v[68:71], v[184:187]
    ds_read_b64_tr_b16 v[106:107], v30 offset:13824
    v_mfma_f32_16x16x32_bf16 v[188:191], v[52:55], v[68:71], v[188:191]
    ds_read_b64_tr_b16 v[108:109], v31 offset:12288
    s_waitcnt lgkmcnt(13)
    v_mfma_f32_16x16x32_bf16 v[192:195], v[40:43], v[72:75], v[192:195]
    ds_read_b64_tr_b16 v[110:111], v31 offset:13824
    v_mfma_f32_16x16x32_bf16 v[196:199], v[44:47], v[72:75], v[196:199]
    ds_read_b64_tr_b16 v[112:113], v28 offset:12416
    v_mfma_f32_16x16x32_bf16 v[200:203], v[48:51], v[72:75], v[200:203]
    ds_read_b64_tr_b16 v[114:115], v28 offset:13952
    v_mfma_f32_16x16x32_bf16 v[204:207], v[52:55], v[72:75], v[204:207]
    ds_read_b64_tr_b16 v[116:117], v29 offset:12416
    s_waitcnt lgkmcnt(15)
    v_mfma_f32_16x16x32_bf16 v[208:211], v[40:43], v[76:79], v[208:211]
    ds_read_b64_tr_b16 v[118:119], v29 offset:13952
    v_mfma_f32_16x16x32_bf16 v[212:215], v[44:47], v[76:79], v[212:215]
    v_mfma_f32_16x16x32_bf16 v[216:219], v[48:51], v[76:79], v[216:219]
    v_mfma_f32_16x16x32_bf16 v[220:223], v[52:55], v[76:79], v[220:223]
    s_waitcnt lgkmcnt(13)
    v_mfma_f32_16x16x32_bf16 v[128:131], v[80:83], v[96:99], v[128:131]
    s_waitcnt lgkmcnt(12)
    v_mfma_f32_16x16x32_bf16 v[132:135], v[84:87], v[96:99], v[132:135]
    s_waitcnt lgkmcnt(11)
    v_mfma_f32_16x16x32_bf16 v[136:139], v[88:91], v[96:99], v[136:139]
    s_waitcnt lgkmcnt(10)
    v_mfma_f32_16x16x32_bf16 v[140:143], v[92:95], v[96:99], v[140:143]
    s_waitcnt lgkmcnt(8)
    v_mfma_f32_16x16x32_bf16 v[144:147], v[80:83], v[100:103], v[144:147]
    v_mfma_f32_16x16x32_bf16 v[148:151], v[84:87], v[100:103], v[148:151]
    v_mfma_f32_16x16x32_bf16 v[152:155], v[88:91], v[100:103], v[152:155]
    v_mfma_f32_16x16x32_bf16 v[156:159], v[92:95], v[100:103], v[156:159]
    s_waitcnt lgkmcnt(6)
    v_mfma_f32_16x16x32_bf16 v[160:163], v[80:83], v[104:107], v[160:163]
    v_mfma_f32_16x16x32_bf16 v[164:167], v[84:87], v[104:107], v[164:167]
    v_mfma_f32_16x16x32_bf16 v[168:171], v[88:91], v[104:107], v[168:171]
    v_mfma_f32_16x16x32_bf16 v[172:175], v[92:95], v[104:107], v[172:175]
    s_waitcnt lgkmcnt(4)
    v_mfma_f32_16x16x32_bf16 v[176:179], v[80:83], v[108:111], v[176:179]
    v_mfma_f32_16x16x32_bf16 v[180:183], v[84:87], v[108:111], v[180:183]
    s_barrier
    v_mfma_f32_16x16x32_bf16 v[184:187], v[88:91], v[108:111], v[184:187]
    ds_read_b128 v[40:43], v26 offset:40960
    ds_read_b64_tr_b16 v[56:57], v28 offset:40960
    v_mfma_f32_16x16x32_bf16 v[188:191], v[92:95], v[108:111], v[188:191]
    ds_read_b64_tr_b16 v[58:59], v28 offset:42496
    ds_read_b128 v[44:47], v27 offset:41984
    s_waitcnt lgkmcnt(6)
    v_mfma_f32_16x16x32_bf16 v[192:195], v[80:83], v[112:115], v[192:195]
    ds_read_b128 v[48:51], v26 offset:45056
    ds_read_b128 v[52:55], v27 offset:46080
    v_mfma_f32_16x16x32_bf16 v[196:199], v[84:87], v[112:115], v[196:199]
    ds_read_b64_tr_b16 v[60:61], v29 offset:40960
    ds_read_b64_tr_b16 v[62:63], v29 offset:42496
    v_mfma_f32_16x16x32_bf16 v[200:203], v[88:91], v[112:115], v[200:203]
    ds_read_b64_tr_b16 v[64:65], v30 offset:40960
    ds_read_b64_tr_b16 v[66:67], v30 offset:42496
    v_mfma_f32_16x16x32_bf16 v[204:207], v[92:95], v[112:115], v[204:207]
    ds_read_b64_tr_b16 v[68:69], v31 offset:40960
    ds_read_b64_tr_b16 v[70:71], v31 offset:42496
    s_waitcnt lgkmcnt(12)
    v_mfma_f32_16x16x32_bf16 v[208:211], v[80:83], v[116:119], v[208:211]
    ds_read_b64_tr_b16 v[72:73], v28 offset:41088
    ds_read_b64_tr_b16 v[74:75], v28 offset:42624
    v_mfma_f32_16x16x32_bf16 v[212:215], v[84:87], v[116:119], v[212:215]
    ds_read_b64_tr_b16 v[76:77], v29 offset:41088
    v_mfma_f32_16x16x32_bf16 v[216:219], v[88:91], v[116:119], v[216:219]
    ds_read_b64_tr_b16 v[78:79], v29 offset:42624
    v_mfma_f32_16x16x32_bf16 v[220:223], v[92:95], v[116:119], v[220:223]
    s_waitcnt lgkmcnt(13)
    v_mfma_f32_16x16x32_bf16 v[128:131], v[40:43], v[56:59], v[128:131]
    s_waitcnt lgkmcnt(12)
    v_mfma_f32_16x16x32_bf16 v[132:135], v[44:47], v[56:59], v[132:135]
    s_waitcnt lgkmcnt(11)
    v_mfma_f32_16x16x32_bf16 v[136:139], v[48:51], v[56:59], v[136:139]
    s_waitcnt lgkmcnt(10)
    v_mfma_f32_16x16x32_bf16 v[140:143], v[52:55], v[56:59], v[140:143]
    s_waitcnt lgkmcnt(8)
    v_mfma_f32_16x16x32_bf16 v[144:147], v[40:43], v[60:63], v[144:147]
    v_mfma_f32_16x16x32_bf16 v[148:151], v[44:47], v[60:63], v[148:151]
    ds_read_b128 v[80:83], v27 offset:40960
    v_mfma_f32_16x16x32_bf16 v[152:155], v[48:51], v[60:63], v[152:155]
    ds_read_b64_tr_b16 v[96:97], v28 offset:53248
    v_mfma_f32_16x16x32_bf16 v[156:159], v[52:55], v[60:63], v[156:159]
    ds_read_b64_tr_b16 v[98:99], v28 offset:54784
    s_waitcnt lgkmcnt(9)
    v_mfma_f32_16x16x32_bf16 v[160:163], v[40:43], v[64:67], v[160:163]
    ds_read_b128 v[84:87], v26 offset:41984
    v_mfma_f32_16x16x32_bf16 v[164:167], v[44:47], v[64:67], v[164:167]
    ds_read_b128 v[88:91], v27 offset:45056
    v_mfma_f32_16x16x32_bf16 v[168:171], v[48:51], v[64:67], v[168:171]
    ds_read_b128 v[92:95], v26 offset:46080
    v_mfma_f32_16x16x32_bf16 v[172:175], v[52:55], v[64:67], v[172:175]
    ds_read_b64_tr_b16 v[100:101], v29 offset:53248
    s_waitcnt lgkmcnt(11)
    v_mfma_f32_16x16x32_bf16 v[176:179], v[40:43], v[68:71], v[176:179]
    ds_read_b64_tr_b16 v[102:103], v29 offset:54784
    v_mfma_f32_16x16x32_bf16 v[180:183], v[44:47], v[68:71], v[180:183]
    ds_read_b64_tr_b16 v[104:105], v30 offset:53248
    v_mfma_f32_16x16x32_bf16 v[184:187], v[48:51], v[68:71], v[184:187]
    ds_read_b64_tr_b16 v[106:107], v30 offset:54784
    v_mfma_f32_16x16x32_bf16 v[188:191], v[52:55], v[68:71], v[188:191]
    ds_read_b64_tr_b16 v[108:109], v31 offset:53248
    s_waitcnt lgkmcnt(13)
    v_mfma_f32_16x16x32_bf16 v[192:195], v[40:43], v[72:75], v[192:195]
    ds_read_b64_tr_b16 v[110:111], v31 offset:54784
    v_mfma_f32_16x16x32_bf16 v[196:199], v[44:47], v[72:75], v[196:199]
    ds_read_b64_tr_b16 v[112:113], v28 offset:53376
    v_mfma_f32_16x16x32_bf16 v[200:203], v[48:51], v[72:75], v[200:203]
    ds_read_b64_tr_b16 v[114:115], v28 offset:54912
    v_mfma_f32_16x16x32_bf16 v[204:207], v[52:55], v[72:75], v[204:207]
    ds_read_b64_tr_b16 v[116:117], v29 offset:53376
    s_waitcnt lgkmcnt(15)
    v_mfma_f32_16x16x32_bf16 v[208:211], v[40:43], v[76:79], v[208:211]
    ds_read_b64_tr_b16 v[118:119], v29 offset:54912
    v_mfma_f32_16x16x32_bf16 v[212:215], v[44:47], v[76:79], v[212:215]
    v_mfma_f32_16x16x32_bf16 v[216:219], v[48:51], v[76:79], v[216:219]
    v_mfma_f32_16x16x32_bf16 v[220:223], v[52:55], v[76:79], v[220:223]
    s_waitcnt lgkmcnt(13)
    v_mfma_f32_16x16x32_bf16 v[128:131], v[80:83], v[96:99], v[128:131]
    s_waitcnt lgkmcnt(12)
    v_mfma_f32_16x16x32_bf16 v[132:135], v[84:87], v[96:99], v[132:135]
    s_waitcnt lgkmcnt(11)
    v_mfma_f32_16x16x32_bf16 v[136:139], v[88:91], v[96:99], v[136:139]
    s_waitcnt lgkmcnt(10)
    v_mfma_f32_16x16x32_bf16 v[140:143], v[92:95], v[96:99], v[140:143]
    s_waitcnt lgkmcnt(8)
    v_mfma_f32_16x16x32_bf16 v[144:147], v[80:83], v[100:103], v[144:147]
    v_mfma_f32_16x16x32_bf16 v[148:151], v[84:87], v[100:103], v[148:151]
    v_mfma_f32_16x16x32_bf16 v[152:155], v[88:91], v[100:103], v[152:155]
    v_mfma_f32_16x16x32_bf16 v[156:159], v[92:95], v[100:103], v[156:159]
    s_waitcnt lgkmcnt(6)
    v_mfma_f32_16x16x32_bf16 v[160:163], v[80:83], v[104:107], v[160:163]
    v_mfma_f32_16x16x32_bf16 v[164:167], v[84:87], v[104:107], v[164:167]
    v_mfma_f32_16x16x32_bf16 v[168:171], v[88:91], v[104:107], v[168:171]
    v_mfma_f32_16x16x32_bf16 v[172:175], v[92:95], v[104:107], v[172:175]
    s_waitcnt lgkmcnt(4)
    v_mfma_f32_16x16x32_bf16 v[176:179], v[80:83], v[108:111], v[176:179]
    v_mfma_f32_16x16x32_bf16 v[180:183], v[84:87], v[108:111], v[180:183]
    s_barrier
    v_mfma_f32_16x16x32_bf16 v[184:187], v[88:91], v[108:111], v[184:187]
    ds_read_b128 v[40:43], v20 offset:0
    ds_read_b64_tr_b16 v[56:57], v22 offset:0
    v_mfma_f32_16x16x32_bf16 v[188:191], v[92:95], v[108:111], v[188:191]
    ds_read_b64_tr_b16 v[58:59], v22 offset:1536
    ds_read_b128 v[44:47], v21 offset:1024
    s_waitcnt lgkmcnt(6)
    v_mfma_f32_16x16x32_bf16 v[192:195], v[80:83], v[112:115], v[192:195]
    ds_read_b128 v[48:51], v20 offset:4096
    ds_read_b128 v[52:55], v21 offset:5120
    v_mfma_f32_16x16x32_bf16 v[196:199], v[84:87], v[112:115], v[196:199]
    ds_read_b64_tr_b16 v[60:61], v23 offset:0
    ds_read_b64_tr_b16 v[62:63], v23 offset:1536
    v_mfma_f32_16x16x32_bf16 v[200:203], v[88:91], v[112:115], v[200:203]
    ds_read_b64_tr_b16 v[64:65], v24 offset:0
    ds_read_b64_tr_b16 v[66:67], v24 offset:1536
    v_mfma_f32_16x16x32_bf16 v[204:207], v[92:95], v[112:115], v[204:207]
    ds_read_b64_tr_b16 v[68:69], v25 offset:0
    ds_read_b64_tr_b16 v[70:71], v25 offset:1536
    s_waitcnt lgkmcnt(12)
    v_mfma_f32_16x16x32_bf16 v[208:211], v[80:83], v[116:119], v[208:211]
    ds_read_b64_tr_b16 v[72:73], v22 offset:128
    ds_read_b64_tr_b16 v[74:75], v22 offset:1664
    v_mfma_f32_16x16x32_bf16 v[212:215], v[84:87], v[116:119], v[212:215]
    ds_read_b64_tr_b16 v[76:77], v23 offset:128
    v_mfma_f32_16x16x32_bf16 v[216:219], v[88:91], v[116:119], v[216:219]
    ds_read_b64_tr_b16 v[78:79], v23 offset:1664
    v_mfma_f32_16x16x32_bf16 v[220:223], v[92:95], v[116:119], v[220:223]
    s_waitcnt lgkmcnt(13)
    v_mfma_f32_16x16x32_bf16 v[128:131], v[40:43], v[56:59], v[128:131]
    s_waitcnt lgkmcnt(12)
    v_mfma_f32_16x16x32_bf16 v[132:135], v[44:47], v[56:59], v[132:135]
    s_waitcnt lgkmcnt(11)
    v_mfma_f32_16x16x32_bf16 v[136:139], v[48:51], v[56:59], v[136:139]
    s_waitcnt lgkmcnt(10)
    v_mfma_f32_16x16x32_bf16 v[140:143], v[52:55], v[56:59], v[140:143]
    s_waitcnt lgkmcnt(8)
    v_mfma_f32_16x16x32_bf16 v[144:147], v[40:43], v[60:63], v[144:147]
    v_mfma_f32_16x16x32_bf16 v[148:151], v[44:47], v[60:63], v[148:151]
    ds_read_b128 v[80:83], v21 offset:0
    v_mfma_f32_16x16x32_bf16 v[152:155], v[48:51], v[60:63], v[152:155]
    ds_read_b64_tr_b16 v[96:97], v22 offset:12288
    v_mfma_f32_16x16x32_bf16 v[156:159], v[52:55], v[60:63], v[156:159]
    ds_read_b64_tr_b16 v[98:99], v22 offset:13824
    s_waitcnt lgkmcnt(9)
    v_mfma_f32_16x16x32_bf16 v[160:163], v[40:43], v[64:67], v[160:163]
    ds_read_b128 v[84:87], v20 offset:1024
    v_mfma_f32_16x16x32_bf16 v[164:167], v[44:47], v[64:67], v[164:167]
    ds_read_b128 v[88:91], v21 offset:4096
    v_mfma_f32_16x16x32_bf16 v[168:171], v[48:51], v[64:67], v[168:171]
    ds_read_b128 v[92:95], v20 offset:5120
    v_mfma_f32_16x16x32_bf16 v[172:175], v[52:55], v[64:67], v[172:175]
    ds_read_b64_tr_b16 v[100:101], v23 offset:12288
    s_waitcnt lgkmcnt(11)
    v_mfma_f32_16x16x32_bf16 v[176:179], v[40:43], v[68:71], v[176:179]
    ds_read_b64_tr_b16 v[102:103], v23 offset:13824
    v_mfma_f32_16x16x32_bf16 v[180:183], v[44:47], v[68:71], v[180:183]
    ds_read_b64_tr_b16 v[104:105], v24 offset:12288
    v_mfma_f32_16x16x32_bf16 v[184:187], v[48:51], v[68:71], v[184:187]
    ds_read_b64_tr_b16 v[106:107], v24 offset:13824
    v_mfma_f32_16x16x32_bf16 v[188:191], v[52:55], v[68:71], v[188:191]
    ds_read_b64_tr_b16 v[108:109], v25 offset:12288
    s_waitcnt lgkmcnt(13)
    v_mfma_f32_16x16x32_bf16 v[192:195], v[40:43], v[72:75], v[192:195]
    ds_read_b64_tr_b16 v[110:111], v25 offset:13824
    v_mfma_f32_16x16x32_bf16 v[196:199], v[44:47], v[72:75], v[196:199]
    ds_read_b64_tr_b16 v[112:113], v22 offset:12416
    v_mfma_f32_16x16x32_bf16 v[200:203], v[48:51], v[72:75], v[200:203]
    ds_read_b64_tr_b16 v[114:115], v22 offset:13952
    v_mfma_f32_16x16x32_bf16 v[204:207], v[52:55], v[72:75], v[204:207]
    ds_read_b64_tr_b16 v[116:117], v23 offset:12416
    s_waitcnt lgkmcnt(15)
    v_mfma_f32_16x16x32_bf16 v[208:211], v[40:43], v[76:79], v[208:211]
    ds_read_b64_tr_b16 v[118:119], v23 offset:13952
    v_mfma_f32_16x16x32_bf16 v[212:215], v[44:47], v[76:79], v[212:215]
    v_mfma_f32_16x16x32_bf16 v[216:219], v[48:51], v[76:79], v[216:219]
    v_mfma_f32_16x16x32_bf16 v[220:223], v[52:55], v[76:79], v[220:223]
    s_waitcnt lgkmcnt(13)
    v_mfma_f32_16x16x32_bf16 v[128:131], v[80:83], v[96:99], v[128:131]
    s_waitcnt lgkmcnt(12)
    v_mfma_f32_16x16x32_bf16 v[132:135], v[84:87], v[96:99], v[132:135]
    s_waitcnt lgkmcnt(11)
    v_mfma_f32_16x16x32_bf16 v[136:139], v[88:91], v[96:99], v[136:139]
    s_waitcnt lgkmcnt(10)
    v_mfma_f32_16x16x32_bf16 v[140:143], v[92:95], v[96:99], v[140:143]
    s_waitcnt lgkmcnt(8)
    v_mfma_f32_16x16x32_bf16 v[144:147], v[80:83], v[100:103], v[144:147]
    v_mfma_f32_16x16x32_bf16 v[148:151], v[84:87], v[100:103], v[148:151]
    v_mfma_f32_16x16x32_bf16 v[152:155], v[88:91], v[100:103], v[152:155]
    v_mfma_f32_16x16x32_bf16 v[156:159], v[92:95], v[100:103], v[156:159]
    s_waitcnt lgkmcnt(6)
    v_mfma_f32_16x16x32_bf16 v[160:163], v[80:83], v[104:107], v[160:163]
    v_mfma_f32_16x16x32_bf16 v[164:167], v[84:87], v[104:107], v[164:167]
    v_mfma_f32_16x16x32_bf16 v[168:171], v[88:91], v[104:107], v[168:171]
    v_mfma_f32_16x16x32_bf16 v[172:175], v[92:95], v[104:107], v[172:175]
    s_waitcnt lgkmcnt(4)
    v_mfma_f32_16x16x32_bf16 v[176:179], v[80:83], v[108:111], v[176:179]
    v_mfma_f32_16x16x32_bf16 v[180:183], v[84:87], v[108:111], v[180:183]
    buffer_load_dword v12, off, s[48:51], 0 sc1
    s_barrier
    v_mfma_f32_16x16x32_bf16 v[184:187], v[88:91], v[108:111], v[184:187]
    ds_read_b128 v[40:43], v20 offset:40960
    ds_read_b64_tr_b16 v[56:57], v22 offset:40960
    v_mfma_f32_16x16x32_bf16 v[188:191], v[92:95], v[108:111], v[188:191]
    ds_read_b64_tr_b16 v[58:59], v22 offset:42496
    ds_read_b128 v[44:47], v21 offset:41984
    s_waitcnt lgkmcnt(6)
    v_mfma_f32_16x16x32_bf16 v[192:195], v[80:83], v[112:115], v[192:195]
    ds_read_b128 v[48:51], v20 offset:45056
    ds_read_b128 v[52:55], v21 offset:46080
    v_mfma_f32_16x16x32_bf16 v[196:199], v[84:87], v[112:115], v[196:199]
    ds_read_b64_tr_b16 v[60:61], v23 offset:40960
    ds_read_b64_tr_b16 v[62:63], v23 offset:42496
    v_mfma_f32_16x16x32_bf16 v[200:203], v[88:91], v[112:115], v[200:203]
    ds_read_b64_tr_b16 v[64:65], v24 offset:40960
    ds_read_b64_tr_b16 v[66:67], v24 offset:42496
    v_mfma_f32_16x16x32_bf16 v[204:207], v[92:95], v[112:115], v[204:207]
    ds_read_b64_tr_b16 v[68:69], v25 offset:40960
    ds_read_b64_tr_b16 v[70:71], v25 offset:42496
    s_waitcnt lgkmcnt(12)
    v_mfma_f32_16x16x32_bf16 v[208:211], v[80:83], v[116:119], v[208:211]
    ds_read_b64_tr_b16 v[72:73], v22 offset:41088
    ds_read_b64_tr_b16 v[74:75], v22 offset:42624
    v_mfma_f32_16x16x32_bf16 v[212:215], v[84:87], v[116:119], v[212:215]
    ds_read_b64_tr_b16 v[76:77], v23 offset:41088
    v_mfma_f32_16x16x32_bf16 v[216:219], v[88:91], v[116:119], v[216:219]
    ds_read_b64_tr_b16 v[78:79], v23 offset:42624
    v_mfma_f32_16x16x32_bf16 v[220:223], v[92:95], v[116:119], v[220:223]
    s_waitcnt lgkmcnt(13)
    v_mfma_f32_16x16x32_bf16 v[128:131], v[40:43], v[56:59], v[128:131]
    s_waitcnt lgkmcnt(12)
    v_mfma_f32_16x16x32_bf16 v[132:135], v[44:47], v[56:59], v[132:135]
    s_waitcnt lgkmcnt(11)
    v_mfma_f32_16x16x32_bf16 v[136:139], v[48:51], v[56:59], v[136:139]
    s_waitcnt lgkmcnt(10)
    v_mfma_f32_16x16x32_bf16 v[140:143], v[52:55], v[56:59], v[140:143]
    s_waitcnt lgkmcnt(8)
    v_mfma_f32_16x16x32_bf16 v[144:147], v[40:43], v[60:63], v[144:147]
    v_mfma_f32_16x16x32_bf16 v[148:151], v[44:47], v[60:63], v[148:151]
    ds_read_b128 v[80:83], v21 offset:40960
    v_mfma_f32_16x16x32_bf16 v[152:155], v[48:51], v[60:63], v[152:155]
    ds_read_b64_tr_b16 v[96:97], v22 offset:53248
    v_mfma_f32_16x16x32_bf16 v[156:159], v[52:55], v[60:63], v[156:159]
    ds_read_b64_tr_b16 v[98:99], v22 offset:54784
    s_waitcnt lgkmcnt(9)
    v_mfma_f32_16x16x32_bf16 v[160:163], v[40:43], v[64:67], v[160:163]
    ds_read_b128 v[84:87], v20 offset:41984
    v_mfma_f32_16x16x32_bf16 v[164:167], v[44:47], v[64:67], v[164:167]
    ds_read_b128 v[88:91], v21 offset:45056
    v_mfma_f32_16x16x32_bf16 v[168:171], v[48:51], v[64:67], v[168:171]
    ds_read_b128 v[92:95], v20 offset:46080
    v_mfma_f32_16x16x32_bf16 v[172:175], v[52:55], v[64:67], v[172:175]
    ds_read_b64_tr_b16 v[100:101], v23 offset:53248
    s_waitcnt lgkmcnt(11)
    v_mfma_f32_16x16x32_bf16 v[176:179], v[40:43], v[68:71], v[176:179]
    ds_read_b64_tr_b16 v[102:103], v23 offset:54784
    v_mfma_f32_16x16x32_bf16 v[180:183], v[44:47], v[68:71], v[180:183]
    ds_read_b64_tr_b16 v[104:105], v24 offset:53248
    v_mfma_f32_16x16x32_bf16 v[184:187], v[48:51], v[68:71], v[184:187]
    ds_read_b64_tr_b16 v[106:107], v24 offset:54784
    v_mfma_f32_16x16x32_bf16 v[188:191], v[52:55], v[68:71], v[188:191]
    ds_read_b64_tr_b16 v[108:109], v25 offset:53248
    s_waitcnt lgkmcnt(13)
    v_mfma_f32_16x16x32_bf16 v[192:195], v[40:43], v[72:75], v[192:195]
    ds_read_b64_tr_b16 v[110:111], v25 offset:54784
    v_mfma_f32_16x16x32_bf16 v[196:199], v[44:47], v[72:75], v[196:199]
    ds_read_b64_tr_b16 v[112:113], v22 offset:53376
    v_mfma_f32_16x16x32_bf16 v[200:203], v[48:51], v[72:75], v[200:203]
    ds_read_b64_tr_b16 v[114:115], v22 offset:54912
    v_mfma_f32_16x16x32_bf16 v[204:207], v[52:55], v[72:75], v[204:207]
    ds_read_b64_tr_b16 v[116:117], v23 offset:53376
    s_waitcnt lgkmcnt(15)
    v_mfma_f32_16x16x32_bf16 v[208:211], v[40:43], v[76:79], v[208:211]
    ds_read_b64_tr_b16 v[118:119], v23 offset:54912
    v_mfma_f32_16x16x32_bf16 v[212:215], v[44:47], v[76:79], v[212:215]
    v_mfma_f32_16x16x32_bf16 v[216:219], v[48:51], v[76:79], v[216:219]
    v_mfma_f32_16x16x32_bf16 v[220:223], v[52:55], v[76:79], v[220:223]
    s_waitcnt lgkmcnt(13)
    v_mfma_f32_16x16x32_bf16 v[128:131], v[80:83], v[96:99], v[128:131]
    s_waitcnt lgkmcnt(12)
    v_mfma_f32_16x16x32_bf16 v[132:135], v[84:87], v[96:99], v[132:135]
    s_waitcnt lgkmcnt(11)
    v_mfma_f32_16x16x32_bf16 v[136:139], v[88:91], v[96:99], v[136:139]
    s_waitcnt lgkmcnt(10)
    v_mfma_f32_16x16x32_bf16 v[140:143], v[92:95], v[96:99], v[140:143]
    s_waitcnt lgkmcnt(8)
    v_mfma_f32_16x16x32_bf16 v[144:147], v[80:83], v[100:103], v[144:147]
    v_mfma_f32_16x16x32_bf16 v[148:151], v[84:87], v[100:103], v[148:151]
    v_mfma_f32_16x16x32_bf16 v[152:155], v[88:91], v[100:103], v[152:155]
    v_mfma_f32_16x16x32_bf16 v[156:159], v[92:95], v[100:103], v[156:159]
    s_waitcnt lgkmcnt(6)
    v_mfma_f32_16x16x32_bf16 v[160:163], v[80:83], v[104:107], v[160:163]
    v_mfma_f32_16x16x32_bf16 v[164:167], v[84:87], v[104:107], v[164:167]
    v_mfma_f32_16x16x32_bf16 v[168:171], v[88:91], v[104:107], v[168:171]
    v_mfma_f32_16x16x32_bf16 v[172:175], v[92:95], v[104:107], v[172:175]
    s_waitcnt lgkmcnt(4)
    v_mfma_f32_16x16x32_bf16 v[176:179], v[80:83], v[108:111], v[176:179]
    v_mfma_f32_16x16x32_bf16 v[180:183], v[84:87], v[108:111], v[180:183]
    s_barrier
    v_mfma_f32_16x16x32_bf16 v[184:187], v[88:91], v[108:111], v[184:187]
    ds_read_b128 v[40:43], v26 offset:0
    ds_read_b64_tr_b16 v[56:57], v28 offset:0
    v_mfma_f32_16x16x32_bf16 v[188:191], v[92:95], v[108:111], v[188:191]
    ds_read_b64_tr_b16 v[58:59], v28 offset:1536
    ds_read_b128 v[44:47], v27 offset:1024
    s_waitcnt lgkmcnt(6)
    v_mfma_f32_16x16x32_bf16 v[192:195], v[80:83], v[112:115], v[192:195]
    ds_read_b128 v[48:51], v26 offset:4096
    ds_read_b128 v[52:55], v27 offset:5120
    v_mfma_f32_16x16x32_bf16 v[196:199], v[84:87], v[112:115], v[196:199]
    ds_read_b64_tr_b16 v[60:61], v29 offset:0
    ds_read_b64_tr_b16 v[62:63], v29 offset:1536
    v_mfma_f32_16x16x32_bf16 v[200:203], v[88:91], v[112:115], v[200:203]
    ds_read_b64_tr_b16 v[64:65], v30 offset:0
    ds_read_b64_tr_b16 v[66:67], v30 offset:1536
    v_mfma_f32_16x16x32_bf16 v[204:207], v[92:95], v[112:115], v[204:207]
    ds_read_b64_tr_b16 v[68:69], v31 offset:0
    ds_read_b64_tr_b16 v[70:71], v31 offset:1536
    s_waitcnt lgkmcnt(12)
    v_mfma_f32_16x16x32_bf16 v[208:211], v[80:83], v[116:119], v[208:211]
    ds_read_b64_tr_b16 v[72:73], v28 offset:128
    ds_read_b64_tr_b16 v[74:75], v28 offset:1664
    v_mfma_f32_16x16x32_bf16 v[212:215], v[84:87], v[116:119], v[212:215]
    ds_read_b64_tr_b16 v[76:77], v29 offset:128
    v_mfma_f32_16x16x32_bf16 v[216:219], v[88:91], v[116:119], v[216:219]
    ds_read_b64_tr_b16 v[78:79], v29 offset:1664
    v_mfma_f32_16x16x32_bf16 v[220:223], v[92:95], v[116:119], v[220:223]
    s_waitcnt lgkmcnt(13)
    v_mfma_f32_16x16x32_bf16 v[128:131], v[40:43], v[56:59], v[128:131]
    s_waitcnt lgkmcnt(12)
    v_mfma_f32_16x16x32_bf16 v[132:135], v[44:47], v[56:59], v[132:135]
    s_waitcnt lgkmcnt(11)
    v_mfma_f32_16x16x32_bf16 v[136:139], v[48:51], v[56:59], v[136:139]
    s_waitcnt lgkmcnt(10)
    v_mfma_f32_16x16x32_bf16 v[140:143], v[52:55], v[56:59], v[140:143]
    s_waitcnt lgkmcnt(8)
    v_mfma_f32_16x16x32_bf16 v[144:147], v[40:43], v[60:63], v[144:147]
    v_mfma_f32_16x16x32_bf16 v[148:151], v[44:47], v[60:63], v[148:151]
    ds_read_b128 v[80:83], v27 offset:0
    v_mfma_f32_16x16x32_bf16 v[152:155], v[48:51], v[60:63], v[152:155]
    ds_read_b64_tr_b16 v[96:97], v28 offset:12288
    v_mfma_f32_16x16x32_bf16 v[156:159], v[52:55], v[60:63], v[156:159]
    ds_read_b64_tr_b16 v[98:99], v28 offset:13824
    s_waitcnt lgkmcnt(9)
    v_mfma_f32_16x16x32_bf16 v[160:163], v[40:43], v[64:67], v[160:163]
    ds_read_b128 v[84:87], v26 offset:1024
    v_mfma_f32_16x16x32_bf16 v[164:167], v[44:47], v[64:67], v[164:167]
    ds_read_b128 v[88:91], v27 offset:4096
    v_mfma_f32_16x16x32_bf16 v[168:171], v[48:51], v[64:67], v[168:171]
    ds_read_b128 v[92:95], v26 offset:5120
    v_mfma_f32_16x16x32_bf16 v[172:175], v[52:55], v[64:67], v[172:175]
    ds_read_b64_tr_b16 v[100:101], v29 offset:12288
    s_waitcnt lgkmcnt(11)
    v_mfma_f32_16x16x32_bf16 v[176:179], v[40:43], v[68:71], v[176:179]
    ds_read_b64_tr_b16 v[102:103], v29 offset:13824
    v_mfma_f32_16x16x32_bf16 v[180:183], v[44:47], v[68:71], v[180:183]
    ds_read_b64_tr_b16 v[104:105], v30 offset:12288
    v_mfma_f32_16x16x32_bf16 v[184:187], v[48:51], v[68:71], v[184:187]
    ds_read_b64_tr_b16 v[106:107], v30 offset:13824
    v_mfma_f32_16x16x32_bf16 v[188:191], v[52:55], v[68:71], v[188:191]
    ds_read_b64_tr_b16 v[108:109], v31 offset:12288
    s_waitcnt lgkmcnt(13)
    v_mfma_f32_16x16x32_bf16 v[192:195], v[40:43], v[72:75], v[192:195]
    ds_read_b64_tr_b16 v[110:111], v31 offset:13824
    v_mfma_f32_16x16x32_bf16 v[196:199], v[44:47], v[72:75], v[196:199]
    ds_read_b64_tr_b16 v[112:113], v28 offset:12416
    v_mfma_f32_16x16x32_bf16 v[200:203], v[48:51], v[72:75], v[200:203]
    ds_read_b64_tr_b16 v[114:115], v28 offset:13952
    v_mfma_f32_16x16x32_bf16 v[204:207], v[52:55], v[72:75], v[204:207]
    ds_read_b64_tr_b16 v[116:117], v29 offset:12416
    s_waitcnt lgkmcnt(15)
    v_mfma_f32_16x16x32_bf16 v[208:211], v[40:43], v[76:79], v[208:211]
    ds_read_b64_tr_b16 v[118:119], v29 offset:13952
    v_mfma_f32_16x16x32_bf16 v[212:215], v[44:47], v[76:79], v[212:215]
    v_mfma_f32_16x16x32_bf16 v[216:219], v[48:51], v[76:79], v[216:219]
    v_mfma_f32_16x16x32_bf16 v[220:223], v[52:55], v[76:79], v[220:223]
    s_waitcnt lgkmcnt(13)
    v_mfma_f32_16x16x32_bf16 v[128:131], v[80:83], v[96:99], v[128:131]
    s_waitcnt lgkmcnt(12)
    v_mfma_f32_16x16x32_bf16 v[132:135], v[84:87], v[96:99], v[132:135]
    s_waitcnt lgkmcnt(11)
    v_mfma_f32_16x16x32_bf16 v[136:139], v[88:91], v[96:99], v[136:139]
    s_waitcnt lgkmcnt(10)
    v_mfma_f32_16x16x32_bf16 v[140:143], v[92:95], v[96:99], v[140:143]
    s_waitcnt lgkmcnt(8)
    v_mfma_f32_16x16x32_bf16 v[144:147], v[80:83], v[100:103], v[144:147]
    v_mfma_f32_16x16x32_bf16 v[148:151], v[84:87], v[100:103], v[148:151]
    v_mfma_f32_16x16x32_bf16 v[152:155], v[88:91], v[100:103], v[152:155]
    v_mfma_f32_16x16x32_bf16 v[156:159], v[92:95], v[100:103], v[156:159]
    s_waitcnt lgkmcnt(6)
    v_mfma_f32_16x16x32_bf16 v[160:163], v[80:83], v[104:107], v[160:163]
    v_mfma_f32_16x16x32_bf16 v[164:167], v[84:87], v[104:107], v[164:167]
    v_mfma_f32_16x16x32_bf16 v[168:171], v[88:91], v[104:107], v[168:171]
    v_mfma_f32_16x16x32_bf16 v[172:175], v[92:95], v[104:107], v[172:175]
    s_waitcnt lgkmcnt(4)
    v_mfma_f32_16x16x32_bf16 v[176:179], v[80:83], v[108:111], v[176:179]
    v_mfma_f32_16x16x32_bf16 v[180:183], v[84:87], v[108:111], v[180:183]
    s_barrier
    v_mfma_f32_16x16x32_bf16 v[184:187], v[88:91], v[108:111], v[184:187]
    ds_read_b128 v[40:43], v26 offset:40960
    ds_read_b64_tr_b16 v[56:57], v28 offset:40960
    v_mfma_f32_16x16x32_bf16 v[188:191], v[92:95], v[108:111], v[188:191]
    ds_read_b64_tr_b16 v[58:59], v28 offset:42496
    ds_read_b128 v[44:47], v27 offset:41984
    s_waitcnt lgkmcnt(6)
    v_mfma_f32_16x16x32_bf16 v[192:195], v[80:83], v[112:115], v[192:195]
    ds_read_b128 v[48:51], v26 offset:45056
    ds_read_b128 v[52:55], v27 offset:46080
    v_mfma_f32_16x16x32_bf16 v[196:199], v[84:87], v[112:115], v[196:199]
    ds_read_b64_tr_b16 v[60:61], v29 offset:40960
    ds_read_b64_tr_b16 v[62:63], v29 offset:42496
    v_mfma_f32_16x16x32_bf16 v[200:203], v[88:91], v[112:115], v[200:203]
    ds_read_b64_tr_b16 v[64:65], v30 offset:40960
    ds_read_b64_tr_b16 v[66:67], v30 offset:42496
    v_mfma_f32_16x16x32_bf16 v[204:207], v[92:95], v[112:115], v[204:207]
    ds_read_b64_tr_b16 v[68:69], v31 offset:40960
    ds_read_b64_tr_b16 v[70:71], v31 offset:42496
    s_waitcnt lgkmcnt(12)
    v_mfma_f32_16x16x32_bf16 v[208:211], v[80:83], v[116:119], v[208:211]
    ds_read_b64_tr_b16 v[72:73], v28 offset:41088
    ds_read_b64_tr_b16 v[74:75], v28 offset:42624
    v_mfma_f32_16x16x32_bf16 v[212:215], v[84:87], v[116:119], v[212:215]
    ds_read_b64_tr_b16 v[76:77], v29 offset:41088
    v_mfma_f32_16x16x32_bf16 v[216:219], v[88:91], v[116:119], v[216:219]
    ds_read_b64_tr_b16 v[78:79], v29 offset:42624
    v_mfma_f32_16x16x32_bf16 v[220:223], v[92:95], v[116:119], v[220:223]
    s_waitcnt lgkmcnt(13)
    v_mfma_f32_16x16x32_bf16 v[128:131], v[40:43], v[56:59], v[128:131]
    s_waitcnt lgkmcnt(12)
    v_mfma_f32_16x16x32_bf16 v[132:135], v[44:47], v[56:59], v[132:135]
    s_waitcnt lgkmcnt(11)
    v_mfma_f32_16x16x32_bf16 v[136:139], v[48:51], v[56:59], v[136:139]
    s_waitcnt lgkmcnt(10)
    v_mfma_f32_16x16x32_bf16 v[140:143], v[52:55], v[56:59], v[140:143]
    s_waitcnt lgkmcnt(8)
    v_mfma_f32_16x16x32_bf16 v[144:147], v[40:43], v[60:63], v[144:147]
    v_mfma_f32_16x16x32_bf16 v[148:151], v[44:47], v[60:63], v[148:151]
    ds_read_b128 v[80:83], v27 offset:40960
    v_mfma_f32_16x16x32_bf16 v[152:155], v[48:51], v[60:63], v[152:155]
    ds_read_b64_tr_b16 v[96:97], v28 offset:53248
    v_mfma_f32_16x16x32_bf16 v[156:159], v[52:55], v[60:63], v[156:159]
    ds_read_b64_tr_b16 v[98:99], v28 offset:54784
    s_waitcnt lgkmcnt(9)
    v_mfma_f32_16x16x32_bf16 v[160:163], v[40:43], v[64:67], v[160:163]
    ds_read_b128 v[84:87], v26 offset:41984
    v_mfma_f32_16x16x32_bf16 v[164:167], v[44:47], v[64:67], v[164:167]
    ds_read_b128 v[88:91], v27 offset:45056
    v_mfma_f32_16x16x32_bf16 v[168:171], v[48:51], v[64:67], v[168:171]
    ds_read_b128 v[92:95], v26 offset:46080
    v_mfma_f32_16x16x32_bf16 v[172:175], v[52:55], v[64:67], v[172:175]
    ds_read_b64_tr_b16 v[100:101], v29 offset:53248
    s_waitcnt lgkmcnt(11)
    v_mfma_f32_16x16x32_bf16 v[176:179], v[40:43], v[68:71], v[176:179]
    ds_read_b64_tr_b16 v[102:103], v29 offset:54784
    v_mfma_f32_16x16x32_bf16 v[180:183], v[44:47], v[68:71], v[180:183]
    ds_read_b64_tr_b16 v[104:105], v30 offset:53248
    v_mfma_f32_16x16x32_bf16 v[184:187], v[48:51], v[68:71], v[184:187]
    ds_read_b64_tr_b16 v[106:107], v30 offset:54784
    v_mfma_f32_16x16x32_bf16 v[188:191], v[52:55], v[68:71], v[188:191]
    ds_read_b64_tr_b16 v[108:109], v31 offset:53248
    s_waitcnt lgkmcnt(13)
    v_mfma_f32_16x16x32_bf16 v[192:195], v[40:43], v[72:75], v[192:195]
    ds_read_b64_tr_b16 v[110:111], v31 offset:54784
    v_mfma_f32_16x16x32_bf16 v[196:199], v[44:47], v[72:75], v[196:199]
    ds_read_b64_tr_b16 v[112:113], v28 offset:53376
    v_mfma_f32_16x16x32_bf16 v[200:203], v[48:51], v[72:75], v[200:203]
    ds_read_b64_tr_b16 v[114:115], v28 offset:54912
    v_mfma_f32_16x16x32_bf16 v[204:207], v[52:55], v[72:75], v[204:207]
    ds_read_b64_tr_b16 v[116:117], v29 offset:53376
    s_waitcnt lgkmcnt(15)
    v_mfma_f32_16x16x32_bf16 v[208:211], v[40:43], v[76:79], v[208:211]
    ds_read_b64_tr_b16 v[118:119], v29 offset:54912
    v_mfma_f32_16x16x32_bf16 v[212:215], v[44:47], v[76:79], v[212:215]
    v_mfma_f32_16x16x32_bf16 v[216:219], v[48:51], v[76:79], v[216:219]
    v_mfma_f32_16x16x32_bf16 v[220:223], v[52:55], v[76:79], v[220:223]
    s_waitcnt lgkmcnt(13)
    v_mfma_f32_16x16x32_bf16 v[128:131], v[80:83], v[96:99], v[128:131]
    s_waitcnt lgkmcnt(12)
    v_mfma_f32_16x16x32_bf16 v[132:135], v[84:87], v[96:99], v[132:135]
    s_waitcnt lgkmcnt(11)
    v_mfma_f32_16x16x32_bf16 v[136:139], v[88:91], v[96:99], v[136:139]
    s_waitcnt lgkmcnt(10)
    v_mfma_f32_16x16x32_bf16 v[140:143], v[92:95], v[96:99], v[140:143]
    s_waitcnt lgkmcnt(8)
    v_mfma_f32_16x16x32_bf16 v[144:147], v[80:83], v[100:103], v[144:147]
    v_mfma_f32_16x16x32_bf16 v[148:151], v[84:87], v[100:103], v[148:151]
    v_mfma_f32_16x16x32_bf16 v[152:155], v[88:91], v[100:103], v[152:155]
    v_mfma_f32_16x16x32_bf16 v[156:159], v[92:95], v[100:103], v[156:159]
    s_waitcnt lgkmcnt(6)
    v_mfma_f32_16x16x32_bf16 v[160:163], v[80:83], v[104:107], v[160:163]
    v_mfma_f32_16x16x32_bf16 v[164:167], v[84:87], v[104:107], v[164:167]
    v_mfma_f32_16x16x32_bf16 v[168:171], v[88:91], v[104:107], v[168:171]
    v_mfma_f32_16x16x32_bf16 v[172:175], v[92:95], v[104:107], v[172:175]
    s_waitcnt lgkmcnt(4)
    v_mfma_f32_16x16x32_bf16 v[176:179], v[80:83], v[108:111], v[176:179]
    v_mfma_f32_16x16x32_bf16 v[180:183], v[84:87], v[108:111], v[180:183]
    s_waitcnt vmcnt(0)
    s_mov_b32 s72, 0
    v_readfirstlane_b32 s37, v12
    s_nop 3
    s_cmp_lg_u32 s37, 0
    s_cbranch_scc1 L_nonced_25
L_nonce_24:
    buffer_load_dword v12, off, s[48:51], 0 sc1
    s_waitcnt vmcnt(0)
    v_readfirstlane_b32 s37, v12
    s_add_u32 s72, s72, 1
    s_nop 2
    s_cmp_lg_u32 s37, 0
    s_cbranch_scc1 L_nonced_25
    s_sleep 1
    s_cmp_lt_u32 s72, 0x20000
    s_cbranch_scc1 L_nonce_24
L_nonced_25:
    s_barrier
    v_mfma_f32_16x16x32_bf16 v[184:187], v[88:91], v[108:111], v[184:187]
    ds_read_b128 v[40:43], v20 offset:0
    ds_read_b64_tr_b16 v[56:57], v22 offset:0
    v_mfma_f32_16x16x32_bf16 v[188:191], v[92:95], v[108:111], v[188:191]
    ds_read_b64_tr_b16 v[58:59], v22 offset:1536
    ds_read_b128 v[44:47], v21 offset:1024
    s_waitcnt lgkmcnt(6)
    v_mfma_f32_16x16x32_bf16 v[192:195], v[80:83], v[112:115], v[192:195]
    ds_read_b128 v[48:51], v20 offset:4096
    ds_read_b128 v[52:55], v21 offset:5120
    v_mfma_f32_16x16x32_bf16 v[196:199], v[84:87], v[112:115], v[196:199]
    ds_read_b64_tr_b16 v[60:61], v23 offset:0
    ds_read_b64_tr_b16 v[62:63], v23 offset:1536
    v_mfma_f32_16x16x32_bf16 v[200:203], v[88:91], v[112:115], v[200:203]
    ds_read_b64_tr_b16 v[64:65], v24 offset:0
    ds_read_b64_tr_b16 v[66:67], v24 offset:1536
    v_mfma_f32_16x16x32_bf16 v[204:207], v[92:95], v[112:115], v[204:207]
    ds_read_b64_tr_b16 v[68:69], v25 offset:0
    ds_read_b64_tr_b16 v[70:71], v25 offset:1536
    s_waitcnt lgkmcnt(12)
    v_mfma_f32_16x16x32_bf16 v[208:211], v[80:83], v[116:119], v[208:211]
    ds_read_b64_tr_b16 v[72:73], v22 offset:128
    ds_read_b64_tr_b16 v[74:75], v22 offset:1664
    v_mfma_f32_16x16x32_bf16 v[212:215], v[84:87], v[116:119], v[212:215]
    ds_read_b64_tr_b16 v[76:77], v23 offset:128
    v_mfma_f32_16x16x32_bf16 v[216:219], v[88:91], v[116:119], v[216:219]
    ds_read_b64_tr_b16 v[78:79], v23 offset:1664
    v_mfma_f32_16x16x32_bf16 v[220:223], v[92:95], v[116:119], v[220:223]
    s_waitcnt lgkmcnt(13)
    v_mfma_f32_16x16x32_bf16 v[128:131], v[40:43], v[56:59], v[128:131]
    s_waitcnt lgkmcnt(12)
    v_mfma_f32_16x16x32_bf16 v[132:135], v[44:47], v[56:59], v[132:135]
    s_waitcnt lgkmcnt(11)
    v_mfma_f32_16x16x32_bf16 v[136:139], v[48:51], v[56:59], v[136:139]
    s_waitcnt lgkmcnt(10)
    v_mfma_f32_16x16x32_bf16 v[140:143], v[52:55], v[56:59], v[140:143]
    s_waitcnt lgkmcnt(8)
    v_mfma_f32_16x16x32_bf16 v[144:147], v[40:43], v[60:63], v[144:147]
    v_mfma_f32_16x16x32_bf16 v[148:151], v[44:47], v[60:63], v[148:151]
    ds_read_b128 v[80:83], v21 offset:0
    v_mfma_f32_16x16x32_bf16 v[152:155], v[48:51], v[60:63], v[152:155]
    ds_read_b64_tr_b16 v[96:97], v22 offset:12288
    v_mfma_f32_16x16x32_bf16 v[156:159], v[52:55], v[60:63], v[156:159]
    ds_read_b64_tr_b16 v[98:99], v22 offset:13824
    s_waitcnt lgkmcnt(9)
    v_mfma_f32_16x16x32_bf16 v[160:163], v[40:43], v[64:67], v[160:163]
    ds_read_b128 v[84:87], v20 offset:1024
    v_mfma_f32_16x16x32_bf16 v[164:167], v[44:47], v[64:67], v[164:167]
    ds_read_b128 v[88:91], v21 offset:4096
    v_mfma_f32_16x16x32_bf16 v[168:171], v[48:51], v[64:67], v[168:171]
    ds_read_b128 v[92:95], v20 offset:5120
    v_mfma_f32_16x16x32_bf16 v[172:175], v[52:55], v[64:67], v[172:175]
    ds_read_b64_tr_b16 v[100:101], v23 offset:12288
    s_waitcnt lgkmcnt(11)
    v_mfma_f32_16x16x32_bf16 v[176:179], v[40:43], v[68:71], v[176:179]
    ds_read_b64_tr_b16 v[102:103], v23 offset:13824
    v_mfma_f32_16x16x32_bf16 v[180:183], v[44:47], v[68:71], v[180:183]
    ds_read_b64_tr_b16 v[104:105], v24 offset:12288
    v_mfma_f32_16x16x32_bf16 v[184:187], v[48:51], v[68:71], v[184:187]
    ds_read_b64_tr_b16 v[106:107], v24 offset:13824
    v_mfma_f32_16x16x32_bf16 v[188:191], v[52:55], v[68:71], v[188:191]
    ds_read_b64_tr_b16 v[108:109], v25 offset:12288
    s_waitcnt lgkmcnt(13)
    v_mfma_f32_16x16x32_bf16 v[192:195], v[40:43], v[72:75], v[192:195]
    ds_read_b64_tr_b16 v[110:111], v25 offset:13824
    v_mfma_f32_16x16x32_bf16 v[196:199], v[44:47], v[72:75], v[196:199]
    ds_read_b64_tr_b16 v[112:113], v22 offset:12416
    v_mfma_f32_16x16x32_bf16 v[200:203], v[48:51], v[72:75], v[200:203]
    ds_read_b64_tr_b16 v[114:115], v22 offset:13952
    v_mfma_f32_16x16x32_bf16 v[204:207], v[52:55], v[72:75], v[204:207]
    ds_read_b64_tr_b16 v[116:117], v23 offset:12416
    s_waitcnt lgkmcnt(15)
    v_mfma_f32_16x16x32_bf16 v[208:211], v[40:43], v[76:79], v[208:211]
    ds_read_b64_tr_b16 v[118:119], v23 offset:13952
    v_mfma_f32_16x16x32_bf16 v[212:215], v[44:47], v[76:79], v[212:215]
    v_mfma_f32_16x16x32_bf16 v[216:219], v[48:51], v[76:79], v[216:219]
    v_mfma_f32_16x16x32_bf16 v[220:223], v[52:55], v[76:79], v[220:223]
    s_waitcnt lgkmcnt(13)
    v_mfma_f32_16x16x32_bf16 v[128:131], v[80:83], v[96:99], v[128:131]
    s_waitcnt lgkmcnt(12)
    v_mfma_f32_16x16x32_bf16 v[132:135], v[84:87], v[96:99], v[132:135]
    s_waitcnt lgkmcnt(11)
    v_mfma_f32_16x16x32_bf16 v[136:139], v[88:91], v[96:99], v[136:139]
    s_waitcnt lgkmcnt(10)
    v_mfma_f32_16x16x32_bf16 v[140:143], v[92:95], v[96:99], v[140:143]
    s_waitcnt lgkmcnt(8)
    v_mfma_f32_16x16x32_bf16 v[144:147], v[80:83], v[100:103], v[144:147]
    v_mfma_f32_16x16x32_bf16 v[148:151], v[84:87], v[100:103], v[148:151]
    v_mfma_f32_16x16x32_bf16 v[152:155], v[88:91], v[100:103], v[152:155]
    v_mfma_f32_16x16x32_bf16 v[156:159], v[92:95], v[100:103], v[156:159]
    s_waitcnt lgkmcnt(6)
    v_mfma_f32_16x16x32_bf16 v[160:163], v[80:83], v[104:107], v[160:163]
    v_mfma_f32_16x16x32_bf16 v[164:167], v[84:87], v[104:107], v[164:167]
    v_mfma_f32_16x16x32_bf16 v[168:171], v[88:91], v[104:107], v[168:171]
    v_mfma_f32_16x16x32_bf16 v[172:175], v[92:95], v[104:107], v[172:175]
    s_waitcnt lgkmcnt(4)
    v_mfma_f32_16x16x32_bf16 v[176:179], v[80:83], v[108:111], v[176:179]
    v_mfma_f32_16x16x32_bf16 v[180:183], v[84:87], v[108:111], v[180:183]
    s_barrier
    v_mfma_f32_16x16x32_bf16 v[184:187], v[88:91], v[108:111], v[184:187]
    ds_read_b128 v[40:43], v20 offset:40960
    ds_read_b64_tr_b16 v[56:57], v22 offset:40960
    v_mfma_f32_16x16x32_bf16 v[188:191], v[92:95], v[108:111], v[188:191]
    ds_read_b64_tr_b16 v[58:59], v22 offset:42496
    ds_read_b128 v[44:47], v21 offset:41984
    s_waitcnt lgkmcnt(6)
    v_mfma_f32_16x16x32_bf16 v[192:195], v[80:83], v[112:115], v[192:195]
    ds_read_b128 v[48:51], v20 offset:45056
    ds_read_b128 v[52:55], v21 offset:46080
    v_mfma_f32_16x16x32_bf16 v[196:199], v[84:87], v[112:115], v[196:199]
    ds_read_b64_tr_b16 v[60:61], v23 offset:40960
    ds_read_b64_tr_b16 v[62:63], v23 offset:42496
    v_mfma_f32_16x16x32_bf16 v[200:203], v[88:91], v[112:115], v[200:203]
    ds_read_b64_tr_b16 v[64:65], v24 offset:40960
    ds_read_b64_tr_b16 v[66:67], v24 offset:42496
    v_mfma_f32_16x16x32_bf16 v[204:207], v[92:95], v[112:115], v[204:207]
    ds_read_b64_tr_b16 v[68:69], v25 offset:40960
    ds_read_b64_tr_b16 v[70:71], v25 offset:42496
    s_waitcnt lgkmcnt(12)
    v_mfma_f32_16x16x32_bf16 v[208:211], v[80:83], v[116:119], v[208:211]
    ds_read_b64_tr_b16 v[72:73], v22 offset:41088
    ds_read_b64_tr_b16 v[74:75], v22 offset:42624
    v_mfma_f32_16x16x32_bf16 v[212:215], v[84:87], v[116:119], v[212:215]
    ds_read_b64_tr_b16 v[76:77], v23 offset:41088
    v_mfma_f32_16x16x32_bf16 v[216:219], v[88:91], v[116:119], v[216:219]
    ds_read_b64_tr_b16 v[78:79], v23 offset:42624
    v_mfma_f32_16x16x32_bf16 v[220:223], v[92:95], v[116:119], v[220:223]
    s_waitcnt lgkmcnt(13)
    v_mfma_f32_16x16x32_bf16 v[128:131], v[40:43], v[56:59], v[128:131]
    ds_read_b128 v[80:83], v21 offset:40960
    ds_read_b64_tr_b16 v[96:97], v22 offset:53248
    s_waitcnt lgkmcnt(14)
    v_mfma_f32_16x16x32_bf16 v[132:135], v[44:47], v[56:59], v[132:135]
    ds_read_b64_tr_b16 v[98:99], v22 offset:54784
    ds_read_b128 v[84:87], v20 offset:41984
    s_waitcnt lgkmcnt(15)
    v_mfma_f32_16x16x32_bf16 v[136:139], v[48:51], v[56:59], v[136:139]
    ds_read_b128 v[88:91], v21 offset:45056
    s_waitcnt lgkmcnt(15)
    v_mfma_f32_16x16x32_bf16 v[140:143], v[52:55], v[56:59], v[140:143]
    ds_read_b128 v[92:95], v20 offset:46080
    s_waitcnt lgkmcnt(0)
    v_mfma_f32_16x16x32_bf16 v[128:131], v[80:83], v[96:99], v[128:131]
    ds_read_b64_tr_b16 v[100:101], v23 offset:53248
    ds_read_b64_tr_b16 v[102:103], v23 offset:54784
    ds_read_b64_tr_b16 v[104:105], v24 offset:53248
    v_mfma_f32_16x16x32_bf16 v[132:135], v[84:87], v[96:99], v[132:135]
    ds_read_b64_tr_b16 v[106:107], v24 offset:54784
    ds_read_b64_tr_b16 v[108:109], v25 offset:53248
    ds_read_b64_tr_b16 v[110:111], v25 offset:54784
    v_mfma_f32_16x16x32_bf16 v[136:139], v[88:91], v[96:99], v[136:139]
    ds_read_b64_tr_b16 v[112:113], v22 offset:53376
    ds_read_b64_tr_b16 v[114:115], v22 offset:54912
    ds_read_b64_tr_b16 v[116:117], v23 offset:53376
    v_mfma_f32_16x16x32_bf16 v[140:143], v[92:95], v[96:99], v[140:143]
    ds_read_b64_tr_b16 v[118:119], v23 offset:54912
    v_mfma_f32_16x16x32_bf16 v[144:147], v[40:43], v[60:63], v[144:147]
    v_mfma_f32_16x16x32_bf16 v[148:151], v[44:47], v[60:63], v[148:151]
    v_mfma_f32_16x16x32_bf16 v[152:155], v[48:51], v[60:63], v[152:155]
    v_mfma_f32_16x16x32_bf16 v[156:159], v[52:55], v[60:63], v[156:159]
    s_waitcnt lgkmcnt(8)
    v_mfma_f32_16x16x32_bf16 v[144:147], v[80:83], v[100:103], v[144:147]
    v_mfma_f32_16x16x32_bf16 v[148:151], v[84:87], v[100:103], v[148:151]
    v_mfma_f32_16x16x32_bf16 v[152:155], v[88:91], v[100:103], v[152:155]
    v_mfma_f32_16x16x32_bf16 v[156:159], v[92:95], v[100:103], v[156:159]
    s_cmp_lg_u32 s52, 0
    s_cbranch_scc1 L_nosc0
    v_pk_mul_f32 v[128:129], v[128:129], s[58:59]
    v_pk_mul_f32 v[130:131], v[130:131], s[58:59]
    v_pk_mul_f32 v[132:133], v[132:133], s[58:59]
    v_pk_mul_f32 v[134:135], v[134:135], s[58:59]
    v_pk_mul_f32 v[136:137], v[136:137], s[58:59]
    v_pk_mul_f32 v[138:139], v[138:139], s[58:59]
    v_pk_mul_f32 v[140:141], v[140:141], s[58:59]
    v_pk_mul_f32 v[142:143], v[142:143], s[58:59]
L_nosc0:
    v_cvt_pk_bf16_f32 v240, v128, v129
    v_cvt_pk_bf16_f32 v241, v130, v131
    v_cvt_pk_bf16_f32 v242, v132, v133
    v_cvt_pk_bf16_f32 v243, v134, v135
    buffer_store_dwordx4 v[240:243], v224, s[20:23], 0 offen offset:0 sc0 sc1
    v_cvt_pk_bf16_f32 v244, v136, v137
    v_cvt_pk_bf16_f32 v245, v138, v139
    v_cvt_pk_bf16_f32 v246, v140, v141
    v_cvt_pk_bf16_f32 v247, v142, v143
    buffer_store_dwordx4 v[244:247], v224, s[20:23], 0 offen offset:1280 sc0 sc1
    v_mfma_f32_16x16x32_bf16 v[160:163], v[40:43], v[64:67], v[160:163]
    v_mfma_f32_16x16x32_bf16 v[164:167], v[44:47], v[64:67], v[164:167]
    v_mfma_f32_16x16x32_bf16 v[168:171], v[48:51], v[64:67], v[168:171]
    v_mfma_f32_16x16x32_bf16 v[172:175], v[52:55], v[64:67], v[172:175]
    s_waitcnt lgkmcnt(0)
    v_mfma_f32_16x16x32_bf16 v[160:163], v[80:83], v[104:107], v[160:163]
    v_mfma_f32_16x16x32_bf16 v[164:167], v[84:87], v[104:107], v[164:167]
    v_mfma_f32_16x16x32_bf16 v[168:171], v[88:91], v[104:107], v[168:171]
    v_mfma_f32_16x16x32_bf16 v[172:175], v[92:95], v[104:107], v[172:175]
    s_cmp_lg_u32 s53, 0
    s_cbranch_scc1 L_nosc1
    v_pk_mul_f32 v[144:145], v[144:145], s[58:59]
    v_pk_mul_f32 v[146:147], v[146:147], s[58:59]
    v_pk_mul_f32 v[148:149], v[148:149], s[58:59]
    v_pk_mul_f32 v[150:151], v[150:151], s[58:59]
    v_pk_mul_f32 v[152:153], v[152:153], s[58:59]
    v_pk_mul_f32 v[154:155], v[154:155], s[58:59]
    v_pk_mul_f32 v[156:157], v[156:157], s[58:59]
    v_pk_mul_f32 v[158:159], v[158:159], s[58:59]
L_nosc1:
    v_cvt_pk_bf16_f32 v232, v144, v145
    v_cvt_pk_bf16_f32 v233, v146, v147
    v_cvt_pk_bf16_f32 v234, v148, v149
    v_cvt_pk_bf16_f32 v235, v150, v151
    buffer_store_dwordx4 v[232:235], v225, s[20:23], 0 offen offset:0 sc0 sc1
    v_cvt_pk_bf16_f32 v236, v152, v153
    v_cvt_pk_bf16_f32 v237, v154, v155
    v_cvt_pk_bf16_f32 v238, v156, v157
    v_cvt_pk_bf16_f32 v239, v158, v159
    buffer_store_dwordx4 v[236:239], v225, s[20:23], 0 offen offset:1280 sc0 sc1
    v_mfma_f32_16x16x32_bf16 v[176:179], v[40:43], v[68:71], v[176:179]
    v_mfma_f32_16x16x32_bf16 v[180:183], v[44:47], v[68:71], v[180:183]
    v_mfma_f32_16x16x32_bf16 v[184:187], v[48:51], v[68:71], v[184:187]
    v_mfma_f32_16x16x32_bf16 v[188:191], v[52:55], v[68:71], v[188:191]
    v_mfma_f32_16x16x32_bf16 v[176:179], v[80:83], v[108:111], v[176:179]
    v_mfma_f32_16x16x32_bf16 v[180:183], v[84:87], v[108:111], v[180:183]
    v_mfma_f32_16x16x32_bf16 v[184:187], v[88:91], v[108:111], v[184:187]
    v_mfma_f32_16x16x32_bf16 v[188:191], v[92:95], v[108:111], v[188:191]
    s_cmp_lg_u32 s54, 0
    s_cbranch_scc1 L_nosc2
    v_pk_mul_f32 v[160:161], v[160:161], s[58:59]
    v_pk_mul_f32 v[162:163], v[162:163], s[58:59]
    v_pk_mul_f32 v[164:165], v[164:165], s[58:59]
    v_pk_mul_f32 v[166:167], v[166:167], s[58:59]
    v_pk_mul_f32 v[168:169], v[168:169], s[58:59]
    v_pk_mul_f32 v[170:171], v[170:171], s[58:59]
    v_pk_mul_f32 v[172:173], v[172:173], s[58:59]
    v_pk_mul_f32 v[174:175], v[174:175], s[58:59]
L_nosc2:
    v_cvt_pk_bf16_f32 v240, v160, v161
    v_cvt_pk_bf16_f32 v241, v162, v163
    v_cvt_pk_bf16_f32 v242, v164, v165
    v_cvt_pk_bf16_f32 v243, v166, v167
    buffer_store_dwordx4 v[240:243], v226, s[20:23], 0 offen offset:0 sc0 sc1
    v_cvt_pk_bf16_f32 v244, v168, v169
    v_cvt_pk_bf16_f32 v245, v170, v171
    v_cvt_pk_bf16_f32 v246, v172, v173
    v_cvt_pk_bf16_f32 v247, v174, v175
    buffer_store_dwordx4 v[244:247], v226, s[20:23], 0 offen offset:1280 sc0 sc1
    v_mfma_f32_16x16x32_bf16 v[192:195], v[40:43], v[72:75], v[192:195]
    v_mfma_f32_16x16x32_bf16 v[196:199], v[44:47], v[72:75], v[196:199]
    v_mfma_f32_16x16x32_bf16 v[200:203], v[48:51], v[72:75], v[200:203]
    v_mfma_f32_16x16x32_bf16 v[204:207], v[52:55], v[72:75], v[204:207]
    v_mfma_f32_16x16x32_bf16 v[192:195], v[80:83], v[112:115], v[192:195]
    v_mfma_f32_16x16x32_bf16 v[196:199], v[84:87], v[112:115], v[196:199]
    v_mfma_f32_16x16x32_bf16 v[200:203], v[88:91], v[112:115], v[200:203]
    v_mfma_f32_16x16x32_bf16 v[204:207], v[92:95], v[112:115], v[204:207]
    s_cmp_lg_u32 s55, 0
    s_cbranch_scc1 L_nosc3
    v_pk_mul_f32 v[176:177], v[176:177], s[58:59]
    v_pk_mul_f32 v[178:179], v[178:179], s[58:59]
    v_pk_mul_f32 v[180:181], v[180:181], s[58:59]
    v_pk_mul_f32 v[182:183], v[182:183], s[58:59]
    v_pk_mul_f32 v[184:185], v[184:185], s[58:59]
    v_pk_mul_f32 v[186:187], v[186:187], s[58:59]
    v_pk_mul_f32 v[188:189], v[188:189], s[58:59]
    v_pk_mul_f32 v[190:191], v[190:191], s[58:59]
L_nosc3:
    v_cvt_pk_bf16_f32 v232, v176, v177
    v_cvt_pk_bf16_f32 v233, v178, v179
    v_cvt_pk_bf16_f32 v234, v180, v181
    v_cvt_pk_bf16_f32 v235, v182, v183
    buffer_store_dwordx4 v[232:235], v227, s[20:23], 0 offen offset:0 sc0 sc1
    v_cvt_pk_bf16_f32 v236, v184, v185
    v_cvt_pk_bf16_f32 v237, v186, v187
    v_cvt_pk_bf16_f32 v238, v188, v189
    v_cvt_pk_bf16_f32 v239, v190, v191
    buffer_store_dwordx4 v[236:239], v227, s[20:23], 0 offen offset:1280 sc0 sc1
    v_mfma_f32_16x16x32_bf16 v[208:211], v[40:43], v[76:79], v[208:211]
    v_mfma_f32_16x16x32_bf16 v[212:215], v[44:47], v[76:79], v[212:215]
    v_mfma_f32_16x16x32_bf16 v[216:219], v[48:51], v[76:79], v[216:219]
    v_mfma_f32_16x16x32_bf16 v[220:223], v[52:55], v[76:79], v[220:223]
    v_mfma_f32_16x16x32_bf16 v[208:211], v[80:83], v[116:119], v[208:211]
    v_mfma_f32_16x16x32_bf16 v[212:215], v[84:87], v[116:119], v[212:215]
    v_mfma_f32_16x16x32_bf16 v[216:219], v[88:91], v[116:119], v[216:219]
    v_mfma_f32_16x16x32_bf16 v[220:223], v[92:95], v[116:119], v[220:223]
    s_cmp_lg_u32 s56, 0
    s_cbranch_scc1 L_nosc4
    v_pk_mul_f32 v[192:193], v[192:193], s[58:59]
    v_pk_mul_f32 v[194:195], v[194:195], s[58:59]
    v_pk_mul_f32 v[196:197], v[196:197], s[58:59]
    v_pk_mul_f32 v[198:199], v[198:199], s[58:59]
    v_pk_mul_f32 v[200:201], v[200:201], s[58:59]
    v_pk_mul_f32 v[202:203], v[202:203], s[58:59]
    v_pk_mul_f32 v[204:205], v[204:205], s[58:59]
    v_pk_mul_f32 v[206:207], v[206:207], s[58:59]
L_nosc4:
    v_cvt_pk_bf16_f32 v240, v192, v193
    v_cvt_pk_bf16_f32 v241, v194, v195
    v_cvt_pk_bf16_f32 v242, v196, v197
    v_cvt_pk_bf16_f32 v243, v198, v199
    buffer_store_dwordx4 v[240:243], v228, s[20:23], 0 offen offset:0 sc0 sc1
    v_cvt_pk_bf16_f32 v244, v200, v201
    v_cvt_pk_bf16_f32 v245, v202, v203
    v_cvt_pk_bf16_f32 v246, v204, v205
    v_cvt_pk_bf16_f32 v247, v206, v207
    buffer_store_dwordx4 v[244:247], v228, s[20:23], 0 offen offset:1280 sc0 sc1
    s_cmp_lg_u32 s57, 0
    s_cbranch_scc1 L_nosc5
    v_pk_mul_f32 v[208:209], v[208:209], s[58:59]
    v_pk_mul_f32 v[210:211], v[210:211], s[58:59]
    v_pk_mul_f32 v[212:213], v[212:213], s[58:59]
    v_pk_mul_f32 v[214:215], v[214:215], s[58:59]
    v_pk_mul_f32 v[216:217], v[216:217], s[58:59]
    v_pk_mul_f32 v[218:219], v[218:219], s[58:59]
    v_pk_mul_f32 v[220:221], v[220:221], s[58:59]
    v_pk_mul_f32 v[222:223], v[222:223], s[58:59]
L_nosc5:
    v_cvt_pk_bf16_f32 v232, v208, v209
    v_cvt_pk_bf16_f32 v233, v210, v211
    v_cvt_pk_bf16_f32 v234, v212, v213
    v_cvt_pk_bf16_f32 v235, v214, v215
    buffer_store_dwordx4 v[232:235], v229, s[20:23], 0 offen offset:0 sc0 sc1
    v_cvt_pk_bf16_f32 v236, v216, v217
    v_cvt_pk_bf16_f32 v237, v218, v219
    v_cvt_pk_bf16_f32 v238, v220, v221
    v_cvt_pk_bf16_f32 v239, v222, v223
    buffer_store_dwordx4 v[236:239], v229, s[20:23], 0 offen offset:1280 sc0 sc1
    s_mov_b32 s40, 0x000fffff
    s_mov_b32 s41, 0x000fffff
    v_bfe_u32 v8, v2, 4, 1
    v_mul_u32_u24 v8, 640, v8
    v_bfe_u32 v9, v2, 2, 2
    v_lshl_add_u32 v8, v9, 5, v8
    v_and_b32 v9, 1, v2
    v_lshl_add_u32 v8, v9, 4, v8
    v_bfe_u32 v9, v2, 1, 1
    v_lshl_add_u32 v8, v9, 3, v8
    v_add_u32 v121, 512, v8
    v_lshrrev_b32 v9, 5, v2
    v_mul_u32_u24 v10, 1280, v9
    v_add_u32 v105, v10, v121
    v_lshl_add_u32 v104, v9, 8, v8
    v_and_b32 v10, 31, v2
    v_lshlrev_b32 v11, 4, v9
    v_lshl_add_u32 v11, v10, 5, v11
    v_add_u32 v106, 10240, v11
    s_mul_i32 s30, s39, 81920
    s_lshl_b32 s31, s42, 3
    s_add_u32 s31, s31, s29
    s_mul_i32 s31, s31, 1280
    s_add_u32 s30, s30, s31
    v_lshlrev_b32 v11, 3, v9
    v_lshl_add_u32 v11, v10, 4, v11
    v_add_u32 v114, s30, v11
    v_lshlrev_b32 v11, 3, v10
    v_add_u32 v11, s30, v11
    v_mov_b32 v8, 0x7f000000
    v_cmp_gt_u32 vcc, 32, v2
    s_mul_i32 s30, s29, 1280
    s_add_u32 s30, s30, 147456
    v_cndmask_b32 v115, v8, v11, vcc
    v_add_u32 v120, s30, v104
    v_add_u32 v121, s30, v121
    s_mul_i32 s30, s27, 192
    s_mul_i32 s31, s30, 3277
    s_lshr_b32 s31, s31, 16
    s_add_u32 s30, s30, 192
    v_add_u32 v8, s31, v2
    v_mul_u32_u24 v10, 20, v8
    v_cmp_gt_u32 vcc, s30, v10
    v_and_b32 v8, 31, v8
    v_mul_u32_u24 v8, 4352, v8
    v_mov_b32 v9, 0x7f000000
    v_cndmask_b32 v12, v9, v8, vcc
    s_waitcnt vmcnt(0)
    s_barrier
    s_cmp_lg_u32 s29, 0
    s_cbranch_scc1 L_w4_26
    v_mov_b32 v13, 1
    buffer_atomic_add v13, v12, s[44:47], 0 offen sc1
L_w4_26:
L_comp_tail:
    s_barrier
    v_and_b32 v116, 27, v2
    v_cmp_eq_u32 vcc, 24, v116
    v_mov_b32 v116, 0x3f803f80
    v_mov_b32 v40, 0
    v_mov_b32 v41, 0
    v_mov_b32 v42, 0
    v_mov_b32 v43, 0
    v_mov_b32 v44, 0
    v_mov_b32 v45, 0
    v_mov_b32 v46, 0
    v_mov_b32 v47, 0
    v_cndmask_b32 v92, 0, v116, vcc
    v_cndmask_b32 v93, 0, v116, vcc
    v_cndmask_b32 v94, 0, v116, vcc
    v_cndmask_b32 v95, 0, v116, vcc
    v_cndmask_b32 v108, 0, v116, vcc
    v_cndmask_b32 v109, 0, v116, vcc
    v_cndmask_b32 v110, 0, v116, vcc
    v_cndmask_b32 v111, 0, v116, vcc
    v_cndmask_b32 v96, 0, v116, vcc
    v_cndmask_b32 v97, 0, v116, vcc
    v_cndmask_b32 v98, 0, v116, vcc
    v_cndmask_b32 v99, 0, v116, vcc
    v_cndmask_b32 v12, 0, v116, vcc
    v_cndmask_b32 v13, 0, v116, vcc
    v_cndmask_b32 v14, 0, v116, vcc
    v_cndmask_b32 v15, 0, v116, vcc
    v_cndmask_b32 v100, 0, v116, vcc
    v_cndmask_b32 v101, 0, v116, vcc
    v_cndmask_b32 v102, 0, v116, vcc
    v_cndmask_b32 v103, 0, v116, vcc
    v_mov_b32 v48, 0
    v_mov_b32 v49, 0
    v_mov_b32 v50, 0
    v_mov_b32 v51, 0
    v_mov_b32 v52, 0
    v_mov_b32 v53, 0
    v_mov_b32 v54, 0
    v_mov_b32 v55, 0
    v_mov_b32 v56, 0
    v_mov_b32 v57, 0
    v_mov_b32 v58, 0
    v_mov_b32 v59, 0
    v_mov_b32 v60, 0
    v_mov_b32 v61, 0
    v_mov_b32 v62, 0
    v_mov_b32 v63, 0
    s_mov_b32 s43, 0
    s_mov_b32 s12, 10
    s_cmp_lt_u32 s29, 2
    s_cselect_b32 s13, 5, 1
    s_cmp_ge_u32 s29, 4
    s_cselect_b32 s13, 5, s13
    s_cselect_b32 s14, 0, 2
    s_cselect_b32 s15, 1, 0
    s_cmp_eq_u32 s36, 1
    s_cselect_b32 s14, s14, 0
    s_or_b32 s14, s14, s15
    s_cmp_eq_u32 s29, 4
    s_cselect_b32 s15, 4, 0
    s_or_b32 s14, s14, s15
    s_cmp_eq_u32 s36, 2
    s_cselect_b32 s15, 2, 0
    s_or_b32 s14, s14, s15
    s_cmp_ge_u32 s29, 4
    s_cselect_b32 s15, 8, 0
    s_cmp_eq_u32 s36, 0
    s_cselect_b32 s15, s15, 0
    s_or_b32 s14, s14, s15
L_comp_tail2:
    s_barrier
L_att:
    s_setprio 3
    ds_read_b64_tr_b16 v[84:85], v121
    ds_read_b64_tr_b16 v[80:81], v120
    ds_read_b64_tr_b16 v[82:83], v120 offset:128
    ds_read_b64_tr_b16 v[86:87], v105 offset:0
    ds_read_b64_tr_b16 v[88:89], v104 offset:0
    ds_read_b64_tr_b16 v[90:91], v104 offset:128
    s_mov_b32 vcc_lo, -1
    s_mov_b32 vcc_hi, 0
    s_waitcnt lgkmcnt(3)
    v_cndmask_b32 v112, v84, 0, vcc
    v_cndmask_b32 v84, 0, v84, vcc
    v_cndmask_b32 v113, v85, 0, vcc
    v_cndmask_b32 v85, 0, v85, vcc
    s_waitcnt lgkmcnt(0)
    s_nop 0
    v_mfma_f32_32x32x8_bf16 v[16:31], v[86:87], v[84:85], 0
    v_mfma_f32_32x32x16_bf16 v[16:31], v[88:91], v[80:83], v[16:31]
    ds_read_b64_tr_b16 v[8:9], v104 offset:1280
    ds_read_b64_tr_b16 v[10:11], v104 offset:1408
    s_mov_b64 exec, s[40:41]
    ds_read_b128 v[92:95], v106 offset:0
    ds_read_b128 v[108:111], v106 offset:640
    s_mov_b64 exec, -1
    s_nop 5
    v_max3_f32 v64, v16, v17, v18
    v_max3_f32 v64, v64, v19, v20
    v_max3_f32 v64, v64, v21, v22
    v_max3_f32 v64, v64, v23, v24
    v_max3_f32 v64, v64, v25, v26
    v_max3_f32 v64, v64, v27, v28
    v_max3_f32 v64, v64, v29, v30
    v_max_f32 v64, v64, v31
    v_mov_b32 v119, v64
    s_nop 1
    v_permlane32_swap_b32 v119, v64
    s_nop 1
    v_max_f32 v64, v64, v119
    v_sub_f32 v64, 0, v64
    v_pk_add_f32 v[16:17], v[16:17], v[64:65] op_sel:[0,0] op_sel_hi:[1,0]
    v_pk_add_f32 v[18:19], v[18:19], v[64:65] op_sel:[0,0] op_sel_hi:[1,0]
    v_pk_add_f32 v[20:21], v[20:21], v[64:65] op_sel:[0,0] op_sel_hi:[1,0]
    v_pk_add_f32 v[22:23], v[22:23], v[64:65] op_sel:[0,0] op_sel_hi:[1,0]
    v_pk_add_f32 v[24:25], v[24:25], v[64:65] op_sel:[0,0] op_sel_hi:[1,0]
    v_pk_add_f32 v[26:27], v[26:27], v[64:65] op_sel:[0,0] op_sel_hi:[1,0]
    v_pk_add_f32 v[28:29], v[28:29], v[64:65] op_sel:[0,0] op_sel_hi:[1,0]
    v_pk_add_f32 v[30:31], v[30:31], v[64:65] op_sel:[0,0] op_sel_hi:[1,0]
    v_pk_mov_b32 v[78:79], v[64:65], v[64:65] op_sel:[0,0]
    v_pk_mov_b32 v[76:77], v[64:65], v[64:65] op_sel:[0,0]
    v_pk_mov_b32 v[74:75], v[64:65], v[64:65] op_sel:[0,0]
    v_pk_mov_b32 v[72:73], v[64:65], v[64:65] op_sel:[0,0]
    v_pk_mov_b32 v[70:71], v[64:65], v[64:65] op_sel:[0,0]
    v_pk_mov_b32 v[68:69], v[64:65], v[64:65] op_sel:[0,0]
    v_pk_mov_b32 v[66:67], v[64:65], v[64:65] op_sel:[0,0]
    v_pk_mov_b32 v[64:65], v[64:65], v[64:65] op_sel:[0,0]
    s_waitcnt lgkmcnt(0)
    s_cmp_ge_u32 s29, 4
    s_cbranch_scc1 L_first
    s_setprio 2
    s_branch L_first
    .p2align 6
L_att_loop:
    s_bitcmp1_b32 s12, s43
    s_cbranch_scc1 L_h0
L_r0:
    s_setprio 3
L_first:
    v_cvt_pk_bf16_f32 v42, v44, v45
    v_cvt_pk_bf16_f32 v43, v46, v47
    v_exp_f32 v16, v16
    v_exp_f32 v17, v17
    v_exp_f32 v18, v18
    v_mfma_f32_32x32x16_bf16 v[48:63], v[96:99], v[40:43], v[48:63]
    v_exp_f32 v19, v19
    v_exp_f32 v20, v20
    v_exp_f32 v21, v21
    v_exp_f32 v22, v22
    v_mfma_f32_32x32x8_bf16 v[32:47], v[86:87], v[112:113], v[64:79]
    v_exp_f32 v23, v23
    v_exp_f32 v24, v24
    v_exp_f32 v25, v25
    v_exp_f32 v26, v26
    v_mfma_f32_32x32x16_bf16 v[32:47], v[8:11], v[80:83], v[32:47]
    ds_read_b64_tr_b16 v[86:87], v105 offset:2560
    ds_read_b64_tr_b16 v[88:89], v104 offset:2560
    ds_read_b64_tr_b16 v[90:91], v104 offset:2688
    ds_read_b64_tr_b16 v[8:9], v104 offset:3840
    ds_read_b64_tr_b16 v[10:11], v104 offset:3968
    v_cvt_pk_bf16_f32 v16, v16, v17
    v_cvt_pk_bf16_f32 v17, v18, v19
    v_cvt_pk_bf16_f32 v18, v20, v21
    v_cvt_pk_bf16_f32 v19, v22, v23
    v_exp_f32 v27, v27
    v_exp_f32 v28, v28
    v_exp_f32 v29, v29
    v_mfma_f32_32x32x16_bf16 v[48:63], v[92:95], v[16:19], v[48:63]
    v_exp_f32 v30, v30
    v_exp_f32 v31, v31
    s_mov_b64 exec, s[40:41]
    ds_read_b128 v[12:15], v106 offset:1280
    ds_read_b128 v[96:99], v106 offset:1920
    ds_read_b128 v[92:95], v106 offset:2560
    ds_read_b128 v[100:103], v106 offset:3200
    s_mov_b64 exec, -1
    v_cvt_pk_bf16_f32 v24, v24, v25
    v_cvt_pk_bf16_f32 v25, v26, v27
    v_cvt_pk_bf16_f32 v26, v28, v29
    v_cvt_pk_bf16_f32 v27, v30, v31
    v_exp_f32 v32, v32
    v_exp_f32 v33, v33
    v_exp_f32 v34, v34
    v_mfma_f32_32x32x16_bf16 v[48:63], v[108:111], v[24:27], v[48:63]
    v_exp_f32 v35, v35
    v_exp_f32 v36, v36
    v_exp_f32 v37, v37
    v_exp_f32 v38, v38
    s_waitcnt lgkmcnt(0)
    v_mfma_f32_32x32x8_bf16 v[16:31], v[86:87], v[84:85], v[64:79]
    v_exp_f32 v39, v39
    v_exp_f32 v40, v40
    v_exp_f32 v41, v41
    v_exp_f32 v42, v42
    v_mfma_f32_32x32x16_bf16 v[16:31], v[88:91], v[80:83], v[16:31]
    v_cvt_pk_bf16_f32 v32, v32, v33
    v_cvt_pk_bf16_f32 v33, v34, v35
    v_cvt_pk_bf16_f32 v34, v36, v37
    v_cvt_pk_bf16_f32 v35, v38, v39
    v_exp_f32 v43, v43
    v_exp_f32 v44, v44
    v_exp_f32 v45, v45
    v_mfma_f32_32x32x16_bf16 v[48:63], v[12:15], v[32:35], v[48:63]
    v_exp_f32 v46, v46
    v_exp_f32 v47, v47
    v_cvt_pk_bf16_f32 v40, v40, v41
    v_cvt_pk_bf16_f32 v41, v42, v43
    v_cvt_pk_bf16_f32 v42, v44, v45
    v_cvt_pk_bf16_f32 v43, v46, v47
    v_exp_f32 v16, v16
    v_exp_f32 v17, v17
    v_exp_f32 v18, v18
    v_mfma_f32_32x32x16_bf16 v[48:63], v[96:99], v[40:43], v[48:63]
    v_exp_f32 v19, v19
    v_exp_f32 v20, v20
    v_exp_f32 v21, v21
    v_exp_f32 v22, v22
    v_mfma_f32_32x32x8_bf16 v[32:47], v[86:87], v[112:113], v[64:79]
    v_exp_f32 v23, v23
    v_exp_f32 v24, v24
    v_exp_f32 v25, v25
    v_exp_f32 v26, v26
    v_mfma_f32_32x32x16_bf16 v[32:47], v[8:11], v[80:83], v[32:47]
    ds_read_b64_tr_b16 v[86:87], v105 offset:5120
    ds_read_b64_tr_b16 v[88:89], v104 offset:5120
    ds_read_b64_tr_b16 v[90:91], v104 offset:5248
    ds_read_b64_tr_b16 v[8:9], v104 offset:6400
    ds_read_b64_tr_b16 v[10:11], v104 offset:6528
    v_cvt_pk_bf16_f32 v16, v16, v17
    v_cvt_pk_bf16_f32 v17, v18, v19
    v_cvt_pk_bf16_f32 v18, v20, v21
    v_cvt_pk_bf16_f32 v19, v22, v23
    v_exp_f32 v27, v27
    v_exp_f32 v28, v28
    v_exp_f32 v29, v29
    v_mfma_f32_32x32x16_bf16 v[48:63], v[92:95], v[16:19], v[48:63]
    v_exp_f32 v30, v30
    v_exp_f32 v31, v31
    s_mov_b64 exec, s[40:41]
    ds_read_b128 v[12:15], v106 offset:3840
    ds_read_b128 v[96:99], v106 offset:4480
    ds_read_b128 v[92:95], v106 offset:5120
    ds_read_b128 v[108:111], v106 offset:5760
    s_mov_b64 exec, -1
    v_cvt_pk_bf16_f32 v24, v24, v25
    v_cvt_pk_bf16_f32 v25, v26, v27
    v_cvt_pk_bf16_f32 v26, v28, v29
    v_cvt_pk_bf16_f32 v27, v30, v31
    v_exp_f32 v32, v32
    v_exp_f32 v33, v33
    v_exp_f32 v34, v34
    v_mfma_f32_32x32x16_bf16 v[48:63], v[100:103], v[24:27], v[48:63]
    v_exp_f32 v35, v35
    v_exp_f32 v36, v36
    v_exp_f32 v37, v37
    v_exp_f32 v38, v38
    s_waitcnt lgkmcnt(0)
    v_mfma_f32_32x32x8_bf16 v[16:31], v[86:87], v[84:85], v[64:79]
    v_exp_f32 v39, v39
    v_exp_f32 v40, v40
    v_exp_f32 v41, v41
    v_exp_f32 v42, v42
    v_mfma_f32_32x32x16_bf16 v[16:31], v[88:91], v[80:83], v[16:31]
    v_cvt_pk_bf16_f32 v32, v32, v33
    v_cvt_pk_bf16_f32 v33, v34, v35
    v_cvt_pk_bf16_f32 v34, v36, v37
    v_cvt_pk_bf16_f32 v35, v38, v39
    v_exp_f32 v43, v43
    v_exp_f32 v44, v44
    v_exp_f32 v45, v45
    v_mfma_f32_32x32x16_bf16 v[48:63], v[12:15], v[32:35], v[48:63]
    v_exp_f32 v46, v46
    v_exp_f32 v47, v47
    v_cvt_pk_bf16_f32 v40, v40, v41
    v_cvt_pk_bf16_f32 v41, v42, v43
    v_cvt_pk_bf16_f32 v42, v44, v45
    v_cvt_pk_bf16_f32 v43, v46, v47
    v_exp_f32 v16, v16
    v_exp_f32 v17, v17
    v_exp_f32 v18, v18
    v_mfma_f32_32x32x16_bf16 v[48:63], v[96:99], v[40:43], v[48:63]
    v_exp_f32 v19, v19
    v_exp_f32 v20, v20
    v_exp_f32 v21, v21
    v_exp_f32 v22, v22
    v_mfma_f32_32x32x8_bf16 v[32:47], v[86:87], v[112:113], v[64:79]
    v_exp_f32 v23, v23
    v_exp_f32 v24, v24
    v_exp_f32 v25, v25
    v_exp_f32 v26, v26
    v_mfma_f32_32x32x16_bf16 v[32:47], v[8:11], v[80:83], v[32:47]
    ds_read_b64_tr_b16 v[86:87], v105 offset:7680
    ds_read_b64_tr_b16 v[88:89], v104 offset:7680
    ds_read_b64_tr_b16 v[90:91], v104 offset:7808
    ds_read_b64_tr_b16 v[8:9], v104 offset:8960
    ds_read_b64_tr_b16 v[10:11], v104 offset:9088
    v_cvt_pk_bf16_f32 v16, v16, v17
    v_cvt_pk_bf16_f32 v17, v18, v19
    v_cvt_pk_bf16_f32 v18, v20, v21
    v_cvt_pk_bf16_f32 v19, v22, v23
    v_exp_f32 v27, v27
    v_exp_f32 v28, v28
    v_exp_f32 v29, v29
    v_mfma_f32_32x32x16_bf16 v[48:63], v[92:95], v[16:19], v[48:63]
    v_exp_f32 v30, v30
    v_exp_f32 v31, v31
    s_mov_b64 exec, s[40:41]
    ds_read_b128 v[12:15], v106 offset:6400
    ds_read_b128 v[96:99], v106 offset:7040
    ds_read_b128 v[92:95], v106 offset:7680
    ds_read_b128 v[100:103], v106 offset:8320
    s_mov_b64 exec, -1
    v_cvt_pk_bf16_f32 v24, v24, v25
    v_cvt_pk_bf16_f32 v25, v26, v27
    v_cvt_pk_bf16_f32 v26, v28, v29
    v_cvt_pk_bf16_f32 v27, v30, v31
    v_exp_f32 v32, v32
    v_exp_f32 v33, v33
    v_exp_f32 v34, v34
    v_mfma_f32_32x32x16_bf16 v[48:63], v[108:111], v[24:27], v[48:63]
    v_exp_f32 v35, v35
    v_exp_f32 v36, v36
    v_exp_f32 v37, v37
    v_exp_f32 v38, v38
    s_waitcnt lgkmcnt(0)
    v_mfma_f32_32x32x8_bf16 v[16:31], v[86:87], v[84:85], v[64:79]
    v_exp_f32 v39, v39
    v_exp_f32 v40, v40
    v_exp_f32 v41, v41
    v_exp_f32 v42, v42
    v_mfma_f32_32x32x16_bf16 v[16:31], v[88:91], v[80:83], v[16:31]
    v_cvt_pk_bf16_f32 v32, v32, v33
    v_cvt_pk_bf16_f32 v33, v34, v35
    v_cvt_pk_bf16_f32 v34, v36, v37
    v_cvt_pk_bf16_f32 v35, v38, v39
    v_exp_f32 v43, v43
    v_exp_f32 v44, v44
    v_exp_f32 v45, v45
    v_mfma_f32_32x32x16_bf16 v[48:63], v[12:15], v[32:35], v[48:63]
    v_exp_f32 v46, v46
    v_exp_f32 v47, v47
    v_cvt_pk_bf16_f32 v40, v40, v41
    v_cvt_pk_bf16_f32 v41, v42, v43
    s_bitcmp1_b32 s13, s43
    s_cbranch_scc1 L_h6
L_r6:
    v_cvt_pk_bf16_f32 v42, v44, v45
    v_cvt_pk_bf16_f32 v43, v46, v47
    v_exp_f32 v16, v16
    v_exp_f32 v17, v17
    v_exp_f32 v18, v18
    v_mfma_f32_32x32x16_bf16 v[48:63], v[96:99], v[40:43], v[48:63]
    v_exp_f32 v19, v19
    v_exp_f32 v20, v20
    v_exp_f32 v21, v21
    v_exp_f32 v22, v22
    v_mfma_f32_32x32x8_bf16 v[32:47], v[86:87], v[112:113], v[64:79]
    v_exp_f32 v23, v23
    v_exp_f32 v24, v24
    v_exp_f32 v25, v25
    v_exp_f32 v26, v26
    v_mfma_f32_32x32x16_bf16 v[32:47], v[8:11], v[80:83], v[32:47]
    ds_read_b64_tr_b16 v[86:87], v105 offset:20480
    ds_read_b64_tr_b16 v[88:89], v104 offset:20480
    ds_read_b64_tr_b16 v[90:91], v104 offset:20608
    ds_read_b64_tr_b16 v[8:9], v104 offset:21760
    ds_read_b64_tr_b16 v[10:11], v104 offset:21888
    v_cvt_pk_bf16_f32 v16, v16, v17
    v_cvt_pk_bf16_f32 v17, v18, v19
    v_cvt_pk_bf16_f32 v18, v20, v21
    v_cvt_pk_bf16_f32 v19, v22, v23
    v_exp_f32 v27, v27
    v_exp_f32 v28, v28
    v_exp_f32 v29, v29
    v_mfma_f32_32x32x16_bf16 v[48:63], v[92:95], v[16:19], v[48:63]
    v_exp_f32 v30, v30
    v_exp_f32 v31, v31
    s_mov_b64 exec, s[40:41]
    ds_read_b128 v[12:15], v106 offset:8960
    ds_read_b128 v[96:99], v106 offset:9600
    ds_read_b128 v[92:95], v106 offset:20480
    ds_read_b128 v[108:111], v106 offset:21120
    s_mov_b64 exec, -1
    v_cvt_pk_bf16_f32 v24, v24, v25
    v_cvt_pk_bf16_f32 v25, v26, v27
    v_cvt_pk_bf16_f32 v26, v28, v29
    v_cvt_pk_bf16_f32 v27, v30, v31
    v_exp_f32 v32, v32
    v_exp_f32 v33, v33
    v_exp_f32 v34, v34
    v_mfma_f32_32x32x16_bf16 v[48:63], v[100:103], v[24:27], v[48:63]
    v_exp_f32 v35, v35
    v_exp_f32 v36, v36
    v_exp_f32 v37, v37
    v_exp_f32 v38, v38
    s_waitcnt lgkmcnt(0)
    v_mfma_f32_32x32x8_bf16 v[16:31], v[86:87], v[84:85], v[64:79]
    v_exp_f32 v39, v39
    v_exp_f32 v40, v40
    v_exp_f32 v41, v41
    v_exp_f32 v42, v42
    v_mfma_f32_32x32x16_bf16 v[16:31], v[88:91], v[80:83], v[16:31]
    v_cvt_pk_bf16_f32 v32, v32, v33
    v_cvt_pk_bf16_f32 v33, v34, v35
    v_cvt_pk_bf16_f32 v34, v36, v37
    v_cvt_pk_bf16_f32 v35, v38, v39
    v_exp_f32 v43, v43
    v_exp_f32 v44, v44
    v_exp_f32 v45, v45
    v_mfma_f32_32x32x16_bf16 v[48:63], v[12:15], v[32:35], v[48:63]
    v_exp_f32 v46, v46
    v_exp_f32 v47, v47
    v_cvt_pk_bf16_f32 v40, v40, v41
    v_cvt_pk_bf16_f32 v41, v42, v43
    v_cvt_pk_bf16_f32 v42, v44, v45
    v_cvt_pk_bf16_f32 v43, v46, v47
    v_exp_f32 v16, v16
    v_exp_f32 v17, v17
    v_exp_f32 v18, v18
    v_mfma_f32_32x32x16_bf16 v[48:63], v[96:99], v[40:43], v[48:63]
    v_exp_f32 v19, v19
    v_exp_f32 v20, v20
    v_exp_f32 v21, v21
    v_exp_f32 v22, v22
    v_mfma_f32_32x32x8_bf16 v[32:47], v[86:87], v[112:113], v[64:79]
    v_exp_f32 v23, v23
    v_exp_f32 v24, v24
    v_exp_f32 v25, v25
    v_exp_f32 v26, v26
    v_mfma_f32_32x32x16_bf16 v[32:47], v[8:11], v[80:83], v[32:47]
    ds_read_b64_tr_b16 v[86:87], v105 offset:23040
    ds_read_b64_tr_b16 v[88:89], v104 offset:23040
    ds_read_b64_tr_b16 v[90:91], v104 offset:23168
    ds_read_b64_tr_b16 v[8:9], v104 offset:24320
    ds_read_b64_tr_b16 v[10:11], v104 offset:24448
    v_cvt_pk_bf16_f32 v16, v16, v17
    v_cvt_pk_bf16_f32 v17, v18, v19
    v_cvt_pk_bf16_f32 v18, v20, v21
    v_cvt_pk_bf16_f32 v19, v22, v23
    v_exp_f32 v27, v27
    v_exp_f32 v28, v28
    v_exp_f32 v29, v29
    v_mfma_f32_32x32x16_bf16 v[48:63], v[92:95], v[16:19], v[48:63]
    v_exp_f32 v30, v30
    v_exp_f32 v31, v31
    s_mov_b64 exec, s[40:41]
    ds_read_b128 v[12:15], v106 offset:21760
    ds_read_b128 v[96:99], v106 offset:22400
    ds_read_b128 v[92:95], v106 offset:23040
    ds_read_b128 v[100:103], v106 offset:23680
    s_mov_b64 exec, -1
    v_cvt_pk_bf16_f32 v24, v24, v25
    v_cvt_pk_bf16_f32 v25, v26, v27
    v_cvt_pk_bf16_f32 v26, v28, v29
    v_cvt_pk_bf16_f32 v27, v30, v31
    v_exp_f32 v32, v32
    v_exp_f32 v33, v33
    v_exp_f32 v34, v34
    v_mfma_f32_32x32x16_bf16 v[48:63], v[108:111], v[24:27], v[48:63]
    v_exp_f32 v35, v35
    v_exp_f32 v36, v36
    v_exp_f32 v37, v37
    v_exp_f32 v38, v38
    s_waitcnt lgkmcnt(0)
    v_mfma_f32_32x32x8_bf16 v[16:31], v[86:87], v[84:85], v[64:79]
    v_exp_f32 v39, v39
    v_exp_f32 v40, v40
    v_exp_f32 v41, v41
    v_exp_f32 v42, v42
    v_mfma_f32_32x32x16_bf16 v[16:31], v[88:91], v[80:83], v[16:31]
    v_cvt_pk_bf16_f32 v32, v32, v33
    v_cvt_pk_bf16_f32 v33, v34, v35
    v_cvt_pk_bf16_f32 v34, v36, v37
    v_cvt_pk_bf16_f32 v35, v38, v39
    v_exp_f32 v43, v43
    v_exp_f32 v44, v44
    v_exp_f32 v45, v45
    v_mfma_f32_32x32x16_bf16 v[48:63], v[12:15], v[32:35], v[48:63]
    v_exp_f32 v46, v46
    v_exp_f32 v47, v47
    v_cvt_pk_bf16_f32 v40, v40, v41
    v_cvt_pk_bf16_f32 v41, v42, v43
    s_bitcmp1_b32 s14, s43
    s_cbranch_scc1 L_h10
L_r10:
    v_cvt_pk_bf16_f32 v42, v44, v45
    v_cvt_pk_bf16_f32 v43, v46, v47
    v_exp_f32 v16, v16
    v_exp_f32 v17, v17
    v_exp_f32 v18, v18
    v_mfma_f32_32x32x16_bf16 v[48:63], v[96:99], v[40:43], v[48:63]
    v_exp_f32 v19, v19
    v_exp_f32 v20, v20
    v_exp_f32 v21, v21
    v_exp_f32 v22, v22
    v_mfma_f32_32x32x8_bf16 v[32:47], v[86:87], v[112:113], v[64:79]
    v_exp_f32 v23, v23
    v_exp_f32 v24, v24
    v_exp_f32 v25, v25
    v_exp_f32 v26, v26
    v_mfma_f32_32x32x16_bf16 v[32:47], v[8:11], v[80:83], v[32:47]
    ds_read_b64_tr_b16 v[86:87], v105 offset:25600
    ds_read_b64_tr_b16 v[88:89], v104 offset:25600
    ds_read_b64_tr_b16 v[90:91], v104 offset:25728
    ds_read_b64_tr_b16 v[8:9], v104 offset:26880
    ds_read_b64_tr_b16 v[10:11], v104 offset:27008
    v_cvt_pk_bf16_f32 v16, v16, v17
    v_cvt_pk_bf16_f32 v17, v18, v19
    v_cvt_pk_bf16_f32 v18, v20, v21
    v_cvt_pk_bf16_f32 v19, v22, v23
    v_exp_f32 v27, v27
    v_exp_f32 v28, v28
    v_exp_f32 v29, v29
    v_mfma_f32_32x32x16_bf16 v[48:63], v[92:95], v[16:19], v[48:63]
    v_exp_f32 v30, v30
    v_exp_f32 v31, v31
    s_mov_b64 exec, s[40:41]
    ds_read_b128 v[12:15], v106 offset:24320
    ds_read_b128 v[96:99], v106 offset:24960
    ds_read_b128 v[92:95], v106 offset:25600
    ds_read_b128 v[108:111], v106 offset:26240
    s_mov_b64 exec, -1
    v_cvt_pk_bf16_f32 v24, v24, v25
    v_cvt_pk_bf16_f32 v25, v26, v27
    s_setprio 2
    v_cvt_pk_bf16_f32 v26, v28, v29
    v_cvt_pk_bf16_f32 v27, v30, v31
    v_exp_f32 v32, v32
    v_exp_f32 v33, v33
    v_exp_f32 v34, v34
    v_mfma_f32_32x32x16_bf16 v[48:63], v[100:103], v[24:27], v[48:63]
    v_exp_f32 v35, v35
    v_exp_f32 v36, v36
    v_exp_f32 v37, v37
    v_exp_f32 v38, v38
    s_waitcnt lgkmcnt(0)
    v_mfma_f32_32x32x8_bf16 v[16:31], v[86:87], v[84:85], v[64:79]
    v_exp_f32 v39, v39
    v_exp_f32 v40, v40
    v_exp_f32 v41, v41
    v_exp_f32 v42, v42
    v_mfma_f32_32x32x16_bf16 v[16:31], v[88:91], v[80:83], v[16:31]
    v_cvt_pk_bf16_f32 v32, v32, v33
    v_cvt_pk_bf16_f32 v33, v34, v35
    v_cvt_pk_bf16_f32 v34, v36, v37
    v_cvt_pk_bf16_f32 v35, v38, v39
    v_exp_f32 v43, v43
    v_exp_f32 v44, v44
    v_exp_f32 v45, v45
    v_mfma_f32_32x32x16_bf16 v[48:63], v[12:15], v[32:35], v[48:63]
    v_exp_f32 v46, v46
    v_exp_f32 v47, v47
    v_cvt_pk_bf16_f32 v40, v40, v41
    v_cvt_pk_bf16_f32 v41, v42, v43
    v_cvt_pk_bf16_f32 v42, v44, v45
    v_cvt_pk_bf16_f32 v43, v46, v47
    v_exp_f32 v16, v16
    v_exp_f32 v17, v17
    v_exp_f32 v18, v18
    v_mfma_f32_32x32x16_bf16 v[48:63], v[96:99], v[40:43], v[48:63]
    v_exp_f32 v19, v19
    v_exp_f32 v20, v20
    v_exp_f32 v21, v21
    v_exp_f32 v22, v22
    v_mfma_f32_32x32x8_bf16 v[32:47], v[86:87], v[112:113], v[64:79]
    v_exp_f32 v23, v23
    v_exp_f32 v24, v24
    v_exp_f32 v25, v25
    v_exp_f32 v26, v26
    v_mfma_f32_32x32x16_bf16 v[32:47], v[8:11], v[80:83], v[32:47]
    ds_read_b64_tr_b16 v[86:87], v105 offset:28160
    ds_read_b64_tr_b16 v[88:89], v104 offset:28160
    ds_read_b64_tr_b16 v[90:91], v104 offset:28288
    ds_read_b64_tr_b16 v[8:9], v104 offset:29440
    ds_read_b64_tr_b16 v[10:11], v104 offset:29568
    v_cvt_pk_bf16_f32 v16, v16, v17
    v_cvt_pk_bf16_f32 v17, v18, v19
    v_cvt_pk_bf16_f32 v18, v20, v21
    v_cvt_pk_bf16_f32 v19, v22, v23
    v_exp_f32 v27, v27
    v_exp_f32 v28, v28
    v_exp_f32 v29, v29
    v_mfma_f32_32x32x16_bf16 v[48:63], v[92:95], v[16:19], v[48:63]
    v_exp_f32 v30, v30
    v_exp_f32 v31, v31
    s_mov_b64 exec, s[40:41]
    ds_read_b128 v[12:15], v106 offset:26880
    ds_read_b128 v[96:99], v106 offset:27520
    ds_read_b128 v[92:95], v106 offset:28160
    ds_read_b128 v[100:103], v106 offset:28800
    s_mov_b64 exec, -1
    v_cvt_pk_bf16_f32 v24, v24, v25
    v_cvt_pk_bf16_f32 v25, v26, v27
    v_cvt_pk_bf16_f32 v26, v28, v29
    v_cvt_pk_bf16_f32 v27, v30, v31
    v_exp_f32 v32, v32
    v_exp_f32 v33, v33
    v_exp_f32 v34, v34
    v_mfma_f32_32x32x16_bf16 v[48:63], v[108:111], v[24:27], v[48:63]
    v_exp_f32 v35, v35
    v_exp_f32 v36, v36
    v_exp_f32 v37, v37
    v_exp_f32 v38, v38
    s_waitcnt lgkmcnt(0)
    v_mfma_f32_32x32x8_bf16 v[16:31], v[86:87], v[84:85], v[64:79]
    v_exp_f32 v39, v39
    v_exp_f32 v40, v40
    v_exp_f32 v41, v41
    v_exp_f32 v42, v42
    v_mfma_f32_32x32x16_bf16 v[16:31], v[88:91], v[80:83], v[16:31]
    v_cvt_pk_bf16_f32 v32, v32, v33
    v_cvt_pk_bf16_f32 v33, v34, v35
    v_cvt_pk_bf16_f32 v34, v36, v37
    v_cvt_pk_bf16_f32 v35, v38, v39
    v_exp_f32 v43, v43
    v_exp_f32 v44, v44
    v_exp_f32 v45, v45
    v_mfma_f32_32x32x16_bf16 v[48:63], v[12:15], v[32:35], v[48:63]
    v_exp_f32 v46, v46
    v_exp_f32 v47, v47
    v_cvt_pk_bf16_f32 v40, v40, v41
    v_cvt_pk_bf16_f32 v41, v42, v43
    s_bitcmp1_b32 s15, s43
    s_cbranch_scc1 L_h14
L_r14:
    s_setprio 1
    v_cvt_pk_bf16_f32 v42, v44, v45
    v_cvt_pk_bf16_f32 v43, v46, v47
    v_exp_f32 v16, v16
    v_exp_f32 v17, v17
    v_exp_f32 v18, v18
    v_mfma_f32_32x32x16_bf16 v[48:63], v[96:99], v[40:43], v[48:63]
    v_exp_f32 v19, v19
    v_exp_f32 v20, v20
    v_exp_f32 v21, v21
    v_exp_f32 v22, v22
    v_mfma_f32_32x32x8_bf16 v[32:47], v[86:87], v[112:113], v[64:79]
    v_exp_f32 v23, v23
    v_exp_f32 v24, v24
    v_exp_f32 v25, v25
    v_exp_f32 v26, v26
    v_mfma_f32_32x32x16_bf16 v[32:47], v[8:11], v[80:83], v[32:47]
    ds_read_b64_tr_b16 v[86:87], v105 offset:40960
    ds_read_b64_tr_b16 v[88:89], v104 offset:40960
    ds_read_b64_tr_b16 v[90:91], v104 offset:41088
    ds_read_b64_tr_b16 v[8:9], v104 offset:42240
    ds_read_b64_tr_b16 v[10:11], v104 offset:42368
    v_cvt_pk_bf16_f32 v16, v16, v17
    v_cvt_pk_bf16_f32 v17, v18, v19
    v_cvt_pk_bf16_f32 v18, v20, v21
    v_cvt_pk_bf16_f32 v19, v22, v23
    v_exp_f32 v27, v27
    v_exp_f32 v28, v28
    v_exp_f32 v29, v29
    v_mfma_f32_32x32x16_bf16 v[48:63], v[92:95], v[16:19], v[48:63]
    v_exp_f32 v30, v30
    v_exp_f32 v31, v31
    s_mov_b64 exec, s[40:41]
    ds_read_b128 v[12:15], v106 offset:29440
    ds_read_b128 v[96:99], v106 offset:30080
    ds_read_b128 v[92:95], v106 offset:40960
    ds_read_b128 v[108:111], v106 offset:41600
    s_mov_b64 exec, -1
    v_cvt_pk_bf16_f32 v24, v24, v25
    v_cvt_pk_bf16_f32 v25, v26, v27
    v_cvt_pk_bf16_f32 v26, v28, v29
    v_cvt_pk_bf16_f32 v27, v30, v31
    v_exp_f32 v32, v32
    v_exp_f32 v33, v33
    v_exp_f32 v34, v34
    v_mfma_f32_32x32x16_bf16 v[48:63], v[100:103], v[24:27], v[48:63]
    v_exp_f32 v35, v35
    v_exp_f32 v36, v36
    v_exp_f32 v37, v37
    v_exp_f32 v38, v38
    s_waitcnt lgkmcnt(0)
    v_mfma_f32_32x32x8_bf16 v[16:31], v[86:87], v[84:85], v[64:79]
    v_exp_f32 v39, v39
    v_exp_f32 v40, v40
    v_exp_f32 v41, v41
    v_exp_f32 v42, v42
    v_mfma_f32_32x32x16_bf16 v[16:31], v[88:91], v[80:83], v[16:31]
    v_cvt_pk_bf16_f32 v32, v32, v33
    v_cvt_pk_bf16_f32 v33, v34, v35
    v_cvt_pk_bf16_f32 v34, v36, v37
    v_cvt_pk_bf16_f32 v35, v38, v39
    v_exp_f32 v43, v43
    v_exp_f32 v44, v44
    v_exp_f32 v45, v45
    v_mfma_f32_32x32x16_bf16 v[48:63], v[12:15], v[32:35], v[48:63]
    v_exp_f32 v46, v46
    v_exp_f32 v47, v47
    v_cvt_pk_bf16_f32 v40, v40, v41
    v_cvt_pk_bf16_f32 v41, v42, v43
    v_add_u32 v104, 40960, v104
    v_add_u32 v105, 40960, v105
    v_add_u32 v106, 40960, v106
    s_add_u32 s43, s43, 1
    s_cmp_lt_u32 s43, 4
    s_cbranch_scc1 L_att_loop
    s_setprio 0
    v_cvt_pk_bf16_f32 v42, v44, v45
    v_cvt_pk_bf16_f32 v43, v46, v47
    s_mov_b32 s43, 0
    s_nop 0
    v_mfma_f32_32x32x16_bf16 v[48:63], v[96:99], v[40:43], v[48:63]
    s_add_u32 s68, s8, 7864320
    s_addc_u32 s69, s9, 0
    s_and_b32 s69, s69, 0xffff
    s_mov_b32 s70, 2621440
    s_mov_b32 s71, 0x00020000
    s_nop 6
L_att_store:
    v_rcp_f32 v16, v60
    s_nop 0
    v_mul_f32 v48, v48, v16
    v_mul_f32 v49, v49, v16
    v_mul_f32 v50, v50, v16
    v_mul_f32 v51, v51, v16
    v_cvt_pk_bf16_f32 v32, v48, v49
    v_cvt_pk_bf16_f32 v33, v50, v51
    buffer_store_dwordx2 v[32:33], v114, s[68:71], 0 offen offset:0 sc0 sc1
    v_mul_f32 v52, v52, v16
    v_mul_f32 v53, v53, v16
    v_mul_f32 v54, v54, v16
    v_mul_f32 v55, v55, v16
    v_cvt_pk_bf16_f32 v34, v52, v53
    v_cvt_pk_bf16_f32 v35, v54, v55
    buffer_store_dwordx2 v[34:35], v114, s[68:71], 0 offen offset:512 sc0 sc1
    v_mul_f32 v56, v56, v16
    v_mul_f32 v57, v57, v16
    v_mul_f32 v58, v58, v16
    v_mul_f32 v59, v59, v16
    v_cvt_pk_bf16_f32 v36, v56, v57
    v_cvt_pk_bf16_f32 v37, v58, v59
    buffer_store_dwordx2 v[36:37], v115, s[68:71], 0 offen offset:1024 sc0 sc1
    v_fma_f32 v16, v48, 0, v60
    v_mul_f32 v17, 0, v49
    v_fma_f32 v16, v50, 0, v16
    v_fma_f32 v17, v51, 0, v17
    v_fma_f32 v16, v52, 0, v16
    v_fma_f32 v17, v53, 0, v17
    v_fma_f32 v16, v54, 0, v16
    v_fma_f32 v17, v55, 0, v17
    v_fma_f32 v16, v56, 0, v16
    v_fma_f32 v17, v57, 0, v17
    v_fma_f32 v16, v58, 0, v16
    v_fma_f32 v17, v59, 0, v17
    v_add_f32 v16, v16, v17
    v_cmp_gt_f32 vcc, 0x53800000, v16
    s_cmp_lg_u32 s43, 0
    s_cbranch_scc1 L_att_done
    s_nop 1
    s_cmp_eq_u64 vcc, -1
    s_cbranch_scc0 L_att_slow
L_att_done:
    s_cmp_eq_u32 s36, 0
    s_cbranch_scc1 L_D
    s_cmp_eq_u32 s36, 1
    s_cbranch_scc1 L_E
    s_waitcnt vmcnt(0)
    s_barrier
    s_cmp_lg_u32 s29, 0
    s_cbranch_scc1 L_w4_27
    s_lshl_b32 s30, s42, 1
    s_bfe_u32 s31, s39, 0x10001
    s_add_u32 s30, s30, s31
    s_mul_i32 s30, s30, 4352
    s_add_u32 s30, s30, 217600
    v_mov_b32 v20, 1
    s_mov_b64 exec, 1
    buffer_atomic_add v20, off, s[44:47], s30 sc1
    s_mov_b64 exec, -1
L_w4_27:
    s_endpgm
L_h10:
    s_cmp_eq_u32 s43, 1
    s_cbranch_scc1 L_h10b
    s_cmp_eq_u32 s43, 3
    s_cbranch_scc1 L_h10e
    s_cmp_eq_u32 s43, 0
    s_cbranch_scc1 L_h10a
    s_and_b32 s30, s24, 3
    s_mul_i32 s30, s30, 8704
    s_add_u32 s30, s30, 182784
    buffer_load_dword v117, off, s[44:47], s30 sc1
    s_add_u32 s30, s30, 4352
    buffer_load_dword v119, off, s[44:47], s30 sc1
    s_branch L_r10
L_h10a:
    s_cmp_eq_u32 s36, 1
    s_cselect_b32 s30, s29, 0
    s_cmp_eq_u32 s30, 4
    s_cbranch_scc0 L_h10d
    v_lshlrev_b32 v116, 2, v2
    v_add_u32 v116, 143360, v116
    s_mov_b32 s72, 0
L_agg:
    s_waitcnt vmcnt(0)
    s_mov_b64 s[30:31], 0
    s_cmp_le_u32 s26, 0
    s_cbranch_scc1 L_agg1
    v_cmp_ne_u32 vcc, s37, v149
    v_cmp_ne_u32 s[32:33], s37, v151
    s_nop 1
    s_or_b64 s[30:31], s[30:31], vcc
    s_or_b64 s[30:31], s[30:31], s[32:33]
    s_cmp_le_u32 s26, 1
    s_cbranch_scc1 L_agg1
    v_cmp_ne_u32 vcc, s37, v153
    v_cmp_ne_u32 s[32:33], s37, v155
    s_nop 1
    s_or_b64 s[30:31], s[30:31], vcc
    s_or_b64 s[30:31], s[30:31], s[32:33]
    s_cmp_le_u32 s26, 2
    s_cbranch_scc1 L_agg1
    v_cmp_ne_u32 vcc, s37, v157
    v_cmp_ne_u32 s[32:33], s37, v159
    s_nop 1
    s_or_b64 s[30:31], s[30:31], vcc
    s_or_b64 s[30:31], s[30:31], s[32:33]
    s_cmp_le_u32 s26, 3
    s_cbranch_scc1 L_agg1
    v_cmp_ne_u32 vcc, s37, v161
    v_cmp_ne_u32 s[32:33], s37, v163
    s_nop 1
    s_or_b64 s[30:31], s[30:31], vcc
    s_or_b64 s[30:31], s[30:31], s[32:33]
    s_cmp_le_u32 s26, 4
    s_cbranch_scc1 L_agg1
    v_cmp_ne_u32 vcc, s37, v165
    v_cmp_ne_u32 s[32:33], s37, v167
    s_nop 1
    s_or_b64 s[30:31], s[30:31], vcc
    s_or_b64 s[30:31], s[30:31], s[32:33]
    s_cmp_le_u32 s26, 5
    s_cbranch_scc1 L_agg1
    v_cmp_ne_u32 vcc, s37, v169
    v_cmp_ne_u32 s[32:33], s37, v171
    s_nop 1
    s_or_b64 s[30:31], s[30:31], vcc
    s_or_b64 s[30:31], s[30:31], s[32:33]
    s_cmp_le_u32 s26, 6
    s_cbranch_scc1 L_agg1
    v_cmp_ne_u32 vcc, s37, v173
    v_cmp_ne_u32 s[32:33], s37, v175
    s_nop 1
    s_or_b64 s[30:31], s[30:31], vcc
    s_or_b64 s[30:31], s[30:31], s[32:33]
L_agg1:
    s_cmp_eq_u64 s[30:31], 0
    s_cbranch_scc1 L_agg2
    s_add_u32 s72, s72, 1
    s_cmp_ge_u32 s72, 0x20000
    s_cbranch_scc1 L_agg2
    s_add_u32 s64, s8, 17891328
    s_addc_u32 s65, s9, 0
    s_and_b32 s65, s65, 0xffff
    s_mov_b32 s66, 81920
    s_mov_b32 s67, 0x00020000
    v_subrev_u32 v117, 10240, v7
    buffer_load_dwordx4 v[148:151], v117, s[64:67], 0 offen sc1
    v_subrev_u32 v117, 20480, v7
    buffer_load_dwordx4 v[152:155], v117, s[64:67], 0 offen sc1
    v_subrev_u32 v117, 30720, v7
    buffer_load_dwordx4 v[156:159], v117, s[64:67], 0 offen sc1
    v_subrev_u32 v117, 40960, v7
    buffer_load_dwordx4 v[160:163], v117, s[64:67], 0 offen sc1
    v_subrev_u32 v117, 51200, v7
    buffer_load_dwordx4 v[164:167], v117, s[64:67], 0 offen sc1
    v_subrev_u32 v117, 61440, v7
    buffer_load_dwordx4 v[168:171], v117, s[64:67], 0 offen sc1
    v_subrev_u32 v117, 71680, v7
    buffer_load_dwordx4 v[172:175], v117, s[64:67], 0 offen sc1
    s_branch L_agg
L_agg2:
    v_mov_b32 v149, v150
    v_mov_b32 v153, v154
    v_mov_b32 v157, v158
    v_mov_b32 v161, v162
    v_mov_b32 v165, v166
    v_mov_b32 v169, v170
    v_mov_b32 v173, v174
    v_pk_fma_f32 v[168:169], v[130:131], v[172:173], v[168:169] op_sel:[0,0,0] op_sel_hi:[0,1,1]
    v_pk_fma_f32 v[168:169], v[130:131], v[172:173], v[168:169] op_sel:[1,1,0] op_sel_hi:[1,0,1] neg_lo:[1,0,0]
    v_pk_fma_f32 v[164:165], v[130:131], v[168:169], v[164:165] op_sel:[0,0,0] op_sel_hi:[0,1,1]
    v_pk_fma_f32 v[164:165], v[130:131], v[168:169], v[164:165] op_sel:[1,1,0] op_sel_hi:[1,0,1] neg_lo:[1,0,0]
    v_pk_fma_f32 v[160:161], v[130:131], v[164:165], v[160:161] op_sel:[0,0,0] op_sel_hi:[0,1,1]
    v_pk_fma_f32 v[160:161], v[130:131], v[164:165], v[160:161] op_sel:[1,1,0] op_sel_hi:[1,0,1] neg_lo:[1,0,0]
    v_pk_fma_f32 v[156:157], v[130:131], v[160:161], v[156:157] op_sel:[0,0,0] op_sel_hi:[0,1,1]
    v_pk_fma_f32 v[156:157], v[130:131], v[160:161], v[156:157] op_sel:[1,1,0] op_sel_hi:[1,0,1] neg_lo:[1,0,0]
    v_pk_fma_f32 v[152:153], v[130:131], v[156:157], v[152:153] op_sel:[0,0,0] op_sel_hi:[0,1,1]
    v_pk_fma_f32 v[152:153], v[130:131], v[156:157], v[152:153] op_sel:[1,1,0] op_sel_hi:[1,0,1] neg_lo:[1,0,0]
    v_pk_fma_f32 v[148:149], v[130:131], v[152:153], v[148:149] op_sel:[0,0,0] op_sel_hi:[0,1,1]
    v_pk_fma_f32 v[148:149], v[130:131], v[152:153], v[148:149] op_sel:[1,1,0] op_sel_hi:[1,0,1] neg_lo:[1,0,0]
    ds_write2st64_b32 v116, v148, v149 offset0:0 offset1:8
    v_pk_fma_f32 v[132:133], v[128:129], v[148:149], v[132:133] op_sel:[0,0,0] op_sel_hi:[0,1,1]
    v_pk_fma_f32 v[132:133], v[128:129], v[148:149], v[132:133] op_sel:[1,1,0] op_sel_hi:[1,0,1] neg_lo:[1,0,0]
    ds_write2st64_b32 v116, v132, v133 offset0:1 offset1:9
    v_pk_fma_f32 v[134:135], v[128:129], v[132:133], v[134:135] op_sel:[0,0,0] op_sel_hi:[0,1,1]
    v_pk_fma_f32 v[134:135], v[128:129], v[132:133], v[134:135] op_sel:[1,1,0] op_sel_hi:[1,0,1] neg_lo:[1,0,0]
    ds_write2st64_b32 v116, v134, v135 offset0:2 offset1:10
    v_pk_fma_f32 v[136:137], v[128:129], v[134:135], v[136:137] op_sel:[0,0,0] op_sel_hi:[0,1,1]
    v_pk_fma_f32 v[136:137], v[128:129], v[134:135], v[136:137] op_sel:[1,1,0] op_sel_hi:[1,0,1] neg_lo:[1,0,0]
    ds_write2st64_b32 v116, v136, v137 offset0:3 offset1:11
    v_pk_fma_f32 v[138:139], v[128:129], v[136:137], v[138:139] op_sel:[0,0,0] op_sel_hi:[0,1,1]
    v_pk_fma_f32 v[138:139], v[128:129], v[136:137], v[138:139] op_sel:[1,1,0] op_sel_hi:[1,0,1] neg_lo:[1,0,0]
    ds_write2st64_b32 v116, v138, v139 offset0:4 offset1:12
    v_pk_fma_f32 v[140:141], v[128:129], v[138:139], v[140:141] op_sel:[0,0,0] op_sel_hi:[0,1,1]
    v_pk_fma_f32 v[140:141], v[128:129], v[138:139], v[140:141] op_sel:[1,1,0] op_sel_hi:[1,0,1] neg_lo:[1,0,0]
    ds_write2st64_b32 v116, v140, v141 offset0:5 offset1:13
    v_pk_fma_f32 v[142:143], v[128:129], v[140:141], v[142:143] op_sel:[0,0,0] op_sel_hi:[0,1,1]
    v_pk_fma_f32 v[142:143], v[128:129], v[140:141], v[142:143] op_sel:[1,1,0] op_sel_hi:[1,0,1] neg_lo:[1,0,0]
    ds_write2st64_b32 v116, v142, v143 offset0:6 offset1:14
    v_pk_fma_f32 v[144:145], v[128:129], v[142:143], v[144:145] op_sel:[0,0,0] op_sel_hi:[0,1,1]
    v_pk_fma_f32 v[144:145], v[128:129], v[142:143], v[144:145] op_sel:[1,1,0] op_sel_hi:[1,0,1] neg_lo:[1,0,0]
    ds_write2st64_b32 v116, v144, v145 offset0:7 offset1:15
L_h10d:
    s_mov_b32 s60, s8
    s_and_b32 s61, s9, 0xffff
    s_mov_b32 s62, 7864320
    s_mov_b32 s63, 0x00020000
    s_add_u32 s32, s96, 5
    s_and_b32 s32, s32, 7
    s_mul_i32 s32, s32, 10240
    s_add_u32 m0, s74, 102400
    s_add_u32 s32, s32, s75
    buffer_load_dwordx4 v107, s[60:63], s32 offen offset:0 sc1 lds
    buffer_load_dwordx4 v107, s[60:63], s32 offen offset:1024 sc1 lds
    buffer_load_dwordx4 v107, s[60:63], s32 offen offset:2048 sc1 lds
    buffer_load_dwordx4 v107, s[60:63], s32 offen offset:3072 sc1 lds
    s_add_u32 m0, s74, 106496
    s_add_u32 s32, s32, 4096
    buffer_load_dwordx4 v107, s[60:63], s32 offen offset:0 sc1 lds
    s_add_u32 s32, s96, 6
    s_and_b32 s32, s32, 7
    s_mul_i32 s32, s32, 10240
    s_add_u32 m0, s74, 122880
    s_add_u32 s32, s32, s75
    buffer_load_dwordx4 v107, s[60:63], s32 offen offset:0 sc1 lds
    buffer_load_dwordx4 v107, s[60:63], s32 offen offset:1024 sc1 lds
    buffer_load_dwordx4 v107, s[60:63], s32 offen offset:2048 sc1 lds
    buffer_load_dwordx4 v107, s[60:63], s32 offen offset:3072 sc1 lds
    s_add_u32 m0, s74, 126976
    s_add_u32 s32, s32, 4096
    buffer_load_dwordx4 v107, s[60:63], s32 offen offset:0 sc1 lds
    s_branch L_r10
L_h10p:
    v_mul_u32_u24 v116, 4352, v2
    v_add_u32 v116, 182784, v116
    v_mov_b32 v117, 1
    s_waitcnt vmcnt(0)
    s_mov_b64 exec, 0xff
    buffer_atomic_add v117, v116, s[44:47], 0 offen sc1
    s_mov_b64 exec, -1
    s_branch L_r10
L_h10b:
    s_cmp_eq_u32 s36, 2
    s_cbranch_scc1 L_h10p
    s_mul_i32 s30, s26, 4352
    s_add_u32 s30, s30, 182784
    s_waitcnt vmcnt(0)
    v_mov_b32 v116, 1
    s_mov_b64 exec, 1
    buffer_atomic_add v116, off, s[44:47], s30 sc1
    s_mov_b64 exec, -1
    s_branch L_r10
L_h6c:
    s_mov_b32 s20, s4
    s_and_b32 s21, s5, 0xffff
    s_mov_b32 s22, 2621440
    s_mov_b32 s23, 0x00020000
    s_add_u32 s16, s8, 15728640
    s_addc_u32 s17, s9, 0
    s_and_b32 s17, s17, 0xffff
    s_mov_b32 s18, 1802240
    s_mov_b32 s19, 0x00020000
    s_add_u32 s52, s8, 10485760
    s_addc_u32 s53, s9, 0
    s_and_b32 s53, s53, 0xffff
    s_mov_b32 s54, 5242880
    s_mov_b32 s55, 0x00020000
    s_branch L_r6
L_h10e:
    s_mov_b32 s20, s4
    s_and_b32 s21, s5, 0xffff
    s_mov_b32 s22, 2621440
    s_mov_b32 s23, 0x00020000
    s_add_u32 s16, s8, 15728640
    s_addc_u32 s17, s9, 0
    s_and_b32 s17, s17, 0xffff
    s_mov_b32 s18, 1802240
    s_mov_b32 s19, 0x00020000
    s_add_u32 s52, s8, 10485760
    s_addc_u32 s53, s9, 0
    s_and_b32 s53, s53, 0xffff
    s_mov_b32 s54, 5242880
    s_mov_b32 s55, 0x00020000
    s_add_u32 m0, s34, 0
    s_lshl_b32 s32, s27, 7
    buffer_load_dwordx4 v182, s[20:23], s32 offen offset:0 lds
    buffer_load_dwordx4 v183, s[20:23], s32 offen offset:1024 lds
    buffer_load_dwordx4 v184, s[20:23], s32 offen offset:2048 lds
    buffer_load_dwordx4 v185, s[20:23], s32 offen offset:3072 lds
    s_add_u32 m0, s35, 16384
    s_nop 0
    buffer_load_dwordx4 v180, s[16:19], s28 offen offset:0 sc1 lds
    buffer_load_dwordx4 v181, s[16:19], s28 offen offset:1024 sc1 lds
    s_branch L_r10
L_h14:
    s_mov_b32 s20, s4
    s_and_b32 s21, s5, 0xffff
    s_mov_b32 s22, 2621440
    s_mov_b32 s23, 0x00020000
    s_add_u32 s16, s8, 15728640
    s_addc_u32 s17, s9, 0
    s_and_b32 s17, s17, 0xffff
    s_mov_b32 s18, 1802240
    s_mov_b32 s19, 0x00020000
    s_add_u32 s52, s8, 10485760
    s_addc_u32 s53, s9, 0
    s_and_b32 s53, s53, 0xffff
    s_mov_b32 s54, 5242880
    s_mov_b32 s55, 0x00020000
    s_add_u32 m0, s34, 24576
    s_lshl_b32 s32, s98, 18
    buffer_load_dwordx4 v176, s[52:55], s32 offen offset:0 sc1 lds
    buffer_load_dwordx4 v177, s[52:55], s32 offen offset:1024 sc1 lds
    buffer_load_dwordx4 v178, s[52:55], s32 offen offset:2048 sc1 lds
    buffer_load_dwordx4 v179, s[52:55], s32 offen offset:3072 sc1 lds
    s_add_u32 m0, s35, 40960
    s_lshl_b32 s33, s98, 7
    buffer_load_dwordx4 v180, s[16:19], s33 offen offset:0 sc1 lds
    buffer_load_dwordx4 v181, s[16:19], s33 offen offset:1024 sc1 lds
    s_add_u32 s98, s98, 1
    s_cmp_eq_u32 s98, 20
    s_cselect_b32 s98, 0, s98
    s_branch L_r14
L_h6:
    s_cmp_eq_u32 s43, 2
    s_cbranch_scc1 L_h6b
    s_cmp_eq_u32 s43, 3
    s_cbranch_scc1 L_h6c
    s_waitcnt vmcnt(0)
    s_barrier
    s_cmp_lt_u32 s29, 4
    s_cbranch_scc1 L_r6
    s_cmp_lg_u32 s29, 4
    s_cbranch_scc1 L_h6a
    s_cmp_lg_u32 s36, 1
    s_cbranch_scc1 L_h6a
    s_add_u32 s64, s8, 17891328
    s_addc_u32 s65, s9, 0
    s_and_b32 s65, s65, 0xffff
    s_mov_b32 s66, 81920
    s_mov_b32 s67, 0x00020000
    v_subrev_u32 v117, 10240, v7
    buffer_load_dwordx4 v[148:151], v117, s[64:67], 0 offen sc1
    v_subrev_u32 v117, 20480, v7
    buffer_load_dwordx4 v[152:155], v117, s[64:67], 0 offen sc1
    v_subrev_u32 v117, 30720, v7
    buffer_load_dwordx4 v[156:159], v117, s[64:67], 0 offen sc1
    v_subrev_u32 v117, 40960, v7
    buffer_load_dwordx4 v[160:163], v117, s[64:67], 0 offen sc1
    v_subrev_u32 v117, 51200, v7
    buffer_load_dwordx4 v[164:167], v117, s[64:67], 0 offen sc1
    v_subrev_u32 v117, 61440, v7
    buffer_load_dwordx4 v[168:171], v117, s[64:67], 0 offen sc1
    v_subrev_u32 v117, 71680, v7
    buffer_load_dwordx4 v[172:175], v117, s[64:67], 0 offen sc1
L_h6a:
    s_mov_b32 s60, s8
    s_and_b32 s61, s9, 0xffff
    s_mov_b32 s62, 7864320
    s_mov_b32 s63, 0x00020000
    s_add_u32 s32, s96, 3
    s_and_b32 s32, s32, 7
    s_mul_i32 s32, s32, 10240
    s_add_u32 m0, s74, 61440
    s_add_u32 s32, s32, s75
    buffer_load_dwordx4 v107, s[60:63], s32 offen offset:0 sc1 lds
    buffer_load_dwordx4 v107, s[60:63], s32 offen offset:1024 sc1 lds
    buffer_load_dwordx4 v107, s[60:63], s32 offen offset:2048 sc1 lds
    buffer_load_dwordx4 v107, s[60:63], s32 offen offset:3072 sc1 lds
    s_add_u32 m0, s74, 65536
    s_add_u32 s32, s32, 4096
    buffer_load_dwordx4 v107, s[60:63], s32 offen offset:0 sc1 lds
    s_add_u32 s32, s96, 4
    s_and_b32 s32, s32, 7
    s_mul_i32 s32, s32, 10240
    s_add_u32 m0, s74, 81920
    s_add_u32 s32, s32, s75
    buffer_load_dwordx4 v107, s[60:63], s32 offen offset:0 sc1 lds
    buffer_load_dwordx4 v107, s[60:63], s32 offen offset:1024 sc1 lds
    buffer_load_dwordx4 v107, s[60:63], s32 offen offset:2048 sc1 lds
    buffer_load_dwordx4 v107, s[60:63], s32 offen offset:3072 sc1 lds
    s_add_u32 m0, s74, 86016
    s_add_u32 s32, s32, 4096
    buffer_load_dwordx4 v107, s[60:63], s32 offen offset:0 sc1 lds
    s_branch L_r6
L_h6b:
    s_load_dwordx2 s[52:53], s[0:1], 88
    s_load_dwordx2 s[56:57], s[0:1], 0
    v_lshlrev_b32 v118, 7, v2
    s_cmp_ge_u32 s29, 4
    s_cbranch_scc1 L_pf_28
    v_mul_u32_u24 v119, 13108, v2
    v_lshrrev_b32 v119, 16, v119
    v_mul_u32_u24 v119, 640, v119
    v_add_u32 v119, v119, v118
    s_and_b32 s30, s24, 3
    s_lshl_b32 s30, s30, 5
    s_add_u32 s30, s30, s25
    s_lshl_b32 s30, s30, 2
    s_and_b32 s31, s29, 1
    s_add_u32 s30, s30, s31
    s_mul_i32 s30, s30, 5120
    s_lshr_b32 s31, s24, 2
    s_mul_i32 s31, s31, 640
    s_add_u32 s30, s30, s31
    v_add_u32 v119, s30, v119
    s_waitcnt lgkmcnt(0)
    s_mov_b32 s64, s56
    s_and_b32 s65, s57, 0xffff
    s_mov_b32 s66, 2621440
    s_mov_b32 s67, 0x00020000
    s_cmp_ge_u32 s29, 2
    s_cbranch_scc1 L_pf_29
    buffer_load_dword v116, v119, s[64:67], 0 offen
    s_branch L_pf_29
L_pf_28:
    s_mul_i32 s30, s25, 25600
    s_mul_i32 s31, s38, 5888
    s_add_u32 s30, s30, s31
    v_add_u32 v119, s30, v118
    s_waitcnt lgkmcnt(0)
    s_mov_b32 s64, s52
    s_and_b32 s65, s53, 0xffff
    s_mov_b32 s66, 819200
    s_mov_b32 s67, 0x00020000
    buffer_load_dword v122, v119, s[64:67], 0 offen
L_pf_29:
    s_branch L_r6
L_h0:
    s_cmp_eq_u32 s43, 3
    s_cbranch_scc1 L_h0c
    s_waitcnt vmcnt(0) lgkmcnt(0)
    s_barrier
    s_setprio 3
    s_cmp_ge_u32 s29, 4
    s_cbranch_scc1 L_h0b
    ds_read2st64_b32 v[116:117], v7 offset0:0 offset1:1
    ds_read2st64_b32 v[118:119], v7 offset0:8 offset1:9
    s_waitcnt lgkmcnt(0)
    s_barrier
    s_cmp_eq_u32 s36, 2
    s_cbranch_scc1 L_h0p
    s_cmp_lg_u32 s36, 1
    s_cbranch_scc1 L_r0
    s_add_u32 s64, s8, 10485760
    s_addc_u32 s65, s9, 0
    s_and_b32 s65, s65, 0xffff
    s_mov_b32 s66, 5242880
    s_mov_b32 s67, 0x00020000
    v_pk_fma_f32 v[128:129], v[4:5], v[116:117], v[128:129] op_sel:[0,0,0] op_sel_hi:[0,1,1]
    v_pk_fma_f32 v[144:145], v[4:5], v[118:119], v[144:145] op_sel:[0,0,0] op_sel_hi:[0,1,1]
    v_pk_fma_f32 v[128:129], v[4:5], v[118:119], v[128:129] op_sel:[1,0,0] op_sel_hi:[1,1,1] neg_lo:[1,0,0] neg_hi:[1,0,0]
    v_pk_fma_f32 v[144:145], v[4:5], v[116:117], v[144:145] op_sel:[1,0,0] op_sel_hi:[1,1,1]
    v_pk_fma_f32 v[130:131], v[4:5], v[128:129], v[130:131] op_sel:[0,0,0] op_sel_hi:[0,1,1]
    v_pk_fma_f32 v[146:147], v[4:5], v[144:145], v[146:147] op_sel:[0,0,0] op_sel_hi:[0,1,1]
    v_pk_fma_f32 v[130:131], v[4:5], v[144:145], v[130:131] op_sel:[1,0,0] op_sel_hi:[1,1,1] neg_lo:[1,0,0] neg_hi:[1,0,0]
    v_pk_fma_f32 v[146:147], v[4:5], v[128:129], v[146:147] op_sel:[1,0,0] op_sel_hi:[1,1,1]
    v_pk_fma_f32 v[132:133], v[4:5], v[130:131], v[132:133] op_sel:[0,0,0] op_sel_hi:[0,1,1]
    v_pk_fma_f32 v[148:149], v[4:5], v[146:147], v[148:149] op_sel:[0,0,0] op_sel_hi:[0,1,1]
    v_pk_fma_f32 v[132:133], v[4:5], v[146:147], v[132:133] op_sel:[1,0,0] op_sel_hi:[1,1,1] neg_lo:[1,0,0] neg_hi:[1,0,0]
    v_pk_fma_f32 v[148:149], v[4:5], v[130:131], v[148:149] op_sel:[1,0,0] op_sel_hi:[1,1,1]
    v_pk_fma_f32 v[134:135], v[4:5], v[132:133], v[134:135] op_sel:[0,0,0] op_sel_hi:[0,1,1]
    v_pk_fma_f32 v[150:151], v[4:5], v[148:149], v[150:151] op_sel:[0,0,0] op_sel_hi:[0,1,1]
    v_pk_fma_f32 v[134:135], v[4:5], v[148:149], v[134:135] op_sel:[1,0,0] op_sel_hi:[1,1,1] neg_lo:[1,0,0] neg_hi:[1,0,0]
    v_pk_fma_f32 v[150:151], v[4:5], v[132:133], v[150:151] op_sel:[1,0,0] op_sel_hi:[1,1,1]
    v_pk_fma_f32 v[136:137], v[4:5], v[134:135], v[136:137] op_sel:[0,0,0] op_sel_hi:[0,1,1]
    v_pk_fma_f32 v[152:153], v[4:5], v[150:151], v[152:153] op_sel:[0,0,0] op_sel_hi:[0,1,1]
    v_pk_fma_f32 v[136:137], v[4:5], v[150:151], v[136:137] op_sel:[1,0,0] op_sel_hi:[1,1,1] neg_lo:[1,0,0] neg_hi:[1,0,0]
    v_pk_fma_f32 v[152:153], v[4:5], v[134:135], v[152:153] op_sel:[1,0,0] op_sel_hi:[1,1,1]
    v_pk_fma_f32 v[138:139], v[4:5], v[136:137], v[138:139] op_sel:[0,0,0] op_sel_hi:[0,1,1]
    v_pk_fma_f32 v[154:155], v[4:5], v[152:153], v[154:155] op_sel:[0,0,0] op_sel_hi:[0,1,1]
    v_pk_fma_f32 v[138:139], v[4:5], v[152:153], v[138:139] op_sel:[1,0,0] op_sel_hi:[1,1,1] neg_lo:[1,0,0] neg_hi:[1,0,0]
    v_pk_fma_f32 v[154:155], v[4:5], v[136:137], v[154:155] op_sel:[1,0,0] op_sel_hi:[1,1,1]
    v_pk_fma_f32 v[140:141], v[4:5], v[138:139], v[140:141] op_sel:[0,0,0] op_sel_hi:[0,1,1]
    v_pk_fma_f32 v[156:157], v[4:5], v[154:155], v[156:157] op_sel:[0,0,0] op_sel_hi:[0,1,1]
    v_pk_fma_f32 v[140:141], v[4:5], v[154:155], v[140:141] op_sel:[1,0,0] op_sel_hi:[1,1,1] neg_lo:[1,0,0] neg_hi:[1,0,0]
    v_pk_fma_f32 v[156:157], v[4:5], v[138:139], v[156:157] op_sel:[1,0,0] op_sel_hi:[1,1,1]
    v_pk_fma_f32 v[142:143], v[4:5], v[140:141], v[142:143] op_sel:[0,0,0] op_sel_hi:[0,1,1]
    v_pk_fma_f32 v[158:159], v[4:5], v[156:157], v[158:159] op_sel:[0,0,0] op_sel_hi:[0,1,1]
    v_pk_fma_f32 v[142:143], v[4:5], v[156:157], v[142:143] op_sel:[1,0,0] op_sel_hi:[1,1,1] neg_lo:[1,0,0] neg_hi:[1,0,0]
    v_pk_fma_f32 v[158:159], v[4:5], v[140:141], v[158:159] op_sel:[1,0,0] op_sel_hi:[1,1,1]
    v_cvt_pk_bf16_f32 v120, v128, v130
    v_cvt_pk_bf16_f32 v121, v132, v134
    v_cvt_pk_bf16_f32 v122, v136, v138
    v_cvt_pk_bf16_f32 v123, v140, v142
    s_mov_b32 s30, 0
    buffer_store_dwordx4 v[120:123], v6, s[64:67], s30 offen sc0 sc1
    v_cvt_pk_bf16_f32 v124, v144, v146
    v_cvt_pk_bf16_f32 v125, v148, v150
    v_cvt_pk_bf16_f32 v126, v152, v154
    v_cvt_pk_bf16_f32 v127, v156, v158
    s_mov_b32 s30, 512
    buffer_store_dwordx4 v[124:127], v6, s[64:67], s30 offen sc0 sc1
    v_cvt_pk_bf16_f32 v120, v129, v131
    v_cvt_pk_bf16_f32 v121, v133, v135
    v_cvt_pk_bf16_f32 v122, v137, v139
    v_cvt_pk_bf16_f32 v123, v141, v143
    s_mov_b32 s30, 4096
    buffer_store_dwordx4 v[120:123], v6, s[64:67], s30 offen sc0 sc1
    v_cvt_pk_bf16_f32 v124, v145, v147
    v_cvt_pk_bf16_f32 v125, v149, v151
    v_cvt_pk_bf16_f32 v126, v153, v155
    v_cvt_pk_bf16_f32 v127, v157, v159
    s_mov_b32 s30, 4608
    buffer_store_dwordx4 v[124:127], v6, s[64:67], s30 offen sc0 sc1
    v_pk_fma_f32 v[160:161], v[4:5], v[142:143], v[160:161] op_sel:[0,0,0] op_sel_hi:[0,1,1]
    v_pk_fma_f32 v[176:177], v[4:5], v[158:159], v[176:177] op_sel:[0,0,0] op_sel_hi:[0,1,1]
    v_pk_fma_f32 v[160:161], v[4:5], v[158:159], v[160:161] op_sel:[1,0,0] op_sel_hi:[1,1,1] neg_lo:[1,0,0] neg_hi:[1,0,0]
    v_pk_fma_f32 v[176:177], v[4:5], v[142:143], v[176:177] op_sel:[1,0,0] op_sel_hi:[1,1,1]
    v_pk_fma_f32 v[162:163], v[4:5], v[160:161], v[162:163] op_sel:[0,0,0] op_sel_hi:[0,1,1]
    v_pk_fma_f32 v[178:179], v[4:5], v[176:177], v[178:179] op_sel:[0,0,0] op_sel_hi:[0,1,1]
    v_pk_fma_f32 v[162:163], v[4:5], v[176:177], v[162:163] op_sel:[1,0,0] op_sel_hi:[1,1,1] neg_lo:[1,0,0] neg_hi:[1,0,0]
    v_pk_fma_f32 v[178:179], v[4:5], v[160:161], v[178:179] op_sel:[1,0,0] op_sel_hi:[1,1,1]
    v_pk_fma_f32 v[164:165], v[4:5], v[162:163], v[164:165] op_sel:[0,0,0] op_sel_hi:[0,1,1]
    v_pk_fma_f32 v[180:181], v[4:5], v[178:179], v[180:181] op_sel:[0,0,0] op_sel_hi:[0,1,1]
    v_pk_fma_f32 v[164:165], v[4:5], v[178:179], v[164:165] op_sel:[1,0,0] op_sel_hi:[1,1,1] neg_lo:[1,0,0] neg_hi:[1,0,0]
    v_pk_fma_f32 v[180:181], v[4:5], v[162:163], v[180:181] op_sel:[1,0,0] op_sel_hi:[1,1,1]
    v_pk_fma_f32 v[166:167], v[4:5], v[164:165], v[166:167] op_sel:[0,0,0] op_sel_hi:[0,1,1]
    v_pk_fma_f32 v[182:183], v[4:5], v[180:181], v[182:183] op_sel:[0,0,0] op_sel_hi:[0,1,1]
    v_pk_fma_f32 v[166:167], v[4:5], v[180:181], v[166:167] op_sel:[1,0,0] op_sel_hi:[1,1,1] neg_lo:[1,0,0] neg_hi:[1,0,0]
    v_pk_fma_f32 v[182:183], v[4:5], v[164:165], v[182:183] op_sel:[1,0,0] op_sel_hi:[1,1,1]
    v_pk_fma_f32 v[168:169], v[4:5], v[166:167], v[168:169] op_sel:[0,0,0] op_sel_hi:[0,1,1]
    v_pk_fma_f32 v[184:185], v[4:5], v[182:183], v[184:185] op_sel:[0,0,0] op_sel_hi:[0,1,1]
    v_pk_fma_f32 v[168:169], v[4:5], v[182:183], v[168:169] op_sel:[1,0,0] op_sel_hi:[1,1,1] neg_lo:[1,0,0] neg_hi:[1,0,0]
    v_pk_fma_f32 v[184:185], v[4:5], v[166:167], v[184:185] op_sel:[1,0,0] op_sel_hi:[1,1,1]
    v_pk_fma_f32 v[170:171], v[4:5], v[168:169], v[170:171] op_sel:[0,0,0] op_sel_hi:[0,1,1]
    v_pk_fma_f32 v[186:187], v[4:5], v[184:185], v[186:187] op_sel:[0,0,0] op_sel_hi:[0,1,1]
    v_pk_fma_f32 v[170:171], v[4:5], v[184:185], v[170:171] op_sel:[1,0,0] op_sel_hi:[1,1,1] neg_lo:[1,0,0] neg_hi:[1,0,0]
    v_pk_fma_f32 v[186:187], v[4:5], v[168:169], v[186:187] op_sel:[1,0,0] op_sel_hi:[1,1,1]
    v_pk_fma_f32 v[172:173], v[4:5], v[170:171], v[172:173] op_sel:[0,0,0] op_sel_hi:[0,1,1]
    v_pk_fma_f32 v[188:189], v[4:5], v[186:187], v[188:189] op_sel:[0,0,0] op_sel_hi:[0,1,1]
    v_pk_fma_f32 v[172:173], v[4:5], v[186:187], v[172:173] op_sel:[1,0,0] op_sel_hi:[1,1,1] neg_lo:[1,0,0] neg_hi:[1,0,0]
    v_pk_fma_f32 v[188:189], v[4:5], v[170:171], v[188:189] op_sel:[1,0,0] op_sel_hi:[1,1,1]
    v_pk_fma_f32 v[174:175], v[4:5], v[172:173], v[174:175] op_sel:[0,0,0] op_sel_hi:[0,1,1]
    v_pk_fma_f32 v[190:191], v[4:5], v[188:189], v[190:191] op_sel:[0,0,0] op_sel_hi:[0,1,1]
    v_pk_fma_f32 v[174:175], v[4:5], v[188:189], v[174:175] op_sel:[1,0,0] op_sel_hi:[1,1,1] neg_lo:[1,0,0] neg_hi:[1,0,0]
    v_pk_fma_f32 v[190:191], v[4:5], v[172:173], v[190:191] op_sel:[1,0,0] op_sel_hi:[1,1,1]
    v_cvt_pk_bf16_f32 v120, v160, v162
    v_cvt_pk_bf16_f32 v121, v164, v166
    v_cvt_pk_bf16_f32 v122, v168, v170
    v_cvt_pk_bf16_f32 v123, v172, v174
    s_mov_b32 s30, 1024
    buffer_store_dwordx4 v[120:123], v6, s[64:67], s30 offen sc0 sc1
    v_cvt_pk_bf16_f32 v124, v176, v178
    v_cvt_pk_bf16_f32 v125, v180, v182
    v_cvt_pk_bf16_f32 v126, v184, v186
    v_cvt_pk_bf16_f32 v127, v188, v190
    s_mov_b32 s30, 1536
    buffer_store_dwordx4 v[124:127], v6, s[64:67], s30 offen sc0 sc1
    v_cvt_pk_bf16_f32 v120, v161, v163
    v_cvt_pk_bf16_f32 v121, v165, v167
    v_cvt_pk_bf16_f32 v122, v169, v171
    v_cvt_pk_bf16_f32 v123, v173, v175
    s_mov_b32 s30, 5120
    buffer_store_dwordx4 v[120:123], v6, s[64:67], s30 offen sc0 sc1
    v_cvt_pk_bf16_f32 v124, v177, v179
    v_cvt_pk_bf16_f32 v125, v181, v183
    v_cvt_pk_bf16_f32 v126, v185, v187
    v_cvt_pk_bf16_f32 v127, v189, v191
    s_mov_b32 s30, 5632
    buffer_store_dwordx4 v[124:127], v6, s[64:67], s30 offen sc0 sc1
    v_pk_fma_f32 v[192:193], v[4:5], v[174:175], v[192:193] op_sel:[0,0,0] op_sel_hi:[0,1,1]
    v_pk_fma_f32 v[208:209], v[4:5], v[190:191], v[208:209] op_sel:[0,0,0] op_sel_hi:[0,1,1]
    v_pk_fma_f32 v[192:193], v[4:5], v[190:191], v[192:193] op_sel:[1,0,0] op_sel_hi:[1,1,1] neg_lo:[1,0,0] neg_hi:[1,0,0]
    v_pk_fma_f32 v[208:209], v[4:5], v[174:175], v[208:209] op_sel:[1,0,0] op_sel_hi:[1,1,1]
    v_pk_fma_f32 v[194:195], v[4:5], v[192:193], v[194:195] op_sel:[0,0,0] op_sel_hi:[0,1,1]
    v_pk_fma_f32 v[210:211], v[4:5], v[208:209], v[210:211] op_sel:[0,0,0] op_sel_hi:[0,1,1]
    v_pk_fma_f32 v[194:195], v[4:5], v[208:209], v[194:195] op_sel:[1,0,0] op_sel_hi:[1,1,1] neg_lo:[1,0,0] neg_hi:[1,0,0]
    v_pk_fma_f32 v[210:211], v[4:5], v[192:193], v[210:211] op_sel:[1,0,0] op_sel_hi:[1,1,1]
    v_pk_fma_f32 v[196:197], v[4:5], v[194:195], v[196:197] op_sel:[0,0,0] op_sel_hi:[0,1,1]
    v_pk_fma_f32 v[212:213], v[4:5], v[210:211], v[212:213] op_sel:[0,0,0] op_sel_hi:[0,1,1]
    v_pk_fma_f32 v[196:197], v[4:5], v[210:211], v[196:197] op_sel:[1,0,0] op_sel_hi:[1,1,1] neg_lo:[1,0,0] neg_hi:[1,0,0]
    v_pk_fma_f32 v[212:213], v[4:5], v[194:195], v[212:213] op_sel:[1,0,0] op_sel_hi:[1,1,1]
    v_pk_fma_f32 v[198:199], v[4:5], v[196:197], v[198:199] op_sel:[0,0,0] op_sel_hi:[0,1,1]
    v_pk_fma_f32 v[214:215], v[4:5], v[212:213], v[214:215] op_sel:[0,0,0] op_sel_hi:[0,1,1]
    v_pk_fma_f32 v[198:199], v[4:5], v[212:213], v[198:199] op_sel:[1,0,0] op_sel_hi:[1,1,1] neg_lo:[1,0,0] neg_hi:[1,0,0]
    v_pk_fma_f32 v[214:215], v[4:5], v[196:197], v[214:215] op_sel:[1,0,0] op_sel_hi:[1,1,1]
    v_pk_fma_f32 v[200:201], v[4:5], v[198:199], v[200:201] op_sel:[0,0,0] op_sel_hi:[0,1,1]
    v_pk_fma_f32 v[216:217], v[4:5], v[214:215], v[216:217] op_sel:[0,0,0] op_sel_hi:[0,1,1]
    v_pk_fma_f32 v[200:201], v[4:5], v[214:215], v[200:201] op_sel:[1,0,0] op_sel_hi:[1,1,1] neg_lo:[1,0,0] neg_hi:[1,0,0]
    v_pk_fma_f32 v[216:217], v[4:5], v[198:199], v[216:217] op_sel:[1,0,0] op_sel_hi:[1,1,1]
    v_pk_fma_f32 v[202:203], v[4:5], v[200:201], v[202:203] op_sel:[0,0,0] op_sel_hi:[0,1,1]
    v_pk_fma_f32 v[218:219], v[4:5], v[216:217], v[218:219] op_sel:[0,0,0] op_sel_hi:[0,1,1]
    v_pk_fma_f32 v[202:203], v[4:5], v[216:217], v[202:203] op_sel:[1,0,0] op_sel_hi:[1,1,1] neg_lo:[1,0,0] neg_hi:[1,0,0]
    v_pk_fma_f32 v[218:219], v[4:5], v[200:201], v[218:219] op_sel:[1,0,0] op_sel_hi:[1,1,1]
    v_pk_fma_f32 v[204:205], v[4:5], v[202:203], v[204:205] op_sel:[0,0,0] op_sel_hi:[0,1,1]
    v_pk_fma_f32 v[220:221], v[4:5], v[218:219], v[220:221] op_sel:[0,0,0] op_sel_hi:[0,1,1]
    v_pk_fma_f32 v[204:205], v[4:5], v[218:219], v[204:205] op_sel:[1,0,0] op_sel_hi:[1,1,1] neg_lo:[1,0,0] neg_hi:[1,0,0]
    v_pk_fma_f32 v[220:221], v[4:5], v[202:203], v[220:221] op_sel:[1,0,0] op_sel_hi:[1,1,1]
    v_pk_fma_f32 v[206:207], v[4:5], v[204:205], v[206:207] op_sel:[0,0,0] op_sel_hi:[0,1,1]
    v_pk_fma_f32 v[222:223], v[4:5], v[220:221], v[222:223] op_sel:[0,0,0] op_sel_hi:[0,1,1]
    v_pk_fma_f32 v[206:207], v[4:5], v[220:221], v[206:207] op_sel:[1,0,0] op_sel_hi:[1,1,1] neg_lo:[1,0,0] neg_hi:[1,0,0]
    v_pk_fma_f32 v[222:223], v[4:5], v[204:205], v[222:223] op_sel:[1,0,0] op_sel_hi:[1,1,1]
    v_cvt_pk_bf16_f32 v120, v192, v194
    v_cvt_pk_bf16_f32 v121, v196, v198
    v_cvt_pk_bf16_f32 v122, v200, v202
    v_cvt_pk_bf16_f32 v123, v204, v206
    s_mov_b32 s30, 2048
    buffer_store_dwordx4 v[120:123], v6, s[64:67], s30 offen sc0 sc1
    v_cvt_pk_bf16_f32 v124, v208, v210
    v_cvt_pk_bf16_f32 v125, v212, v214
    v_cvt_pk_bf16_f32 v126, v216, v218
    v_cvt_pk_bf16_f32 v127, v220, v222
    s_mov_b32 s30, 2560
    buffer_store_dwordx4 v[124:127], v6, s[64:67], s30 offen sc0 sc1
    v_cvt_pk_bf16_f32 v120, v193, v195
    v_cvt_pk_bf16_f32 v121, v197, v199
    v_cvt_pk_bf16_f32 v122, v201, v203
    v_cvt_pk_bf16_f32 v123, v205, v207
    s_mov_b32 s30, 6144
    buffer_store_dwordx4 v[120:123], v6, s[64:67], s30 offen sc0 sc1
    v_cvt_pk_bf16_f32 v124, v209, v211
    v_cvt_pk_bf16_f32 v125, v213, v215
    v_cvt_pk_bf16_f32 v126, v217, v219
    v_cvt_pk_bf16_f32 v127, v221, v223
    s_mov_b32 s30, 6656
    buffer_store_dwordx4 v[124:127], v6, s[64:67], s30 offen sc0 sc1
    v_pk_fma_f32 v[224:225], v[4:5], v[206:207], v[224:225] op_sel:[0,0,0] op_sel_hi:[0,1,1]
    v_pk_fma_f32 v[240:241], v[4:5], v[222:223], v[240:241] op_sel:[0,0,0] op_sel_hi:[0,1,1]
    v_pk_fma_f32 v[224:225], v[4:5], v[222:223], v[224:225] op_sel:[1,0,0] op_sel_hi:[1,1,1] neg_lo:[1,0,0] neg_hi:[1,0,0]
    v_pk_fma_f32 v[240:241], v[4:5], v[206:207], v[240:241] op_sel:[1,0,0] op_sel_hi:[1,1,1]
    v_pk_fma_f32 v[226:227], v[4:5], v[224:225], v[226:227] op_sel:[0,0,0] op_sel_hi:[0,1,1]
    v_pk_fma_f32 v[242:243], v[4:5], v[240:241], v[242:243] op_sel:[0,0,0] op_sel_hi:[0,1,1]
    v_pk_fma_f32 v[226:227], v[4:5], v[240:241], v[226:227] op_sel:[1,0,0] op_sel_hi:[1,1,1] neg_lo:[1,0,0] neg_hi:[1,0,0]
    v_pk_fma_f32 v[242:243], v[4:5], v[224:225], v[242:243] op_sel:[1,0,0] op_sel_hi:[1,1,1]
    v_pk_fma_f32 v[228:229], v[4:5], v[226:227], v[228:229] op_sel:[0,0,0] op_sel_hi:[0,1,1]
    v_pk_fma_f32 v[244:245], v[4:5], v[242:243], v[244:245] op_sel:[0,0,0] op_sel_hi:[0,1,1]
    v_pk_fma_f32 v[228:229], v[4:5], v[242:243], v[228:229] op_sel:[1,0,0] op_sel_hi:[1,1,1] neg_lo:[1,0,0] neg_hi:[1,0,0]
    v_pk_fma_f32 v[244:245], v[4:5], v[226:227], v[244:245] op_sel:[1,0,0] op_sel_hi:[1,1,1]
    v_pk_fma_f32 v[230:231], v[4:5], v[228:229], v[230:231] op_sel:[0,0,0] op_sel_hi:[0,1,1]
    v_pk_fma_f32 v[246:247], v[4:5], v[244:245], v[246:247] op_sel:[0,0,0] op_sel_hi:[0,1,1]
    v_pk_fma_f32 v[230:231], v[4:5], v[244:245], v[230:231] op_sel:[1,0,0] op_sel_hi:[1,1,1] neg_lo:[1,0,0] neg_hi:[1,0,0]
    v_pk_fma_f32 v[246:247], v[4:5], v[228:229], v[246:247] op_sel:[1,0,0] op_sel_hi:[1,1,1]
    v_pk_fma_f32 v[232:233], v[4:5], v[230:231], v[232:233] op_sel:[0,0,0] op_sel_hi:[0,1,1]
    v_pk_fma_f32 v[248:249], v[4:5], v[246:247], v[248:249] op_sel:[0,0,0] op_sel_hi:[0,1,1]
    v_pk_fma_f32 v[232:233], v[4:5], v[246:247], v[232:233] op_sel:[1,0,0] op_sel_hi:[1,1,1] neg_lo:[1,0,0] neg_hi:[1,0,0]
    v_pk_fma_f32 v[248:249], v[4:5], v[230:231], v[248:249] op_sel:[1,0,0] op_sel_hi:[1,1,1]
    v_pk_fma_f32 v[234:235], v[4:5], v[232:233], v[234:235] op_sel:[0,0,0] op_sel_hi:[0,1,1]
    v_pk_fma_f32 v[250:251], v[4:5], v[248:249], v[250:251] op_sel:[0,0,0] op_sel_hi:[0,1,1]
    v_pk_fma_f32 v[234:235], v[4:5], v[248:249], v[234:235] op_sel:[1,0,0] op_sel_hi:[1,1,1] neg_lo:[1,0,0] neg_hi:[1,0,0]
    v_pk_fma_f32 v[250:251], v[4:5], v[232:233], v[250:251] op_sel:[1,0,0] op_sel_hi:[1,1,1]
    v_pk_fma_f32 v[236:237], v[4:5], v[234:235], v[236:237] op_sel:[0,0,0] op_sel_hi:[0,1,1]
    v_pk_fma_f32 v[252:253], v[4:5], v[250:251], v[252:253] op_sel:[0,0,0] op_sel_hi:[0,1,1]
    v_pk_fma_f32 v[236:237], v[4:5], v[250:251], v[236:237] op_sel:[1,0,0] op_sel_hi:[1,1,1] neg_lo:[1,0,0] neg_hi:[1,0,0]
    v_pk_fma_f32 v[252:253], v[4:5], v[234:235], v[252:253] op_sel:[1,0,0] op_sel_hi:[1,1,1]
    v_pk_fma_f32 v[238:239], v[4:5], v[236:237], v[238:239] op_sel:[0,0,0] op_sel_hi:[0,1,1]
    v_pk_fma_f32 v[254:255], v[4:5], v[252:253], v[254:255] op_sel:[0,0,0] op_sel_hi:[0,1,1]
    v_pk_fma_f32 v[238:239], v[4:5], v[252:253], v[238:239] op_sel:[1,0,0] op_sel_hi:[1,1,1] neg_lo:[1,0,0] neg_hi:[1,0,0]
    v_pk_fma_f32 v[254:255], v[4:5], v[236:237], v[254:255] op_sel:[1,0,0] op_sel_hi:[1,1,1]
    v_cvt_pk_bf16_f32 v120, v224, v226
    v_cvt_pk_bf16_f32 v121, v228, v230
    v_cvt_pk_bf16_f32 v122, v232, v234
    v_cvt_pk_bf16_f32 v123, v236, v238
    s_mov_b32 s30, 3072
    buffer_store_dwordx4 v[120:123], v6, s[64:67], s30 offen sc0 sc1
    v_cvt_pk_bf16_f32 v124, v240, v242
    v_cvt_pk_bf16_f32 v125, v244, v246
    v_cvt_pk_bf16_f32 v126, v248, v250
    v_cvt_pk_bf16_f32 v127, v252, v254
    s_mov_b32 s30, 3584
    buffer_store_dwordx4 v[124:127], v6, s[64:67], s30 offen sc0 sc1
    v_cvt_pk_bf16_f32 v120, v225, v227
    v_cvt_pk_bf16_f32 v121, v229, v231
    v_cvt_pk_bf16_f32 v122, v233, v235
    v_cvt_pk_bf16_f32 v123, v237, v239
    s_mov_b32 s30, 7168
    buffer_store_dwordx4 v[120:123], v6, s[64:67], s30 offen sc0 sc1
    v_cvt_pk_bf16_f32 v124, v241, v243
    v_cvt_pk_bf16_f32 v125, v245, v247
    v_cvt_pk_bf16_f32 v126, v249, v251
    v_cvt_pk_bf16_f32 v127, v253, v255
    s_mov_b32 s30, 7680
    buffer_store_dwordx4 v[124:127], v6, s[64:67], s30 offen sc0 sc1
    s_branch L_r0
L_h0b:
    s_mov_b32 s60, s8
    s_and_b32 s61, s9, 0xffff
    s_mov_b32 s62, 7864320
    s_mov_b32 s63, 0x00020000
    s_barrier
    s_add_u32 s32, s96, 7
    s_and_b32 s32, s32, 7
    s_mul_i32 s32, s32, 10240
    s_add_u32 m0, s74, 143360
    s_add_u32 s32, s32, s75
    buffer_load_dwordx4 v107, s[60:63], s32 offen offset:0 sc1 lds
    buffer_load_dwordx4 v107, s[60:63], s32 offen offset:1024 sc1 lds
    buffer_load_dwordx4 v107, s[60:63], s32 offen offset:2048 sc1 lds
    buffer_load_dwordx4 v107, s[60:63], s32 offen offset:3072 sc1 lds
    s_add_u32 m0, s74, 147456
    s_add_u32 s32, s32, 4096
    buffer_load_dwordx4 v107, s[60:63], s32 offen offset:0 sc1 lds
    s_cmp_lg_u32 s36, 2
    s_cbranch_scc1 L_r0
L_h0p:
    s_add_u32 s64, s8, 15728640
    s_addc_u32 s65, s9, 0
    s_and_b32 s65, s65, 0xffff
    s_mov_b32 s66, 1802240
    s_mov_b32 s67, 0x00020000
    buffer_store_dwordx4 v[240:243], v248, s[64:67], 0 offen sc0 sc1
    buffer_store_dwordx4 v[244:247], v249, s[64:67], 0 offen sc0 sc1
    s_mov_b32 s30, 0
    buffer_store_dwordx4 v[128:131], v250, s[64:67], s30 offen sc0 sc1
    s_mov_b32 s30, 8448
    buffer_store_dwordx4 v[136:139], v250, s[64:67], s30 offen sc0 sc1
    s_mov_b32 s30, 16896
    buffer_store_dwordx4 v[144:147], v250, s[64:67], s30 offen sc0 sc1
    s_mov_b32 s30, 25344
    buffer_store_dwordx4 v[152:155], v250, s[64:67], s30 offen sc0 sc1
    s_mov_b32 s30, 33792
    buffer_store_dwordx4 v[160:163], v250, s[64:67], s30 offen sc0 sc1
    s_mov_b32 s30, 42240
    buffer_store_dwordx4 v[168:171], v250, s[64:67], s30 offen sc0 sc1
    s_mov_b32 s30, 50688
    buffer_store_dwordx4 v[176:179], v250, s[64:67], s30 offen sc0 sc1
    s_mov_b32 s30, 59136
    buffer_store_dwordx4 v[184:187], v250, s[64:67], s30 offen sc0 sc1
    s_mov_b32 s30, 67584
    buffer_store_dwordx4 v[192:195], v250, s[64:67], s30 offen sc0 sc1
    s_mov_b32 s30, 76032
    buffer_store_dwordx4 v[200:203], v250, s[64:67], s30 offen sc0 sc1
    s_mov_b32 s30, 84480
    buffer_store_dwordx4 v[208:211], v250, s[64:67], s30 offen sc0 sc1
    s_mov_b32 s30, 92928
    buffer_store_dwordx4 v[216:219], v250, s[64:67], s30 offen sc0 sc1
    s_mov_b32 s30, 101376
    buffer_store_dwordx4 v[224:227], v250, s[64:67], s30 offen sc0 sc1
    s_mov_b32 s30, 109824
    buffer_store_dwordx4 v[232:235], v251, s[64:67], s30 offen sc0 sc1
    s_branch L_r0
L_h0c:
    s_waitcnt vmcnt(0)
    s_cmp_lg_u32 s29, 4
    s_cbranch_scc1 L_w4_30
    s_and_b32 s30, s24, 3
    s_mul_i32 s30, s30, 8704
    s_add_u32 s30, s30, 182784
    s_mov_b32 s72, 0
    s_branch L_chk_33
L_poll_31:
    v_mov_b32 v117, 0
    s_mov_b64 exec, 1
    buffer_atomic_add v117, off, s[44:47], s30 sc0 sc1
    s_mov_b64 exec, -1
    s_waitcnt vmcnt(0)
L_chk_33:
    v_readfirstlane_b32 s99, v117
    s_add_u32 s72, s72, 1
    s_nop 2
    s_cmp_eq_u32 s99, 168
    s_cbranch_scc1 L_polled_32
    s_sleep 1
    s_cmp_lt_u32 s72, 0x20000
    s_cbranch_scc1 L_poll_31
L_polled_32:
    s_add_u32 s30, s30, 4352
    s_mov_b32 s72, 0
    s_branch L_chk_36
L_poll_34:
    v_mov_b32 v119, 0
    s_mov_b64 exec, 1
    buffer_atomic_add v119, off, s[44:47], s30 sc0 sc1
    s_mov_b64 exec, -1
    s_waitcnt vmcnt(0)
L_chk_36:
    v_readfirstlane_b32 s99, v119
    s_add_u32 s72, s72, 1
    s_nop 2
    s_cmp_eq_u32 s99, 168
    s_cbranch_scc1 L_polled_35
    s_sleep 1
    s_cmp_lt_u32 s72, 0x20000
    s_cbranch_scc1 L_poll_34
L_polled_35:
L_w4_30:
    s_barrier
    s_setprio 3
    s_cmp_ge_u32 s29, 5
    s_cbranch_scc1 L_pfw
    s_add_u32 s64, s8, 10485760
    s_addc_u32 s65, s9, 0
    s_and_b32 s65, s65, 0xffff
    s_mov_b32 s66, 5242880
    s_mov_b32 s67, 0x00020000
    s_and_b32 s30, s24, 3
    s_lshl_b32 s30, s30, 5
    s_add_u32 s30, s30, s25
    s_lshl_b32 s30, s30, 11
    s_lshl_b32 s31, s29, 20
    s_add_u32 s30, s30, s31
    v_lshrrev_b32 v118, 4, v2
    v_lshlrev_b32 v118, 18, v118
    v_and_b32 v119, 15, v2
    v_lshl_add_u32 v118, v119, 7, v118
    v_add_u32 v118, s30, v118
    buffer_load_dword v122, v118, s[64:67], 0 offen sc1
    s_cmp_lt_u32 s29, 4
    s_cbranch_scc1 L_r0
L_pfw:
    v_lshlrev_b32 v118, 7, v2
    s_add_u32 s64, s8, 15728640
    s_addc_u32 s65, s9, 0
    s_and_b32 s65, s65, 0xffff
    s_mov_b32 s66, 1802240
    s_mov_b32 s67, 0x00020000
    s_lshr_b32 s30, s24, 2
    s_lshl_b32 s30, s30, 5
    s_add_u32 s30, s30, s25
    s_mul_i32 s30, s30, 28160
    s_mul_i32 s31, s38, 6656
    s_add_u32 s30, s30, s31
    v_add_u32 v119, s30, v118
    buffer_load_dword v122, v119, s[64:67], 0 offen sc1
    s_branch L_r0
L_D:
    s_cmp_lt_u32 s29, 4
    s_cbranch_scc1 L_D_comp
    s_mov_b32 s20, s4
    s_and_b32 s21, s5, 0xffff
    s_mov_b32 s22, 2621440
    s_mov_b32 s23, 0x00020000
    s_add_u32 s16, s8, 15728640
    s_addc_u32 s17, s9, 0
    s_and_b32 s17, s17, 0xffff
    s_mov_b32 s18, 1802240
    s_mov_b32 s19, 0x00020000
    s_add_u32 s52, s8, 10485760
    s_addc_u32 s53, s9, 0
    s_and_b32 s53, s53, 0xffff
    s_mov_b32 s54, 5242880
    s_mov_b32 s55, 0x00020000
    s_barrier
    s_add_u32 m0, s34, 49152
    s_lshl_b32 s32, s98, 18
    buffer_load_dwordx4 v176, s[52:55], s32 offen offset:0 sc1 lds
    buffer_load_dwordx4 v177, s[52:55], s32 offen offset:1024 sc1 lds
    buffer_load_dwordx4 v178, s[52:55], s32 offen offset:2048 sc1 lds
    buffer_load_dwordx4 v179, s[52:55], s32 offen offset:3072 sc1 lds
    s_add_u32 m0, s35, 65536
    s_lshl_b32 s33, s98, 7
    buffer_load_dwordx4 v180, s[16:19], s33 offen offset:0 sc1 lds
    buffer_load_dwordx4 v181, s[16:19], s33 offen offset:1024 sc1 lds
    s_add_u32 s98, s98, 1
    s_cmp_eq_u32 s98, 20
    s_cselect_b32 s98, 0, s98
    s_add_u32 m0, s34, 73728
    s_lshl_b32 s32, s98, 18
    buffer_load_dwordx4 v176, s[52:55], s32 offen offset:0 sc1 lds
    buffer_load_dwordx4 v177, s[52:55], s32 offen offset:1024 sc1 lds
    buffer_load_dwordx4 v178, s[52:55], s32 offen offset:2048 sc1 lds
    buffer_load_dwordx4 v179, s[52:55], s32 offen offset:3072 sc1 lds
    s_add_u32 m0, s35, 90112
    s_lshl_b32 s33, s98, 7
    buffer_load_dwordx4 v180, s[16:19], s33 offen offset:0 sc1 lds
    buffer_load_dwordx4 v181, s[16:19], s33 offen offset:1024 sc1 lds
    s_add_u32 s98, s98, 1
    s_cmp_eq_u32 s98, 20
    s_cselect_b32 s98, 0, s98
    s_waitcnt vmcnt(12)
    s_barrier
    s_barrier
    s_add_u32 m0, s34, 98304
    s_lshl_b32 s32, s98, 18
    buffer_load_dwordx4 v176, s[52:55], s32 offen offset:0 sc1 lds
    buffer_load_dwordx4 v177, s[52:55], s32 offen offset:1024 sc1 lds
    buffer_load_dwordx4 v178, s[52:55], s32 offen offset:2048 sc1 lds
    buffer_load_dwordx4 v179, s[52:55], s32 offen offset:3072 sc1 lds
    s_add_u32 m0, s35, 114688
    s_lshl_b32 s33, s98, 7
    buffer_load_dwordx4 v180, s[16:19], s33 offen offset:0 sc1 lds
    buffer_load_dwordx4 v181, s[16:19], s33 offen offset:1024 sc1 lds
    s_add_u32 s98, s98, 1
    s_cmp_eq_u32 s98, 20
    s_cselect_b32 s98, 0, s98
    s_barrier
    s_add_u32 m0, s34, 122880
    s_lshl_b32 s32, s98, 18
    buffer_load_dwordx4 v176, s[52:55], s32 offen offset:0 sc1 lds
    buffer_load_dwordx4 v177, s[52:55], s32 offen offset:1024 sc1 lds
    buffer_load_dwordx4 v178, s[52:55], s32 offen offset:2048 sc1 lds
    buffer_load_dwordx4 v179, s[52:55], s32 offen offset:3072 sc1 lds
    s_add_u32 m0, s35, 139264
    s_lshl_b32 s33, s98, 7
    buffer_load_dwordx4 v180, s[16:19], s33 offen offset:0 sc1 lds
    buffer_load_dwordx4 v181, s[16:19], s33 offen offset:1024 sc1 lds
    s_add_u32 s98, s98, 1
    s_cmp_eq_u32 s98, 20
    s_cselect_b32 s98, 0, s98
    s_waitcnt vmcnt(18)
    s_barrier
    s_add_u32 m0, s34, 0
    s_lshl_b32 s32, s98, 18
    buffer_load_dwordx4 v176, s[52:55], s32 offen offset:0 sc1 lds
    buffer_load_dwordx4 v177, s[52:55], s32 offen offset:1024 sc1 lds
    buffer_load_dwordx4 v178, s[52:55], s32 offen offset:2048 sc1 lds
    buffer_load_dwordx4 v179, s[52:55], s32 offen offset:3072 sc1 lds
    s_add_u32 m0, s35, 16384
    s_lshl_b32 s33, s98, 7
    buffer_load_dwordx4 v180, s[16:19], s33 offen offset:0 sc1 lds
    buffer_load_dwordx4 v181, s[16:19], s33 offen offset:1024 sc1 lds
    s_add_u32 s98, s98, 1
    s_cmp_eq_u32 s98, 20
    s_cselect_b32 s98, 0, s98
    s_waitcnt vmcnt(18)
    s_barrier
    s_add_u32 m0, s34, 24576
    s_lshl_b32 s32, s98, 18
    buffer_load_dwordx4 v176, s[52:55], s32 offen offset:0 sc1 lds
    buffer_load_dwordx4 v177, s[52:55], s32 offen offset:1024 sc1 lds
    buffer_load_dwordx4 v178, s[52:55], s32 offen offset:2048 sc1 lds
    buffer_load_dwordx4 v179, s[52:55], s32 offen offset:3072 sc1 lds
    s_add_u32 m0, s35, 40960
    s_lshl_b32 s33, s98, 7
    buffer_load_dwordx4 v180, s[16:19], s33 offen offset:0 sc1 lds
    buffer_load_dwordx4 v181, s[16:19], s33 offen offset:1024 sc1 lds
    s_add_u32 s98, s98, 1
    s_cmp_eq_u32 s98, 20
    s_cselect_b32 s98, 0, s98
    s_waitcnt vmcnt(18)
    s_barrier
    s_add_u32 m0, s34, 49152
    s_lshl_b32 s32, s98, 18
    buffer_load_dwordx4 v176, s[52:55], s32 offen offset:0 sc1 lds
    buffer_load_dwordx4 v177, s[52:55], s32 offen offset:1024 sc1 lds
    buffer_load_dwordx4 v178, s[52:55], s32 offen offset:2048 sc1 lds
    buffer_load_dwordx4 v179, s[52:55], s32 offen offset:3072 sc1 lds
    s_add_u32 m0, s35, 65536
    s_lshl_b32 s33, s98, 7
    buffer_load_dwordx4 v180, s[16:19], s33 offen offset:0 sc1 lds
    buffer_load_dwordx4 v181, s[16:19], s33 offen offset:1024 sc1 lds
    s_add_u32 s98, s98, 1
    s_cmp_eq_u32 s98, 20
    s_cselect_b32 s98, 0, s98
    s_waitcnt vmcnt(18)
    s_barrier
    s_add_u32 m0, s34, 73728
    s_lshl_b32 s32, s98, 18
    buffer_load_dwordx4 v176, s[52:55], s32 offen offset:0 sc1 lds
    buffer_load_dwordx4 v177, s[52:55], s32 offen offset:1024 sc1 lds
    buffer_load_dwordx4 v178, s[52:55], s32 offen offset:2048 sc1 lds
    buffer_load_dwordx4 v179, s[52:55], s32 offen offset:3072 sc1 lds
    s_add_u32 m0, s35, 90112
    s_lshl_b32 s33, s98, 7
    buffer_load_dwordx4 v180, s[16:19], s33 offen offset:0 sc1 lds
    buffer_load_dwordx4 v181, s[16:19], s33 offen offset:1024 sc1 lds
    s_add_u32 s98, s98, 1
    s_cmp_eq_u32 s98, 20
    s_cselect_b32 s98, 0, s98
    s_waitcnt vmcnt(18)
    s_barrier
    s_add_u32 m0, s34, 98304
    s_lshl_b32 s32, s98, 18
    buffer_load_dwordx4 v176, s[52:55], s32 offen offset:0 sc1 lds
    buffer_load_dwordx4 v177, s[52:55], s32 offen offset:1024 sc1 lds
    buffer_load_dwordx4 v178, s[52:55], s32 offen offset:2048 sc1 lds
    buffer_load_dwordx4 v179, s[52:55], s32 offen offset:3072 sc1 lds
    s_add_u32 m0, s35, 114688
    s_lshl_b32 s33, s98, 7
    buffer_load_dwordx4 v180, s[16:19], s33 offen offset:0 sc1 lds
    buffer_load_dwordx4 v181, s[16:19], s33 offen offset:1024 sc1 lds
    s_add_u32 s98, s98, 1
    s_cmp_eq_u32 s98, 20
    s_cselect_b32 s98, 0, s98
    s_waitcnt vmcnt(18)
    s_barrier
    s_add_u32 m0, s34, 122880
    s_lshl_b32 s32, s98, 18
    buffer_load_dwordx4 v176, s[52:55], s32 offen offset:0 sc1 lds
    buffer_load_dwordx4 v177, s[52:55], s32 offen offset:1024 sc1 lds
    buffer_load_dwordx4 v178, s[52:55], s32 offen offset:2048 sc1 lds
    buffer_load_dwordx4 v179, s[52:55], s32 offen offset:3072 sc1 lds
    s_add_u32 m0, s35, 139264
    s_lshl_b32 s33, s98, 7
    buffer_load_dwordx4 v180, s[16:19], s33 offen offset:0 sc1 lds
    buffer_load_dwordx4 v181, s[16:19], s33 offen offset:1024 sc1 lds
    s_add_u32 s98, s98, 1
    s_cmp_eq_u32 s98, 20
    s_cselect_b32 s98, 0, s98
    s_waitcnt vmcnt(18)
    s_barrier
    s_add_u32 m0, s34, 0
    s_lshl_b32 s32, s98, 18
    buffer_load_dwordx4 v176, s[52:55], s32 offen offset:0 sc1 lds
    buffer_load_dwordx4 v177, s[52:55], s32 offen offset:1024 sc1 lds
    buffer_load_dwordx4 v178, s[52:55], s32 offen offset:2048 sc1 lds
    buffer_load_dwordx4 v179, s[52:55], s32 offen offset:3072 sc1 lds
    s_add_u32 m0, s35, 16384
    s_lshl_b32 s33, s98, 7
    buffer_load_dwordx4 v180, s[16:19], s33 offen offset:0 sc1 lds
    buffer_load_dwordx4 v181, s[16:19], s33 offen offset:1024 sc1 lds
    s_add_u32 s98, s98, 1
    s_cmp_eq_u32 s98, 20
    s_cselect_b32 s98, 0, s98
    s_waitcnt vmcnt(18)
    s_barrier
    s_add_u32 m0, s34, 24576
    s_lshl_b32 s32, s98, 18
    buffer_load_dwordx4 v176, s[52:55], s32 offen offset:0 sc1 lds
    buffer_load_dwordx4 v177, s[52:55], s32 offen offset:1024 sc1 lds
    buffer_load_dwordx4 v178, s[52:55], s32 offen offset:2048 sc1 lds
    buffer_load_dwordx4 v179, s[52:55], s32 offen offset:3072 sc1 lds
    s_add_u32 m0, s35, 40960
    s_lshl_b32 s33, s98, 7
    buffer_load_dwordx4 v180, s[16:19], s33 offen offset:0 sc1 lds
    buffer_load_dwordx4 v181, s[16:19], s33 offen offset:1024 sc1 lds
    s_add_u32 s98, s98, 1
    s_cmp_eq_u32 s98, 20
    s_cselect_b32 s98, 0, s98
    s_waitcnt vmcnt(18)
    s_barrier
    s_add_u32 m0, s34, 49152
    s_lshl_b32 s32, s98, 18
    buffer_load_dwordx4 v176, s[52:55], s32 offen offset:0 sc1 lds
    buffer_load_dwordx4 v177, s[52:55], s32 offen offset:1024 sc1 lds
    buffer_load_dwordx4 v178, s[52:55], s32 offen offset:2048 sc1 lds
    buffer_load_dwordx4 v179, s[52:55], s32 offen offset:3072 sc1 lds
    s_add_u32 m0, s35, 65536
    s_lshl_b32 s33, s98, 7
    buffer_load_dwordx4 v180, s[16:19], s33 offen offset:0 sc1 lds
    buffer_load_dwordx4 v181, s[16:19], s33 offen offset:1024 sc1 lds
    s_add_u32 s98, s98, 1
    s_cmp_eq_u32 s98, 20
    s_cselect_b32 s98, 0, s98
    s_waitcnt vmcnt(18)
    s_barrier
    s_add_u32 m0, s34, 73728
    s_lshl_b32 s32, s98, 18
    buffer_load_dwordx4 v176, s[52:55], s32 offen offset:0 sc1 lds
    buffer_load_dwordx4 v177, s[52:55], s32 offen offset:1024 sc1 lds
    buffer_load_dwordx4 v178, s[52:55], s32 offen offset:2048 sc1 lds
    buffer_load_dwordx4 v179, s[52:55], s32 offen offset:3072 sc1 lds
    s_add_u32 m0, s35, 90112
    s_lshl_b32 s33, s98, 7
    buffer_load_dwordx4 v180, s[16:19], s33 offen offset:0 sc1 lds
    buffer_load_dwordx4 v181, s[16:19], s33 offen offset:1024 sc1 lds
    s_add_u32 s98, s98, 1
    s_cmp_eq_u32 s98, 20
    s_cselect_b32 s98, 0, s98
    s_waitcnt vmcnt(18)
    s_barrier
    s_add_u32 m0, s34, 98304
    s_lshl_b32 s32, s98, 18
    buffer_load_dwordx4 v176, s[52:55], s32 offen offset:0 sc1 lds
    buffer_load_dwordx4 v177, s[52:55], s32 offen offset:1024 sc1 lds
    buffer_load_dwordx4 v178, s[52:55], s32 offen offset:2048 sc1 lds
    buffer_load_dwordx4 v179, s[52:55], s32 offen offset:3072 sc1 lds
    s_add_u32 m0, s35, 114688
    s_lshl_b32 s33, s98, 7
    buffer_load_dwordx4 v180, s[16:19], s33 offen offset:0 sc1 lds
    buffer_load_dwordx4 v181, s[16:19], s33 offen offset:1024 sc1 lds
    s_add_u32 s98, s98, 1
    s_cmp_eq_u32 s98, 20
    s_cselect_b32 s98, 0, s98
    s_waitcnt vmcnt(18)
    s_barrier
    s_add_u32 m0, s34, 122880
    s_lshl_b32 s32, s98, 18
    buffer_load_dwordx4 v176, s[52:55], s32 offen offset:0 sc1 lds
    buffer_load_dwordx4 v177, s[52:55], s32 offen offset:1024 sc1 lds
    buffer_load_dwordx4 v178, s[52:55], s32 offen offset:2048 sc1 lds
    buffer_load_dwordx4 v179, s[52:55], s32 offen offset:3072 sc1 lds
    s_add_u32 m0, s35, 139264
    s_lshl_b32 s33, s98, 7
    buffer_load_dwordx4 v180, s[16:19], s33 offen offset:0 sc1 lds
    buffer_load_dwordx4 v181, s[16:19], s33 offen offset:1024 sc1 lds
    s_add_u32 s98, s98, 1
    s_cmp_eq_u32 s98, 20
    s_cselect_b32 s98, 0, s98
    s_waitcnt vmcnt(18)
    s_barrier
    s_add_u32 m0, s34, 0
    s_lshl_b32 s32, s98, 18
    buffer_load_dwordx4 v176, s[52:55], s32 offen offset:0 sc1 lds
    buffer_load_dwordx4 v177, s[52:55], s32 offen offset:1024 sc1 lds
    buffer_load_dwordx4 v178, s[52:55], s32 offen offset:2048 sc1 lds
    buffer_load_dwordx4 v179, s[52:55], s32 offen offset:3072 sc1 lds
    s_add_u32 m0, s35, 16384
    s_lshl_b32 s33, s98, 7
    buffer_load_dwordx4 v180, s[16:19], s33 offen offset:0 sc1 lds
    buffer_load_dwordx4 v181, s[16:19], s33 offen offset:1024 sc1 lds
    s_add_u32 s98, s98, 1
    s_cmp_eq_u32 s98, 20
    s_cselect_b32 s98, 0, s98
    s_waitcnt vmcnt(18)
    s_barrier
    s_add_u32 m0, s34, 24576
    s_lshl_b32 s32, s98, 18
    buffer_load_dwordx4 v176, s[52:55], s32 offen offset:0 sc1 lds
    buffer_load_dwordx4 v177, s[52:55], s32 offen offset:1024 sc1 lds
    buffer_load_dwordx4 v178, s[52:55], s32 offen offset:2048 sc1 lds
    buffer_load_dwordx4 v179, s[52:55], s32 offen offset:3072 sc1 lds
    s_add_u32 m0, s35, 40960
    s_lshl_b32 s33, s98, 7
    buffer_load_dwordx4 v180, s[16:19], s33 offen offset:0 sc1 lds
    buffer_load_dwordx4 v181, s[16:19], s33 offen offset:1024 sc1 lds
    s_add_u32 s98, s98, 1
    s_cmp_eq_u32 s98, 20
    s_cselect_b32 s98, 0, s98
    s_waitcnt vmcnt(18)
    s_barrier
    s_add_u32 m0, s34, 49152
    s_lshl_b32 s32, s98, 18
    buffer_load_dwordx4 v176, s[52:55], s32 offen offset:0 sc1 lds
    buffer_load_dwordx4 v177, s[52:55], s32 offen offset:1024 sc1 lds
    buffer_load_dwordx4 v178, s[52:55], s32 offen offset:2048 sc1 lds
    buffer_load_dwordx4 v179, s[52:55], s32 offen offset:3072 sc1 lds
    s_add_u32 m0, s35, 65536
    s_lshl_b32 s33, s98, 7
    buffer_load_dwordx4 v180, s[16:19], s33 offen offset:0 sc1 lds
    buffer_load_dwordx4 v181, s[16:19], s33 offen offset:1024 sc1 lds
    s_add_u32 s98, s98, 1
    s_cmp_eq_u32 s98, 20
    s_cselect_b32 s98, 0, s98
    s_waitcnt vmcnt(18)
    s_barrier
    s_waitcnt vmcnt(12)
    s_barrier
    s_waitcnt vmcnt(6)
    s_barrier
    s_waitcnt vmcnt(0)
    s_barrier
    s_endpgm
L_D_comp:
    s_barrier
    s_load_dwordx2 s[6:7], s[0:1], 96
    s_waitcnt vmcnt(0)
    s_barrier
    s_cmp_lg_u32 s29, 0
    s_cbranch_scc1 L_w4_37
    s_lshl_b32 s30, s42, 1
    s_bfe_u32 s31, s39, 0x10001
    s_add_u32 s30, s30, s31
    s_mul_i32 s30, s30, 4352
    s_add_u32 s30, s30, 217600
    v_mov_b32 v20, 1
    s_mov_b64 exec, 1
    buffer_atomic_add v20, off, s[44:47], s30 sc1
    s_mov_b64 exec, -1
L_w4_37:
    v_and_b32 v3, 31, v2
    s_lshr_b32 s32, s29, 1
    s_lshl_b32 s30, s32, 6
    v_add_u32 v11, s30, v3
    v_lshrrev_b32 v9, 5, v2
    v_bfe_u32 v8, v11, 1, 3
    v_xor_b32 v8, v8, v9
    v_xor_b32 v10, 0, v8
    v_lshlrev_b32 v10, 4, v10
    v_lshl_add_u32 v92, v11, 7, v10
    v_xor_b32 v10, 2, v8
    v_lshlrev_b32 v10, 4, v10
    v_lshl_add_u32 v93, v11, 7, v10
    v_xor_b32 v10, 4, v8
    v_lshlrev_b32 v10, 4, v10
    v_lshl_add_u32 v94, v11, 7, v10
    v_xor_b32 v10, 6, v8
    v_lshlrev_b32 v10, 4, v10
    v_lshl_add_u32 v95, v11, 7, v10
    s_and_b32 s30, s29, 1
    s_lshl_b32 s30, s30, 5
    v_add_u32 v11, s30, v3
    v_bfe_u32 v8, v11, 1, 3
    v_xor_b32 v8, v8, v9
    v_xor_b32 v10, 0, v8
    v_lshlrev_b32 v10, 4, v10
    v_lshl_add_u32 v74, v11, 7, v10
    v_add_u32 v74, 16384, v74
    v_xor_b32 v10, 2, v8
    v_lshlrev_b32 v10, 4, v10
    v_lshl_add_u32 v75, v11, 7, v10
    v_add_u32 v75, 16384, v75
    v_xor_b32 v10, 4, v8
    v_lshlrev_b32 v10, 4, v10
    v_lshl_add_u32 v76, v11, 7, v10
    v_add_u32 v76, 16384, v76
    v_xor_b32 v10, 6, v8
    v_lshlrev_b32 v10, 4, v10
    v_lshl_add_u32 v77, v11, 7, v10
    v_add_u32 v77, 16384, v77
    v_bfe_u32 v3, v2, 4, 1
    v_lshlrev_b32 v3, 1, v3
    v_bfe_u32 v8, v2, 1, 1
    v_add_u32 v3, v3, v8
    v_lshlrev_b32 v8, 1, v9
    v_xor_b32 v8, v8, v3
    v_lshlrev_b32 v8, 6, v8
    v_lshl_add_u32 v8, v3, 10, v8
    v_bfe_u32 v3, v2, 2, 2
    v_lshl_add_u32 v8, v3, 4, v8
    v_and_b32 v3, 1, v2
    v_lshl_add_u32 v8, v3, 3, v8
    s_lshl_b32 s30, s32, 13
    v_add_u32 v72, s30, v8
    v_xor_b32 v73, 64, v72
    v_add_u32 v78, 49152, v72
    v_add_u32 v79, 49152, v73
    v_add_u32 v80, 49152, v74
    v_add_u32 v81, 49152, v75
    v_add_u32 v82, 49152, v76
    v_add_u32 v83, 49152, v77
    v_add_u32 v84, 98304, v72
    v_add_u32 v85, 98304, v73
    v_add_u32 v86, 98304, v74
    v_add_u32 v87, 98304, v75
    v_add_u32 v88, 98304, v76
    v_add_u32 v89, 98304, v77
    s_lshl_b32 s35, s27, 6
    s_lshr_b32 s30, s29, 1
    s_lshl_b32 s30, s30, 6
    s_lshl_b32 s31, s26, 7
    s_add_u32 s30, s30, s31
    v_lshrrev_b32 v9, 5, v2
    v_lshl_add_u32 v10, v9, 2, s30
    v_mul_u32_u24 v10, 5120, v10
    s_and_b32 s31, s29, 1
    s_mul_i32 s31, s31, 32
    s_add_u32 s31, s31, s35
    v_and_b32 v3, 31, v2
    v_add_u32 v11, s31, v3
    v_lshl_add_u32 v16, v11, 2, v10
    s_waitcnt lgkmcnt(0)
    s_mov_b32 s20, s6
    s_and_b32 s21, s7, 0xffff
    s_mov_b32 s22, 10485760
    s_mov_b32 s23, 0x00020000
    s_barrier
    ds_read_b128 v[40:43], v92
    ds_read_b128 v[48:51], v74 offset:0
    ds_read_b128 v[44:47], v92 offset:4096
    s_waitcnt lgkmcnt(1)
    v_mfma_f32_32x32x16_bf16 v[128:143], v[40:43], v[48:51], 0
    ds_read_b128 v[52:55], v93
    ds_read_b128 v[60:63], v75 offset:0
    ds_read_b128 v[56:59], v93 offset:4096
    s_waitcnt lgkmcnt(3)
    v_mfma_f32_32x32x16_bf16 v[144:159], v[44:47], v[48:51], 0
    s_waitcnt lgkmcnt(1)
    v_mfma_f32_32x32x16_bf16 v[128:143], v[52:55], v[60:63], v[128:143]
    ds_read_b128 v[40:43], v94
    ds_read_b128 v[48:51], v76 offset:0
    ds_read_b128 v[44:47], v94 offset:4096
    s_waitcnt lgkmcnt(3)
    v_mfma_f32_32x32x16_bf16 v[144:159], v[56:59], v[60:63], v[144:159]
    s_waitcnt lgkmcnt(1)
    v_mfma_f32_32x32x16_bf16 v[128:143], v[40:43], v[48:51], v[128:143]
    ds_read_b128 v[52:55], v95
    ds_read_b128 v[60:63], v77 offset:0
    ds_read_b128 v[56:59], v95 offset:4096
    s_waitcnt lgkmcnt(3)
    v_mfma_f32_32x32x16_bf16 v[144:159], v[44:47], v[48:51], v[144:159]
    s_barrier
    s_waitcnt lgkmcnt(1)
    v_mfma_f32_32x32x16_bf16 v[128:143], v[52:55], v[60:63], v[128:143]
    ds_read_b64_tr_b16 v[40:41], v72 offset:24576
    ds_read_b64_tr_b16 v[42:43], v73 offset:24576
    ds_read_b128 v[48:51], v74 offset:24576
    s_waitcnt lgkmcnt(3)
    v_mfma_f32_32x32x16_bf16 v[144:159], v[56:59], v[60:63], v[144:159]
    ds_read_b64_tr_b16 v[44:45], v72 offset:28672
    ds_read_b64_tr_b16 v[46:47], v73 offset:28672
    s_waitcnt lgkmcnt(2)
    v_mfma_f32_32x32x16_bf16 v[128:143], v[40:43], v[48:51], v[128:143]
    ds_read_b64_tr_b16 v[52:53], v72 offset:24832
    ds_read_b64_tr_b16 v[54:55], v73 offset:24832
    ds_read_b128 v[60:63], v75 offset:24576
    s_waitcnt lgkmcnt(3)
    v_mfma_f32_32x32x16_bf16 v[144:159], v[44:47], v[48:51], v[144:159]
    ds_read_b64_tr_b16 v[56:57], v72 offset:28928
    ds_read_b64_tr_b16 v[58:59], v73 offset:28928
    s_waitcnt lgkmcnt(2)
    v_mfma_f32_32x32x16_bf16 v[128:143], v[52:55], v[60:63], v[128:143]
    ds_read_b64_tr_b16 v[40:41], v72 offset:25088
    ds_read_b64_tr_b16 v[42:43], v73 offset:25088
    ds_read_b128 v[48:51], v76 offset:24576
    s_waitcnt lgkmcnt(3)
    v_mfma_f32_32x32x16_bf16 v[144:159], v[56:59], v[60:63], v[144:159]
    ds_read_b64_tr_b16 v[44:45], v72 offset:29184
    ds_read_b64_tr_b16 v[46:47], v73 offset:29184
    s_waitcnt lgkmcnt(2)
    v_mfma_f32_32x32x16_bf16 v[128:143], v[40:43], v[48:51], v[128:143]
    ds_read_b64_tr_b16 v[52:53], v72 offset:25344
    ds_read_b64_tr_b16 v[54:55], v73 offset:25344
    ds_read_b128 v[60:63], v77 offset:24576
    s_waitcnt lgkmcnt(3)
    v_mfma_f32_32x32x16_bf16 v[144:159], v[44:47], v[48:51], v[144:159]
    ds_read_b64_tr_b16 v[56:57], v72 offset:29440
    ds_read_b64_tr_b16 v[58:59], v73 offset:29440
    s_barrier
    s_waitcnt lgkmcnt(2)
    v_mfma_f32_32x32x16_bf16 v[128:143], v[52:55], v[60:63], v[128:143]
    ds_read_b64_tr_b16 v[40:41], v78 offset:0
    ds_read_b64_tr_b16 v[42:43], v79 offset:0
    ds_read_b128 v[48:51], v80 offset:0
    s_waitcnt lgkmcnt(3)
    v_mfma_f32_32x32x16_bf16 v[144:159], v[56:59], v[60:63], v[144:159]
    ds_read_b64_tr_b16 v[44:45], v78 offset:4096
    ds_read_b64_tr_b16 v[46:47], v79 offset:4096
    s_waitcnt lgkmcnt(2)
    v_mfma_f32_32x32x16_bf16 v[128:143], v[40:43], v[48:51], v[128:143]
    ds_read_b64_tr_b16 v[52:53], v78 offset:256
    ds_read_b64_tr_b16 v[54:55], v79 offset:256
    ds_read_b128 v[60:63], v81 offset:0
    s_waitcnt lgkmcnt(3)
    v_mfma_f32_32x32x16_bf16 v[144:159], v[44:47], v[48:51], v[144:159]
    ds_read_b64_tr_b16 v[56:57], v78 offset:4352
    ds_read_b64_tr_b16 v[58:59], v79 offset:4352
    s_waitcnt lgkmcnt(2)
    v_mfma_f32_32x32x16_bf16 v[128:143], v[52:55], v[60:63], v[128:143]
    ds_read_b64_tr_b16 v[40:41], v78 offset:512
    ds_read_b64_tr_b16 v[42:43], v79 offset:512
    ds_read_b128 v[48:51], v82 offset:0
    s_waitcnt lgkmcnt(3)
    v_mfma_f32_32x32x16_bf16 v[144:159], v[56:59], v[60:63], v[144:159]
    ds_read_b64_tr_b16 v[44:45], v78 offset:4608
    ds_read_b64_tr_b16 v[46:47], v79 offset:4608
    s_waitcnt lgkmcnt(2)
    v_mfma_f32_32x32x16_bf16 v[128:143], v[40:43], v[48:51], v[128:143]
    ds_read_b64_tr_b16 v[52:53], v78 offset:768
    ds_read_b64_tr_b16 v[54:55], v79 offset:768
    ds_read_b128 v[60:63], v83 offset:0
    s_waitcnt lgkmcnt(3)
    v_mfma_f32_32x32x16_bf16 v[144:159], v[44:47], v[48:51], v[144:159]
    ds_read_b64_tr_b16 v[56:57], v78 offset:4864
    ds_read_b64_tr_b16 v[58:59], v79 offset:4864
    s_barrier
    s_waitcnt lgkmcnt(2)
    v_mfma_f32_32x32x16_bf16 v[128:143], v[52:55], v[60:63], v[128:143]
    ds_read_b64_tr_b16 v[40:41], v78 offset:24576
    ds_read_b64_tr_b16 v[42:43], v79 offset:24576
    ds_read_b128 v[48:51], v80 offset:24576
    s_waitcnt lgkmcnt(3)
    v_mfma_f32_32x32x16_bf16 v[144:159], v[56:59], v[60:63], v[144:159]
    ds_read_b64_tr_b16 v[44:45], v78 offset:28672
    ds_read_b64_tr_b16 v[46:47], v79 offset:28672
    s_waitcnt lgkmcnt(2)
    v_mfma_f32_32x32x16_bf16 v[128:143], v[40:43], v[48:51], v[128:143]
    ds_read_b64_tr_b16 v[52:53], v78 offset:24832
    ds_read_b64_tr_b16 v[54:55], v79 offset:24832
    ds_read_b128 v[60:63], v81 offset:24576
    s_waitcnt lgkmcnt(3)
    v_mfma_f32_32x32x16_bf16 v[144:159], v[44:47], v[48:51], v[144:159]
    ds_read_b64_tr_b16 v[56:57], v78 offset:28928
    ds_read_b64_tr_b16 v[58:59], v79 offset:28928
    s_waitcnt lgkmcnt(2)
    v_mfma_f32_32x32x16_bf16 v[128:143], v[52:55], v[60:63], v[128:143]
    ds_read_b64_tr_b16 v[40:41], v78 offset:25088
    ds_read_b64_tr_b16 v[42:43], v79 offset:25088
    ds_read_b128 v[48:51], v82 offset:24576
    s_waitcnt lgkmcnt(3)
    v_mfma_f32_32x32x16_bf16 v[144:159], v[56:59], v[60:63], v[144:159]
    ds_read_b64_tr_b16 v[44:45], v78 offset:29184
    ds_read_b64_tr_b16 v[46:47], v79 offset:29184
    s_waitcnt lgkmcnt(2)
    v_mfma_f32_32x32x16_bf16 v[128:143], v[40:43], v[48:51], v[128:143]
    ds_read_b64_tr_b16 v[52:53], v78 offset:25344
    ds_read_b64_tr_b16 v[54:55], v79 offset:25344
    ds_read_b128 v[60:63], v83 offset:24576
    s_waitcnt lgkmcnt(3)
    v_mfma_f32_32x32x16_bf16 v[144:159], v[44:47], v[48:51], v[144:159]
    ds_read_b64_tr_b16 v[56:57], v78 offset:29440
    ds_read_b64_tr_b16 v[58:59], v79 offset:29440
    s_barrier
    s_waitcnt lgkmcnt(2)
    v_mfma_f32_32x32x16_bf16 v[128:143], v[52:55], v[60:63], v[128:143]
    ds_read_b64_tr_b16 v[40:41], v84 offset:0
    ds_read_b64_tr_b16 v[42:43], v85 offset:0
    ds_read_b128 v[48:51], v86 offset:0
    s_waitcnt lgkmcnt(3)
    v_mfma_f32_32x32x16_bf16 v[144:159], v[56:59], v[60:63], v[144:159]
    ds_read_b64_tr_b16 v[44:45], v84 offset:4096
    ds_read_b64_tr_b16 v[46:47], v85 offset:4096
    s_waitcnt lgkmcnt(2)
    v_mfma_f32_32x32x16_bf16 v[128:143], v[40:43], v[48:51], v[128:143]
    ds_read_b64_tr_b16 v[52:53], v84 offset:256
    ds_read_b64_tr_b16 v[54:55], v85 offset:256
    ds_read_b128 v[60:63], v87 offset:0
    s_waitcnt lgkmcnt(3)
    v_mfma_f32_32x32x16_bf16 v[144:159], v[44:47], v[48:51], v[144:159]
    ds_read_b64_tr_b16 v[56:57], v84 offset:4352
    ds_read_b64_tr_b16 v[58:59], v85 offset:4352
    s_waitcnt lgkmcnt(2)
    v_mfma_f32_32x32x16_bf16 v[128:143], v[52:55], v[60:63], v[128:143]
    ds_read_b64_tr_b16 v[40:41], v84 offset:512
    ds_read_b64_tr_b16 v[42:43], v85 offset:512
    ds_read_b128 v[48:51], v88 offset:0
    s_waitcnt lgkmcnt(3)
    v_mfma_f32_32x32x16_bf16 v[144:159], v[56:59], v[60:63], v[144:159]
    ds_read_b64_tr_b16 v[44:45], v84 offset:4608
    ds_read_b64_tr_b16 v[46:47], v85 offset:4608
    s_waitcnt lgkmcnt(2)
    v_mfma_f32_32x32x16_bf16 v[128:143], v[40:43], v[48:51], v[128:143]
    ds_read_b64_tr_b16 v[52:53], v84 offset:768
    ds_read_b64_tr_b16 v[54:55], v85 offset:768
    ds_read_b128 v[60:63], v89 offset:0
    s_waitcnt lgkmcnt(3)
    v_mfma_f32_32x32x16_bf16 v[144:159], v[44:47], v[48:51], v[144:159]
    ds_read_b64_tr_b16 v[56:57], v84 offset:4864
    ds_read_b64_tr_b16 v[58:59], v85 offset:4864
    s_barrier
    s_waitcnt lgkmcnt(2)
    v_mfma_f32_32x32x16_bf16 v[128:143], v[52:55], v[60:63], v[128:143]
    ds_read_b64_tr_b16 v[40:41], v84 offset:24576
    ds_read_b64_tr_b16 v[42:43], v85 offset:24576
    ds_read_b128 v[48:51], v86 offset:24576
    s_waitcnt lgkmcnt(3)
    v_mfma_f32_32x32x16_bf16 v[144:159], v[56:59], v[60:63], v[144:159]
    ds_read_b64_tr_b16 v[44:45], v84 offset:28672
    ds_read_b64_tr_b16 v[46:47], v85 offset:28672
    s_waitcnt lgkmcnt(2)
    v_mfma_f32_32x32x16_bf16 v[128:143], v[40:43], v[48:51], v[128:143]
    ds_read_b64_tr_b16 v[52:53], v84 offset:24832
    ds_read_b64_tr_b16 v[54:55], v85 offset:24832
    ds_read_b128 v[60:63], v87 offset:24576
    s_waitcnt lgkmcnt(3)
    v_mfma_f32_32x32x16_bf16 v[144:159], v[44:47], v[48:51], v[144:159]
    ds_read_b64_tr_b16 v[56:57], v84 offset:28928
    ds_read_b64_tr_b16 v[58:59], v85 offset:28928
    s_waitcnt lgkmcnt(2)
    v_mfma_f32_32x32x16_bf16 v[128:143], v[52:55], v[60:63], v[128:143]
    ds_read_b64_tr_b16 v[40:41], v84 offset:25088
    ds_read_b64_tr_b16 v[42:43], v85 offset:25088
    ds_read_b128 v[48:51], v88 offset:24576
    s_waitcnt lgkmcnt(3)
    v_mfma_f32_32x32x16_bf16 v[144:159], v[56:59], v[60:63], v[144:159]
    ds_read_b64_tr_b16 v[44:45], v84 offset:29184
    ds_read_b64_tr_b16 v[46:47], v85 offset:29184
    s_waitcnt lgkmcnt(2)
    v_mfma_f32_32x32x16_bf16 v[128:143], v[40:43], v[48:51], v[128:143]
    ds_read_b64_tr_b16 v[52:53], v84 offset:25344
    ds_read_b64_tr_b16 v[54:55], v85 offset:25344
    ds_read_b128 v[60:63], v89 offset:24576
    s_waitcnt lgkmcnt(3)
    v_mfma_f32_32x32x16_bf16 v[144:159], v[44:47], v[48:51], v[144:159]
    ds_read_b64_tr_b16 v[56:57], v84 offset:29440
    ds_read_b64_tr_b16 v[58:59], v85 offset:29440
    s_barrier
    s_waitcnt lgkmcnt(2)
    v_mfma_f32_32x32x16_bf16 v[128:143], v[52:55], v[60:63], v[128:143]
    ds_read_b64_tr_b16 v[40:41], v72 offset:0
    ds_read_b64_tr_b16 v[42:43], v73 offset:0
    ds_read_b128 v[48:51], v74 offset:0
    s_waitcnt lgkmcnt(3)
    v_mfma_f32_32x32x16_bf16 v[144:159], v[56:59], v[60:63], v[144:159]
    ds_read_b64_tr_b16 v[44:45], v72 offset:4096
    ds_read_b64_tr_b16 v[46:47], v73 offset:4096
    s_waitcnt lgkmcnt(2)
    v_mfma_f32_32x32x16_bf16 v[128:143], v[40:43], v[48:51], v[128:143]
    ds_read_b64_tr_b16 v[52:53], v72 offset:256
    ds_read_b64_tr_b16 v[54:55], v73 offset:256
    ds_read_b128 v[60:63], v75 offset:0
    s_waitcnt lgkmcnt(3)
    v_mfma_f32_32x32x16_bf16 v[144:159], v[44:47], v[48:51], v[144:159]
    ds_read_b64_tr_b16 v[56:57], v72 offset:4352
    ds_read_b64_tr_b16 v[58:59], v73 offset:4352
    s_waitcnt lgkmcnt(2)
    v_mfma_f32_32x32x16_bf16 v[128:143], v[52:55], v[60:63], v[128:143]
    ds_read_b64_tr_b16 v[40:41], v72 offset:512
    ds_read_b64_tr_b16 v[42:43], v73 offset:512
    ds_read_b128 v[48:51], v76 offset:0
    s_waitcnt lgkmcnt(3)
    v_mfma_f32_32x32x16_bf16 v[144:159], v[56:59], v[60:63], v[144:159]
    ds_read_b64_tr_b16 v[44:45], v72 offset:4608
    ds_read_b64_tr_b16 v[46:47], v73 offset:4608
    s_waitcnt lgkmcnt(2)
    v_mfma_f32_32x32x16_bf16 v[128:143], v[40:43], v[48:51], v[128:143]
    ds_read_b64_tr_b16 v[52:53], v72 offset:768
    ds_read_b64_tr_b16 v[54:55], v73 offset:768
    ds_read_b128 v[60:63], v77 offset:0
    s_waitcnt lgkmcnt(3)
    v_mfma_f32_32x32x16_bf16 v[144:159], v[44:47], v[48:51], v[144:159]
    ds_read_b64_tr_b16 v[56:57], v72 offset:4864
    ds_read_b64_tr_b16 v[58:59], v73 offset:4864
    s_barrier
    s_waitcnt lgkmcnt(2)
    v_mfma_f32_32x32x16_bf16 v[128:143], v[52:55], v[60:63], v[128:143]
    ds_read_b64_tr_b16 v[40:41], v72 offset:24576
    ds_read_b64_tr_b16 v[42:43], v73 offset:24576
    ds_read_b128 v[48:51], v74 offset:24576
    s_waitcnt lgkmcnt(3)
    v_mfma_f32_32x32x16_bf16 v[144:159], v[56:59], v[60:63], v[144:159]
    ds_read_b64_tr_b16 v[44:45], v72 offset:28672
    ds_read_b64_tr_b16 v[46:47], v73 offset:28672
    s_waitcnt lgkmcnt(2)
    v_mfma_f32_32x32x16_bf16 v[128:143], v[40:43], v[48:51], v[128:143]
    ds_read_b64_tr_b16 v[52:53], v72 offset:24832
    ds_read_b64_tr_b16 v[54:55], v73 offset:24832
    ds_read_b128 v[60:63], v75 offset:24576
    s_waitcnt lgkmcnt(3)
    v_mfma_f32_32x32x16_bf16 v[144:159], v[44:47], v[48:51], v[144:159]
    ds_read_b64_tr_b16 v[56:57], v72 offset:28928
    ds_read_b64_tr_b16 v[58:59], v73 offset:28928
    s_waitcnt lgkmcnt(2)
    v_mfma_f32_32x32x16_bf16 v[128:143], v[52:55], v[60:63], v[128:143]
    ds_read_b64_tr_b16 v[40:41], v72 offset:25088
    ds_read_b64_tr_b16 v[42:43], v73 offset:25088
    ds_read_b128 v[48:51], v76 offset:24576
    s_waitcnt lgkmcnt(3)
    v_mfma_f32_32x32x16_bf16 v[144:159], v[56:59], v[60:63], v[144:159]
    ds_read_b64_tr_b16 v[44:45], v72 offset:29184
    ds_read_b64_tr_b16 v[46:47], v73 offset:29184
    s_waitcnt lgkmcnt(2)
    v_mfma_f32_32x32x16_bf16 v[128:143], v[40:43], v[48:51], v[128:143]
    ds_read_b64_tr_b16 v[52:53], v72 offset:25344
    ds_read_b64_tr_b16 v[54:55], v73 offset:25344
    ds_read_b128 v[60:63], v77 offset:24576
    s_waitcnt lgkmcnt(3)
    v_mfma_f32_32x32x16_bf16 v[144:159], v[44:47], v[48:51], v[144:159]
    ds_read_b64_tr_b16 v[56:57], v72 offset:29440
    ds_read_b64_tr_b16 v[58:59], v73 offset:29440
    s_barrier
    s_waitcnt lgkmcnt(2)
    v_mfma_f32_32x32x16_bf16 v[128:143], v[52:55], v[60:63], v[128:143]
    ds_read_b64_tr_b16 v[40:41], v78 offset:0
    ds_read_b64_tr_b16 v[42:43], v79 offset:0
    ds_read_b128 v[48:51], v80 offset:0
    s_waitcnt lgkmcnt(3)
    v_mfma_f32_32x32x16_bf16 v[144:159], v[56:59], v[60:63], v[144:159]
    ds_read_b64_tr_b16 v[44:45], v78 offset:4096
    ds_read_b64_tr_b16 v[46:47], v79 offset:4096
    s_waitcnt lgkmcnt(2)
    v_mfma_f32_32x32x16_bf16 v[128:143], v[40:43], v[48:51], v[128:143]
    ds_read_b64_tr_b16 v[52:53], v78 offset:256
    ds_read_b64_tr_b16 v[54:55], v79 offset:256
    ds_read_b128 v[60:63], v81 offset:0
    s_waitcnt lgkmcnt(3)
    v_mfma_f32_32x32x16_bf16 v[144:159], v[44:47], v[48:51], v[144:159]
    ds_read_b64_tr_b16 v[56:57], v78 offset:4352
    ds_read_b64_tr_b16 v[58:59], v79 offset:4352
    s_waitcnt lgkmcnt(2)
    v_mfma_f32_32x32x16_bf16 v[128:143], v[52:55], v[60:63], v[128:143]
    ds_read_b64_tr_b16 v[40:41], v78 offset:512
    ds_read_b64_tr_b16 v[42:43], v79 offset:512
    ds_read_b128 v[48:51], v82 offset:0
    s_waitcnt lgkmcnt(3)
    v_mfma_f32_32x32x16_bf16 v[144:159], v[56:59], v[60:63], v[144:159]
    ds_read_b64_tr_b16 v[44:45], v78 offset:4608
    ds_read_b64_tr_b16 v[46:47], v79 offset:4608
    s_waitcnt lgkmcnt(2)
    v_mfma_f32_32x32x16_bf16 v[128:143], v[40:43], v[48:51], v[128:143]
    ds_read_b64_tr_b16 v[52:53], v78 offset:768
    ds_read_b64_tr_b16 v[54:55], v79 offset:768
    ds_read_b128 v[60:63], v83 offset:0
    s_waitcnt lgkmcnt(3)
    v_mfma_f32_32x32x16_bf16 v[144:159], v[44:47], v[48:51], v[144:159]
    ds_read_b64_tr_b16 v[56:57], v78 offset:4864
    ds_read_b64_tr_b16 v[58:59], v79 offset:4864
    s_barrier
    s_waitcnt lgkmcnt(2)
    v_mfma_f32_32x32x16_bf16 v[128:143], v[52:55], v[60:63], v[128:143]
    ds_read_b64_tr_b16 v[40:41], v78 offset:24576
    ds_read_b64_tr_b16 v[42:43], v79 offset:24576
    ds_read_b128 v[48:51], v80 offset:24576
    s_waitcnt lgkmcnt(3)
    v_mfma_f32_32x32x16_bf16 v[144:159], v[56:59], v[60:63], v[144:159]
    ds_read_b64_tr_b16 v[44:45], v78 offset:28672
    ds_read_b64_tr_b16 v[46:47], v79 offset:28672
    s_waitcnt lgkmcnt(2)
    v_mfma_f32_32x32x16_bf16 v[128:143], v[40:43], v[48:51], v[128:143]
    ds_read_b64_tr_b16 v[52:53], v78 offset:24832
    ds_read_b64_tr_b16 v[54:55], v79 offset:24832
    ds_read_b128 v[60:63], v81 offset:24576
    s_waitcnt lgkmcnt(3)
    v_mfma_f32_32x32x16_bf16 v[144:159], v[44:47], v[48:51], v[144:159]
    ds_read_b64_tr_b16 v[56:57], v78 offset:28928
    ds_read_b64_tr_b16 v[58:59], v79 offset:28928
    s_waitcnt lgkmcnt(2)
    v_mfma_f32_32x32x16_bf16 v[128:143], v[52:55], v[60:63], v[128:143]
    ds_read_b64_tr_b16 v[40:41], v78 offset:25088
    ds_read_b64_tr_b16 v[42:43], v79 offset:25088
    ds_read_b128 v[48:51], v82 offset:24576
    s_waitcnt lgkmcnt(3)
    v_mfma_f32_32x32x16_bf16 v[144:159], v[56:59], v[60:63], v[144:159]
    ds_read_b64_tr_b16 v[44:45], v78 offset:29184
    ds_read_b64_tr_b16 v[46:47], v79 offset:29184
    s_waitcnt lgkmcnt(2)
    v_mfma_f32_32x32x16_bf16 v[128:143], v[40:43], v[48:51], v[128:143]
    ds_read_b64_tr_b16 v[52:53], v78 offset:25344
    ds_read_b64_tr_b16 v[54:55], v79 offset:25344
    ds_read_b128 v[60:63], v83 offset:24576
    s_waitcnt lgkmcnt(3)
    v_mfma_f32_32x32x16_bf16 v[144:159], v[44:47], v[48:51], v[144:159]
    ds_read_b64_tr_b16 v[56:57], v78 offset:29440
    ds_read_b64_tr_b16 v[58:59], v79 offset:29440
    s_barrier
    s_waitcnt lgkmcnt(2)
    v_mfma_f32_32x32x16_bf16 v[128:143], v[52:55], v[60:63], v[128:143]
    ds_read_b64_tr_b16 v[40:41], v84 offset:0
    ds_read_b64_tr_b16 v[42:43], v85 offset:0
    ds_read_b128 v[48:51], v86 offset:0
    s_waitcnt lgkmcnt(3)
    v_mfma_f32_32x32x16_bf16 v[144:159], v[56:59], v[60:63], v[144:159]
    ds_read_b64_tr_b16 v[44:45], v84 offset:4096
    ds_read_b64_tr_b16 v[46:47], v85 offset:4096
    s_waitcnt lgkmcnt(2)
    v_mfma_f32_32x32x16_bf16 v[128:143], v[40:43], v[48:51], v[128:143]
    ds_read_b64_tr_b16 v[52:53], v84 offset:256
    ds_read_b64_tr_b16 v[54:55], v85 offset:256
    ds_read_b128 v[60:63], v87 offset:0
    s_waitcnt lgkmcnt(3)
    v_mfma_f32_32x32x16_bf16 v[144:159], v[44:47], v[48:51], v[144:159]
    ds_read_b64_tr_b16 v[56:57], v84 offset:4352
    ds_read_b64_tr_b16 v[58:59], v85 offset:4352
    s_waitcnt lgkmcnt(2)
    v_mfma_f32_32x32x16_bf16 v[128:143], v[52:55], v[60:63], v[128:143]
    ds_read_b64_tr_b16 v[40:41], v84 offset:512
    ds_read_b64_tr_b16 v[42:43], v85 offset:512
    ds_read_b128 v[48:51], v88 offset:0
    s_waitcnt lgkmcnt(3)
    v_mfma_f32_32x32x16_bf16 v[144:159], v[56:59], v[60:63], v[144:159]
    ds_read_b64_tr_b16 v[44:45], v84 offset:4608
    ds_read_b64_tr_b16 v[46:47], v85 offset:4608
    s_waitcnt lgkmcnt(2)
    v_mfma_f32_32x32x16_bf16 v[128:143], v[40:43], v[48:51], v[128:143]
    ds_read_b64_tr_b16 v[52:53], v84 offset:768
    ds_read_b64_tr_b16 v[54:55], v85 offset:768
    ds_read_b128 v[60:63], v89 offset:0
    s_waitcnt lgkmcnt(3)
    v_mfma_f32_32x32x16_bf16 v[144:159], v[44:47], v[48:51], v[144:159]
    ds_read_b64_tr_b16 v[56:57], v84 offset:4864
    ds_read_b64_tr_b16 v[58:59], v85 offset:4864
    s_barrier
    s_waitcnt lgkmcnt(2)
    v_mfma_f32_32x32x16_bf16 v[128:143], v[52:55], v[60:63], v[128:143]
    ds_read_b64_tr_b16 v[40:41], v84 offset:24576
    ds_read_b64_tr_b16 v[42:43], v85 offset:24576
    ds_read_b128 v[48:51], v86 offset:24576
    s_waitcnt lgkmcnt(3)
    v_mfma_f32_32x32x16_bf16 v[144:159], v[56:59], v[60:63], v[144:159]
    ds_read_b64_tr_b16 v[44:45], v84 offset:28672
    ds_read_b64_tr_b16 v[46:47], v85 offset:28672
    s_waitcnt lgkmcnt(2)
    v_mfma_f32_32x32x16_bf16 v[128:143], v[40:43], v[48:51], v[128:143]
    ds_read_b64_tr_b16 v[52:53], v84 offset:24832
    ds_read_b64_tr_b16 v[54:55], v85 offset:24832
    ds_read_b128 v[60:63], v87 offset:24576
    s_waitcnt lgkmcnt(3)
    v_mfma_f32_32x32x16_bf16 v[144:159], v[44:47], v[48:51], v[144:159]
    ds_read_b64_tr_b16 v[56:57], v84 offset:28928
    ds_read_b64_tr_b16 v[58:59], v85 offset:28928
    s_waitcnt lgkmcnt(2)
    v_mfma_f32_32x32x16_bf16 v[128:143], v[52:55], v[60:63], v[128:143]
    ds_read_b64_tr_b16 v[40:41], v84 offset:25088
    ds_read_b64_tr_b16 v[42:43], v85 offset:25088
    ds_read_b128 v[48:51], v88 offset:24576
    s_waitcnt lgkmcnt(3)
    v_mfma_f32_32x32x16_bf16 v[144:159], v[56:59], v[60:63], v[144:159]
    ds_read_b64_tr_b16 v[44:45], v84 offset:29184
    ds_read_b64_tr_b16 v[46:47], v85 offset:29184
    s_waitcnt lgkmcnt(2)
    v_mfma_f32_32x32x16_bf16 v[128:143], v[40:43], v[48:51], v[128:143]
    ds_read_b64_tr_b16 v[52:53], v84 offset:25344
    ds_read_b64_tr_b16 v[54:55], v85 offset:25344
    ds_read_b128 v[60:63], v89 offset:24576
    s_waitcnt lgkmcnt(3)
    v_mfma_f32_32x32x16_bf16 v[144:159], v[44:47], v[48:51], v[144:159]
    ds_read_b64_tr_b16 v[56:57], v84 offset:29440
    ds_read_b64_tr_b16 v[58:59], v85 offset:29440
    s_barrier
    s_waitcnt lgkmcnt(2)
    v_mfma_f32_32x32x16_bf16 v[128:143], v[52:55], v[60:63], v[128:143]
    ds_read_b64_tr_b16 v[40:41], v72 offset:0
    ds_read_b64_tr_b16 v[42:43], v73 offset:0
    ds_read_b128 v[48:51], v74 offset:0
    s_waitcnt lgkmcnt(3)
    v_mfma_f32_32x32x16_bf16 v[144:159], v[56:59], v[60:63], v[144:159]
    ds_read_b64_tr_b16 v[44:45], v72 offset:4096
    ds_read_b64_tr_b16 v[46:47], v73 offset:4096
    s_waitcnt lgkmcnt(2)
    v_mfma_f32_32x32x16_bf16 v[128:143], v[40:43], v[48:51], v[128:143]
    ds_read_b64_tr_b16 v[52:53], v72 offset:256
    ds_read_b64_tr_b16 v[54:55], v73 offset:256
    ds_read_b128 v[60:63], v75 offset:0
    s_waitcnt lgkmcnt(3)
    v_mfma_f32_32x32x16_bf16 v[144:159], v[44:47], v[48:51], v[144:159]
    ds_read_b64_tr_b16 v[56:57], v72 offset:4352
    ds_read_b64_tr_b16 v[58:59], v73 offset:4352
    s_waitcnt lgkmcnt(2)
    v_mfma_f32_32x32x16_bf16 v[128:143], v[52:55], v[60:63], v[128:143]
    ds_read_b64_tr_b16 v[40:41], v72 offset:512
    ds_read_b64_tr_b16 v[42:43], v73 offset:512
    ds_read_b128 v[48:51], v76 offset:0
    s_waitcnt lgkmcnt(3)
    v_mfma_f32_32x32x16_bf16 v[144:159], v[56:59], v[60:63], v[144:159]
    ds_read_b64_tr_b16 v[44:45], v72 offset:4608
    ds_read_b64_tr_b16 v[46:47], v73 offset:4608
    s_waitcnt lgkmcnt(2)
    v_mfma_f32_32x32x16_bf16 v[128:143], v[40:43], v[48:51], v[128:143]
    ds_read_b64_tr_b16 v[52:53], v72 offset:768
    ds_read_b64_tr_b16 v[54:55], v73 offset:768
    ds_read_b128 v[60:63], v77 offset:0
    s_waitcnt lgkmcnt(3)
    v_mfma_f32_32x32x16_bf16 v[144:159], v[44:47], v[48:51], v[144:159]
    ds_read_b64_tr_b16 v[56:57], v72 offset:4864
    ds_read_b64_tr_b16 v[58:59], v73 offset:4864
    s_barrier
    s_waitcnt lgkmcnt(2)
    v_mfma_f32_32x32x16_bf16 v[128:143], v[52:55], v[60:63], v[128:143]
    ds_read_b64_tr_b16 v[40:41], v72 offset:24576
    ds_read_b64_tr_b16 v[42:43], v73 offset:24576
    ds_read_b128 v[48:51], v74 offset:24576
    s_waitcnt lgkmcnt(3)
    v_mfma_f32_32x32x16_bf16 v[144:159], v[56:59], v[60:63], v[144:159]
    ds_read_b64_tr_b16 v[44:45], v72 offset:28672
    ds_read_b64_tr_b16 v[46:47], v73 offset:28672
    s_waitcnt lgkmcnt(2)
    v_mfma_f32_32x32x16_bf16 v[128:143], v[40:43], v[48:51], v[128:143]
    ds_read_b64_tr_b16 v[52:53], v72 offset:24832
    ds_read_b64_tr_b16 v[54:55], v73 offset:24832
    ds_read_b128 v[60:63], v75 offset:24576
    s_waitcnt lgkmcnt(3)
    v_mfma_f32_32x32x16_bf16 v[144:159], v[44:47], v[48:51], v[144:159]
    ds_read_b64_tr_b16 v[56:57], v72 offset:28928
    ds_read_b64_tr_b16 v[58:59], v73 offset:28928
    s_waitcnt lgkmcnt(2)
    v_mfma_f32_32x32x16_bf16 v[128:143], v[52:55], v[60:63], v[128:143]
    ds_read_b64_tr_b16 v[40:41], v72 offset:25088
    ds_read_b64_tr_b16 v[42:43], v73 offset:25088
    ds_read_b128 v[48:51], v76 offset:24576
    s_waitcnt lgkmcnt(3)
    v_mfma_f32_32x32x16_bf16 v[144:159], v[56:59], v[60:63], v[144:159]
    ds_read_b64_tr_b16 v[44:45], v72 offset:29184
    ds_read_b64_tr_b16 v[46:47], v73 offset:29184
    s_waitcnt lgkmcnt(2)
    v_mfma_f32_32x32x16_bf16 v[128:143], v[40:43], v[48:51], v[128:143]
    ds_read_b64_tr_b16 v[52:53], v72 offset:25344
    ds_read_b64_tr_b16 v[54:55], v73 offset:25344
    ds_read_b128 v[60:63], v77 offset:24576
    s_waitcnt lgkmcnt(3)
    v_mfma_f32_32x32x16_bf16 v[144:159], v[44:47], v[48:51], v[144:159]
    ds_read_b64_tr_b16 v[56:57], v72 offset:29440
    ds_read_b64_tr_b16 v[58:59], v73 offset:29440
    s_barrier
    s_waitcnt lgkmcnt(2)
    v_mfma_f32_32x32x16_bf16 v[128:143], v[52:55], v[60:63], v[128:143]
    ds_read_b64_tr_b16 v[40:41], v78 offset:0
    ds_read_b64_tr_b16 v[42:43], v79 offset:0
    ds_read_b128 v[48:51], v80 offset:0
    s_waitcnt lgkmcnt(3)
    v_mfma_f32_32x32x16_bf16 v[144:159], v[56:59], v[60:63], v[144:159]
    ds_read_b64_tr_b16 v[44:45], v78 offset:4096
    ds_read_b64_tr_b16 v[46:47], v79 offset:4096
    s_waitcnt lgkmcnt(2)
    v_mfma_f32_32x32x16_bf16 v[128:143], v[40:43], v[48:51], v[128:143]
    ds_read_b64_tr_b16 v[52:53], v78 offset:256
    ds_read_b64_tr_b16 v[54:55], v79 offset:256
    ds_read_b128 v[60:63], v81 offset:0
    s_waitcnt lgkmcnt(3)
    v_mfma_f32_32x32x16_bf16 v[144:159], v[44:47], v[48:51], v[144:159]
    ds_read_b64_tr_b16 v[56:57], v78 offset:4352
    ds_read_b64_tr_b16 v[58:59], v79 offset:4352
    s_waitcnt lgkmcnt(2)
    v_mfma_f32_32x32x16_bf16 v[128:143], v[52:55], v[60:63], v[128:143]
    ds_read_b64_tr_b16 v[40:41], v78 offset:512
    ds_read_b64_tr_b16 v[42:43], v79 offset:512
    ds_read_b128 v[48:51], v82 offset:0
    s_waitcnt lgkmcnt(3)
    v_mfma_f32_32x32x16_bf16 v[144:159], v[56:59], v[60:63], v[144:159]
    ds_read_b64_tr_b16 v[44:45], v78 offset:4608
    ds_read_b64_tr_b16 v[46:47], v79 offset:4608
    s_waitcnt lgkmcnt(2)
    v_mfma_f32_32x32x16_bf16 v[128:143], v[40:43], v[48:51], v[128:143]
    ds_read_b64_tr_b16 v[52:53], v78 offset:768
    ds_read_b64_tr_b16 v[54:55], v79 offset:768
    ds_read_b128 v[60:63], v83 offset:0
    s_waitcnt lgkmcnt(3)
    v_mfma_f32_32x32x16_bf16 v[144:159], v[44:47], v[48:51], v[144:159]
    ds_read_b64_tr_b16 v[56:57], v78 offset:4864
    ds_read_b64_tr_b16 v[58:59], v79 offset:4864
    s_barrier
    s_waitcnt lgkmcnt(2)
    v_mfma_f32_32x32x16_bf16 v[128:143], v[52:55], v[60:63], v[128:143]
    ds_read_b64_tr_b16 v[40:41], v78 offset:24576
    ds_read_b64_tr_b16 v[42:43], v79 offset:24576
    ds_read_b128 v[48:51], v80 offset:24576
    s_waitcnt lgkmcnt(3)
    v_mfma_f32_32x32x16_bf16 v[144:159], v[56:59], v[60:63], v[144:159]
    ds_read_b64_tr_b16 v[44:45], v78 offset:28672
    ds_read_b64_tr_b16 v[46:47], v79 offset:28672
    s_waitcnt lgkmcnt(2)
    v_mfma_f32_32x32x16_bf16 v[128:143], v[40:43], v[48:51], v[128:143]
    ds_read_b64_tr_b16 v[52:53], v78 offset:24832
    ds_read_b64_tr_b16 v[54:55], v79 offset:24832
    ds_read_b128 v[60:63], v81 offset:24576
    s_waitcnt lgkmcnt(3)
    v_mfma_f32_32x32x16_bf16 v[144:159], v[44:47], v[48:51], v[144:159]
    ds_read_b64_tr_b16 v[56:57], v78 offset:28928
    ds_read_b64_tr_b16 v[58:59], v79 offset:28928
    s_waitcnt lgkmcnt(2)
    v_mfma_f32_32x32x16_bf16 v[128:143], v[52:55], v[60:63], v[128:143]
    ds_read_b64_tr_b16 v[40:41], v78 offset:25088
    ds_read_b64_tr_b16 v[42:43], v79 offset:25088
    ds_read_b128 v[48:51], v82 offset:24576
    s_waitcnt lgkmcnt(3)
    v_mfma_f32_32x32x16_bf16 v[144:159], v[56:59], v[60:63], v[144:159]
    ds_read_b64_tr_b16 v[44:45], v78 offset:29184
    ds_read_b64_tr_b16 v[46:47], v79 offset:29184
    s_waitcnt lgkmcnt(2)
    v_mfma_f32_32x32x16_bf16 v[128:143], v[40:43], v[48:51], v[128:143]
    ds_read_b64_tr_b16 v[52:53], v78 offset:25344
    ds_read_b64_tr_b16 v[54:55], v79 offset:25344
    ds_read_b128 v[60:63], v83 offset:24576
    s_waitcnt lgkmcnt(3)
    v_mfma_f32_32x32x16_bf16 v[144:159], v[44:47], v[48:51], v[144:159]
    ds_read_b64_tr_b16 v[56:57], v78 offset:29440
    ds_read_b64_tr_b16 v[58:59], v79 offset:29440
    s_barrier
    s_waitcnt lgkmcnt(2)
    v_mfma_f32_32x32x16_bf16 v[128:143], v[52:55], v[60:63], v[128:143]
    ds_read_b64_tr_b16 v[40:41], v84 offset:0
    ds_read_b64_tr_b16 v[42:43], v85 offset:0
    ds_read_b128 v[48:51], v86 offset:0
    s_waitcnt lgkmcnt(3)
    v_mfma_f32_32x32x16_bf16 v[144:159], v[56:59], v[60:63], v[144:159]
    ds_read_b64_tr_b16 v[44:45], v84 offset:4096
    ds_read_b64_tr_b16 v[46:47], v85 offset:4096
    s_waitcnt lgkmcnt(2)
    v_mfma_f32_32x32x16_bf16 v[128:143], v[40:43], v[48:51], v[128:143]
    ds_read_b64_tr_b16 v[52:53], v84 offset:256
    ds_read_b64_tr_b16 v[54:55], v85 offset:256
    ds_read_b128 v[60:63], v87 offset:0
    s_waitcnt lgkmcnt(3)
    v_mfma_f32_32x32x16_bf16 v[144:159], v[44:47], v[48:51], v[144:159]
    ds_read_b64_tr_b16 v[56:57], v84 offset:4352
    ds_read_b64_tr_b16 v[58:59], v85 offset:4352
    s_waitcnt lgkmcnt(2)
    v_mfma_f32_32x32x16_bf16 v[128:143], v[52:55], v[60:63], v[128:143]
    ds_read_b64_tr_b16 v[40:41], v84 offset:512
    ds_read_b64_tr_b16 v[42:43], v85 offset:512
    ds_read_b128 v[48:51], v88 offset:0
    s_waitcnt lgkmcnt(3)
    v_mfma_f32_32x32x16_bf16 v[144:159], v[56:59], v[60:63], v[144:159]
    ds_read_b64_tr_b16 v[44:45], v84 offset:4608
    ds_read_b64_tr_b16 v[46:47], v85 offset:4608
    s_waitcnt lgkmcnt(2)
    v_mfma_f32_32x32x16_bf16 v[128:143], v[40:43], v[48:51], v[128:143]
    ds_read_b64_tr_b16 v[52:53], v84 offset:768
    ds_read_b64_tr_b16 v[54:55], v85 offset:768
    ds_read_b128 v[60:63], v89 offset:0
    s_waitcnt lgkmcnt(3)
    v_mfma_f32_32x32x16_bf16 v[144:159], v[44:47], v[48:51], v[144:159]
    ds_read_b64_tr_b16 v[56:57], v84 offset:4864
    ds_read_b64_tr_b16 v[58:59], v85 offset:4864
    s_barrier
    s_waitcnt lgkmcnt(2)
    v_mfma_f32_32x32x16_bf16 v[128:143], v[52:55], v[60:63], v[128:143]
    ds_read_b64_tr_b16 v[40:41], v84 offset:24576
    ds_read_b64_tr_b16 v[42:43], v85 offset:24576
    ds_read_b128 v[48:51], v86 offset:24576
    s_waitcnt lgkmcnt(3)
    v_mfma_f32_32x32x16_bf16 v[144:159], v[56:59], v[60:63], v[144:159]
    ds_read_b64_tr_b16 v[44:45], v84 offset:28672
    ds_read_b64_tr_b16 v[46:47], v85 offset:28672
    s_waitcnt lgkmcnt(2)
    v_mfma_f32_32x32x16_bf16 v[128:143], v[40:43], v[48:51], v[128:143]
    ds_read_b64_tr_b16 v[52:53], v84 offset:24832
    ds_read_b64_tr_b16 v[54:55], v85 offset:24832
    ds_read_b128 v[60:63], v87 offset:24576
    s_waitcnt lgkmcnt(3)
    v_mfma_f32_32x32x16_bf16 v[144:159], v[44:47], v[48:51], v[144:159]
    ds_read_b64_tr_b16 v[56:57], v84 offset:28928
    ds_read_b64_tr_b16 v[58:59], v85 offset:28928
    s_waitcnt lgkmcnt(2)
    v_mfma_f32_32x32x16_bf16 v[128:143], v[52:55], v[60:63], v[128:143]
    ds_read_b64_tr_b16 v[40:41], v84 offset:25088
    ds_read_b64_tr_b16 v[42:43], v85 offset:25088
    ds_read_b128 v[48:51], v88 offset:24576
    s_waitcnt lgkmcnt(3)
    v_mfma_f32_32x32x16_bf16 v[144:159], v[56:59], v[60:63], v[144:159]
    ds_read_b64_tr_b16 v[44:45], v84 offset:29184
    ds_read_b64_tr_b16 v[46:47], v85 offset:29184
    s_waitcnt lgkmcnt(2)
    v_mfma_f32_32x32x16_bf16 v[128:143], v[40:43], v[48:51], v[128:143]
    ds_read_b64_tr_b16 v[52:53], v84 offset:25344
    ds_read_b64_tr_b16 v[54:55], v85 offset:25344
    ds_read_b128 v[60:63], v89 offset:24576
    s_waitcnt lgkmcnt(3)
    v_mfma_f32_32x32x16_bf16 v[144:159], v[44:47], v[48:51], v[144:159]
    ds_read_b64_tr_b16 v[56:57], v84 offset:29440
    ds_read_b64_tr_b16 v[58:59], v85 offset:29440
    s_barrier
    s_waitcnt lgkmcnt(2)
    v_mfma_f32_32x32x16_bf16 v[128:143], v[52:55], v[60:63], v[128:143]
    ds_read_b64_tr_b16 v[40:41], v72 offset:0
    ds_read_b64_tr_b16 v[42:43], v73 offset:0
    ds_read_b128 v[48:51], v74 offset:0
    s_waitcnt lgkmcnt(3)
    v_mfma_f32_32x32x16_bf16 v[144:159], v[56:59], v[60:63], v[144:159]
    ds_read_b64_tr_b16 v[44:45], v72 offset:4096
    ds_read_b64_tr_b16 v[46:47], v73 offset:4096
    s_waitcnt lgkmcnt(2)
    v_mfma_f32_32x32x16_bf16 v[128:143], v[40:43], v[48:51], v[128:143]
    ds_read_b64_tr_b16 v[52:53], v72 offset:256
    ds_read_b64_tr_b16 v[54:55], v73 offset:256
    ds_read_b128 v[60:63], v75 offset:0
    s_waitcnt lgkmcnt(3)
    v_mfma_f32_32x32x16_bf16 v[144:159], v[44:47], v[48:51], v[144:159]
    ds_read_b64_tr_b16 v[56:57], v72 offset:4352
    ds_read_b64_tr_b16 v[58:59], v73 offset:4352
    s_waitcnt lgkmcnt(2)
    v_mfma_f32_32x32x16_bf16 v[128:143], v[52:55], v[60:63], v[128:143]
    ds_read_b64_tr_b16 v[40:41], v72 offset:512
    ds_read_b64_tr_b16 v[42:43], v73 offset:512
    ds_read_b128 v[48:51], v76 offset:0
    s_waitcnt lgkmcnt(3)
    v_mfma_f32_32x32x16_bf16 v[144:159], v[56:59], v[60:63], v[144:159]
    ds_read_b64_tr_b16 v[44:45], v72 offset:4608
    ds_read_b64_tr_b16 v[46:47], v73 offset:4608
    s_waitcnt lgkmcnt(2)
    v_mfma_f32_32x32x16_bf16 v[128:143], v[40:43], v[48:51], v[128:143]
    ds_read_b64_tr_b16 v[52:53], v72 offset:768
    ds_read_b64_tr_b16 v[54:55], v73 offset:768
    ds_read_b128 v[60:63], v77 offset:0
    s_waitcnt lgkmcnt(3)
    v_mfma_f32_32x32x16_bf16 v[144:159], v[44:47], v[48:51], v[144:159]
    ds_read_b64_tr_b16 v[56:57], v72 offset:4864
    ds_read_b64_tr_b16 v[58:59], v73 offset:4864
    s_barrier
    s_waitcnt lgkmcnt(2)
    v_mfma_f32_32x32x16_bf16 v[128:143], v[52:55], v[60:63], v[128:143]
    ds_read_b64_tr_b16 v[40:41], v72 offset:24576
    ds_read_b64_tr_b16 v[42:43], v73 offset:24576
    ds_read_b128 v[48:51], v74 offset:24576
    s_waitcnt lgkmcnt(3)
    v_mfma_f32_32x32x16_bf16 v[144:159], v[56:59], v[60:63], v[144:159]
    ds_read_b64_tr_b16 v[44:45], v72 offset:28672
    ds_read_b64_tr_b16 v[46:47], v73 offset:28672
    s_waitcnt lgkmcnt(2)
    v_mfma_f32_32x32x16_bf16 v[128:143], v[40:43], v[48:51], v[128:143]
    ds_read_b64_tr_b16 v[52:53], v72 offset:24832
    ds_read_b64_tr_b16 v[54:55], v73 offset:24832
    ds_read_b128 v[60:63], v75 offset:24576
    s_waitcnt lgkmcnt(3)
    v_mfma_f32_32x32x16_bf16 v[144:159], v[44:47], v[48:51], v[144:159]
    ds_read_b64_tr_b16 v[56:57], v72 offset:28928
    ds_read_b64_tr_b16 v[58:59], v73 offset:28928
    s_waitcnt lgkmcnt(2)
    v_mfma_f32_32x32x16_bf16 v[128:143], v[52:55], v[60:63], v[128:143]
    ds_read_b64_tr_b16 v[40:41], v72 offset:25088
    ds_read_b64_tr_b16 v[42:43], v73 offset:25088
    ds_read_b128 v[48:51], v76 offset:24576
    s_waitcnt lgkmcnt(3)
    v_mfma_f32_32x32x16_bf16 v[144:159], v[56:59], v[60:63], v[144:159]
    ds_read_b64_tr_b16 v[44:45], v72 offset:29184
    ds_read_b64_tr_b16 v[46:47], v73 offset:29184
    s_waitcnt lgkmcnt(2)
    v_mfma_f32_32x32x16_bf16 v[128:143], v[40:43], v[48:51], v[128:143]
    ds_read_b64_tr_b16 v[52:53], v72 offset:25344
    ds_read_b64_tr_b16 v[54:55], v73 offset:25344
    ds_read_b128 v[60:63], v77 offset:24576
    s_waitcnt lgkmcnt(3)
    v_mfma_f32_32x32x16_bf16 v[144:159], v[44:47], v[48:51], v[144:159]
    ds_read_b64_tr_b16 v[56:57], v72 offset:29440
    ds_read_b64_tr_b16 v[58:59], v73 offset:29440
    s_barrier
    s_waitcnt lgkmcnt(2)
    v_mfma_f32_32x32x16_bf16 v[128:143], v[52:55], v[60:63], v[128:143]
    ds_read_b64_tr_b16 v[40:41], v78 offset:0
    ds_read_b64_tr_b16 v[42:43], v79 offset:0
    ds_read_b128 v[48:51], v80 offset:0
    s_waitcnt lgkmcnt(3)
    v_mfma_f32_32x32x16_bf16 v[144:159], v[56:59], v[60:63], v[144:159]
    ds_read_b64_tr_b16 v[44:45], v78 offset:4096
    ds_read_b64_tr_b16 v[46:47], v79 offset:4096
    s_waitcnt lgkmcnt(2)
    v_mfma_f32_32x32x16_bf16 v[128:143], v[40:43], v[48:51], v[128:143]
    ds_read_b64_tr_b16 v[52:53], v78 offset:256
    ds_read_b64_tr_b16 v[54:55], v79 offset:256
    ds_read_b128 v[60:63], v81 offset:0
    s_waitcnt lgkmcnt(3)
    v_mfma_f32_32x32x16_bf16 v[144:159], v[44:47], v[48:51], v[144:159]
    ds_read_b64_tr_b16 v[56:57], v78 offset:4352
    ds_read_b64_tr_b16 v[58:59], v79 offset:4352
    s_waitcnt lgkmcnt(2)
    v_mfma_f32_32x32x16_bf16 v[128:143], v[52:55], v[60:63], v[128:143]
    ds_read_b64_tr_b16 v[40:41], v78 offset:512
    ds_read_b64_tr_b16 v[42:43], v79 offset:512
    ds_read_b128 v[48:51], v82 offset:0
    s_waitcnt lgkmcnt(3)
    v_mfma_f32_32x32x16_bf16 v[144:159], v[56:59], v[60:63], v[144:159]
    ds_read_b64_tr_b16 v[44:45], v78 offset:4608
    ds_read_b64_tr_b16 v[46:47], v79 offset:4608
    s_waitcnt lgkmcnt(2)
    v_mfma_f32_32x32x16_bf16 v[128:143], v[40:43], v[48:51], v[128:143]
    ds_read_b64_tr_b16 v[52:53], v78 offset:768
    ds_read_b64_tr_b16 v[54:55], v79 offset:768
    ds_read_b128 v[60:63], v83 offset:0
    s_waitcnt lgkmcnt(3)
    v_mfma_f32_32x32x16_bf16 v[144:159], v[44:47], v[48:51], v[144:159]
    ds_read_b64_tr_b16 v[56:57], v78 offset:4864
    ds_read_b64_tr_b16 v[58:59], v79 offset:4864
    s_waitcnt lgkmcnt(2)
    v_mfma_f32_32x32x16_bf16 v[128:143], v[52:55], v[60:63], v[128:143]
    s_waitcnt lgkmcnt(0)
    v_mfma_f32_32x32x16_bf16 v[144:159], v[56:59], v[60:63], v[144:159]
    s_nop 10
    s_mov_b32 s30, 0
    buffer_store_dword v128, v16, s[20:23], s30 offen sc0 sc1
    s_mov_b32 s30, 5120
    buffer_store_dword v129, v16, s[20:23], s30 offen sc0 sc1
    s_mov_b32 s30, 10240
    buffer_store_dword v130, v16, s[20:23], s30 offen sc0 sc1
    s_mov_b32 s30, 15360
    buffer_store_dword v131, v16, s[20:23], s30 offen sc0 sc1
    s_mov_b32 s30, 40960
    buffer_store_dword v132, v16, s[20:23], s30 offen sc0 sc1
    s_mov_b32 s30, 46080
    buffer_store_dword v133, v16, s[20:23], s30 offen sc0 sc1
    s_mov_b32 s30, 51200
    buffer_store_dword v134, v16, s[20:23], s30 offen sc0 sc1
    s_mov_b32 s30, 56320
    buffer_store_dword v135, v16, s[20:23], s30 offen sc0 sc1
    s_mov_b32 s30, 81920
    buffer_store_dword v136, v16, s[20:23], s30 offen sc0 sc1
    s_mov_b32 s30, 87040
    buffer_store_dword v137, v16, s[20:23], s30 offen sc0 sc1
    s_mov_b32 s30, 92160
    buffer_store_dword v138, v16, s[20:23], s30 offen sc0 sc1
    s_mov_b32 s30, 97280
    buffer_store_dword v139, v16, s[20:23], s30 offen sc0 sc1
    s_mov_b32 s30, 122880
    buffer_store_dword v140, v16, s[20:23], s30 offen sc0 sc1
    s_mov_b32 s30, 128000
    buffer_store_dword v141, v16, s[20:23], s30 offen sc0 sc1
    s_mov_b32 s30, 133120
    buffer_store_dword v142, v16, s[20:23], s30 offen sc0 sc1
    s_mov_b32 s30, 138240
    buffer_store_dword v143, v16, s[20:23], s30 offen sc0 sc1
    s_mov_b32 s30, 163840
    buffer_store_dword v144, v16, s[20:23], s30 offen sc0 sc1
    s_mov_b32 s30, 168960
    buffer_store_dword v145, v16, s[20:23], s30 offen sc0 sc1
    s_mov_b32 s30, 174080
    buffer_store_dword v146, v16, s[20:23], s30 offen sc0 sc1
    s_mov_b32 s30, 179200
    buffer_store_dword v147, v16, s[20:23], s30 offen sc0 sc1
    s_mov_b32 s30, 204800
    buffer_store_dword v148, v16, s[20:23], s30 offen sc0 sc1
    s_mov_b32 s30, 209920
    buffer_store_dword v149, v16, s[20:23], s30 offen sc0 sc1
    s_mov_b32 s30, 215040
    buffer_store_dword v150, v16, s[20:23], s30 offen sc0 sc1
    s_mov_b32 s30, 220160
    buffer_store_dword v151, v16, s[20:23], s30 offen sc0 sc1
    s_mov_b32 s30, 245760
    buffer_store_dword v152, v16, s[20:23], s30 offen sc0 sc1
    s_mov_b32 s30, 250880
    buffer_store_dword v153, v16, s[20:23], s30 offen sc0 sc1
    s_mov_b32 s30, 256000
    buffer_store_dword v154, v16, s[20:23], s30 offen sc0 sc1
    s_mov_b32 s30, 261120
    buffer_store_dword v155, v16, s[20:23], s30 offen sc0 sc1
    s_mov_b32 s30, 286720
    buffer_store_dword v156, v16, s[20:23], s30 offen sc0 sc1
    s_mov_b32 s30, 291840
    buffer_store_dword v157, v16, s[20:23], s30 offen sc0 sc1
    s_mov_b32 s30, 296960
    buffer_store_dword v158, v16, s[20:23], s30 offen sc0 sc1
    s_mov_b32 s30, 302080
    buffer_store_dword v159, v16, s[20:23], s30 offen sc0 sc1
    s_endpgm
L_E:
    s_cmp_lt_u32 s29, 4
    s_cbranch_scc1 L_E_comp
    s_mov_b32 s16, s4
    s_and_b32 s17, s5, 0xffff
    s_mov_b32 s18, 819200
    s_mov_b32 s19, 0x00020000
    s_cmp_lg_u32 s29, 4
    s_cbranch_scc1 L_w4_38
    v_mov_b32 v21, 0
    s_mov_b64 exec, 1
    buffer_atomic_add v21, off, s[44:47], s23 sc0 sc1
    s_mov_b64 exec, -1
L_w4_38:
    s_barrier
    s_add_u32 s35, s22, 0
    s_and_b32 s35, s35, 3
    s_and_b32 s33, s35, 1
    s_lshl_b32 s33, s33, 4
    s_lshr_b32 s35, s35, 1
    s_add_u32 s35, s35, s33
    s_add_u32 m0, s20, 20480
    s_mul_i32 s33, s35, 25600
    buffer_load_dwordx4 v176, s[16:19], s33 offen offset:0 lds
    buffer_load_dwordx4 v177, s[16:19], s33 offen offset:1024 lds
    buffer_load_dwordx4 v178, s[16:19], s33 offen offset:2048 lds
    buffer_load_dwordx4 v179, s[16:19], s33 offen offset:3072 lds
    s_add_u32 m0, s20, 24576
    s_nop 0
    buffer_load_dwordx4 v180, s[16:19], s33 offen offset:0 lds
    s_add_u32 s35, s22, 1
    s_and_b32 s35, s35, 3
    s_and_b32 s33, s35, 1
    s_lshl_b32 s33, s33, 4
    s_lshr_b32 s35, s35, 1
    s_add_u32 s35, s35, s33
    s_add_u32 m0, s20, 61440
    s_mul_i32 s33, s35, 25600
    buffer_load_dwordx4 v176, s[16:19], s33 offen offset:0 lds
    buffer_load_dwordx4 v177, s[16:19], s33 offen offset:1024 lds
    buffer_load_dwordx4 v178, s[16:19], s33 offen offset:2048 lds
    buffer_load_dwordx4 v179, s[16:19], s33 offen offset:3072 lds
    s_add_u32 m0, s20, 65536
    s_nop 0
    buffer_load_dwordx4 v180, s[16:19], s33 offen offset:0 lds
    s_waitcnt vmcnt(10)
    s_barrier
    s_cmp_lg_u32 s29, 4
    s_cbranch_scc1 L_w4_39
    s_mov_b32 s72, 0
    s_branch L_chk_42
L_poll_40:
    v_mov_b32 v21, 0
    s_mov_b64 exec, 1
    buffer_atomic_add v21, off, s[44:47], s23 sc0 sc1
    s_mov_b64 exec, -1
    s_waitcnt vmcnt(0)
L_chk_42:
    v_readfirstlane_b32 s99, v21
    s_add_u32 s72, s72, 1
    s_nop 2
    s_cmp_eq_u32 s99, 16
    s_cbranch_scc1 L_polled_41
    s_sleep 6
    s_cmp_lt_u32 s72, 0x20000
    s_cbranch_scc1 L_poll_40
L_polled_41:
    s_add_u32 s23, s23, 4352
L_w4_39:
    s_barrier
    s_add_u32 s35, s22, 0
    s_and_b32 s35, s35, 3
    s_and_b32 s33, s35, 1
    s_lshl_b32 s33, s33, 4
    s_lshr_b32 s35, s35, 1
    s_add_u32 s35, s35, s33
    s_add_u32 m0, s20, 0
    s_mul_i32 s32, s35, 81920
    buffer_load_dwordx4 v181, s[68:71], s32 offen offset:0 sc1 lds
    buffer_load_dwordx4 v182, s[68:71], s32 offen offset:1024 sc1 lds
    buffer_load_dwordx4 v183, s[68:71], s32 offen offset:2048 sc1 lds
    buffer_load_dwordx4 v184, s[68:71], s32 offen offset:3072 sc1 lds
    s_add_u32 m0, s20, 4096
    s_nop 0
    buffer_load_dwordx4 v185, s[68:71], s32 offen offset:0 sc1 lds
    s_add_u32 s35, s22, 1
    s_and_b32 s35, s35, 3
    s_and_b32 s33, s35, 1
    s_lshl_b32 s33, s33, 4
    s_lshr_b32 s35, s35, 1
    s_add_u32 s35, s35, s33
    s_add_u32 m0, s20, 40960
    s_mul_i32 s32, s35, 81920
    buffer_load_dwordx4 v181, s[68:71], s32 offen offset:0 sc1 lds
    buffer_load_dwordx4 v182, s[68:71], s32 offen offset:1024 sc1 lds
    buffer_load_dwordx4 v183, s[68:71], s32 offen offset:2048 sc1 lds
    buffer_load_dwordx4 v184, s[68:71], s32 offen offset:3072 sc1 lds
    s_add_u32 m0, s20, 45056
    s_nop 0
    buffer_load_dwordx4 v185, s[68:71], s32 offen offset:0 sc1 lds
    s_waitcnt vmcnt(5)
    s_barrier
    s_add_u32 s35, s22, 2
    s_and_b32 s35, s35, 3
    s_and_b32 s33, s35, 1
    s_lshl_b32 s33, s33, 4
    s_lshr_b32 s35, s35, 1
    s_add_u32 s35, s35, s33
    s_add_u32 m0, s20, 81920
    s_mul_i32 s32, s35, 81920
    buffer_load_dwordx4 v181, s[68:71], s32 offen offset:0 sc1 lds
    buffer_load_dwordx4 v182, s[68:71], s32 offen offset:1024 sc1 lds
    buffer_load_dwordx4 v183, s[68:71], s32 offen offset:2048 sc1 lds
    buffer_load_dwordx4 v184, s[68:71], s32 offen offset:3072 sc1 lds
    s_add_u32 m0, s20, 86016
    s_nop 0
    buffer_load_dwordx4 v185, s[68:71], s32 offen offset:0 sc1 lds
    s_add_u32 s35, s22, 2
    s_and_b32 s35, s35, 3
    s_and_b32 s33, s35, 1
    s_lshl_b32 s33, s33, 4
    s_lshr_b32 s35, s35, 1
    s_add_u32 s35, s35, s33
    s_add_u32 m0, s20, 102400
    s_mul_i32 s33, s35, 25600
    buffer_load_dwordx4 v176, s[16:19], s33 offen offset:0 lds
    buffer_load_dwordx4 v177, s[16:19], s33 offen offset:1024 lds
    buffer_load_dwordx4 v178, s[16:19], s33 offen offset:2048 lds
    buffer_load_dwordx4 v179, s[16:19], s33 offen offset:3072 lds
    s_add_u32 m0, s20, 106496
    s_nop 0
    buffer_load_dwordx4 v180, s[16:19], s33 offen offset:0 lds
    s_waitcnt vmcnt(10)
    s_barrier
    s_cmp_lg_u32 s29, 4
    s_cbranch_scc1 L_w4_43
    v_mov_b32 v21, 0
    s_mov_b64 exec, 1
    buffer_atomic_add v21, off, s[44:47], s23 sc0 sc1
    s_mov_b64 exec, -1
L_w4_43:
    s_add_u32 s35, s22, 3
    s_and_b32 s35, s35, 3
    s_and_b32 s33, s35, 1
    s_lshl_b32 s33, s33, 4
    s_lshr_b32 s35, s35, 1
    s_add_u32 s35, s35, s33
    s_add_u32 m0, s20, 122880
    s_mul_i32 s32, s35, 81920
    buffer_load_dwordx4 v181, s[68:71], s32 offen offset:0 sc1 lds
    buffer_load_dwordx4 v182, s[68:71], s32 offen offset:1024 sc1 lds
    buffer_load_dwordx4 v183, s[68:71], s32 offen offset:2048 sc1 lds
    buffer_load_dwordx4 v184, s[68:71], s32 offen offset:3072 sc1 lds
    s_add_u32 m0, s20, 126976
    s_nop 0
    buffer_load_dwordx4 v185, s[68:71], s32 offen offset:0 sc1 lds
    s_add_u32 s35, s22, 3
    s_and_b32 s35, s35, 3
    s_and_b32 s33, s35, 1
    s_lshl_b32 s33, s33, 4
    s_lshr_b32 s35, s35, 1
    s_add_u32 s35, s35, s33
    s_add_u32 m0, s20, 143360
    s_mul_i32 s33, s35, 25600
    buffer_load_dwordx4 v176, s[16:19], s33 offen offset:0 lds
    buffer_load_dwordx4 v177, s[16:19], s33 offen offset:1024 lds
    buffer_load_dwordx4 v178, s[16:19], s33 offen offset:2048 lds
    buffer_load_dwordx4 v179, s[16:19], s33 offen offset:3072 lds
    s_add_u32 m0, s20, 147456
    s_nop 0
    buffer_load_dwordx4 v180, s[16:19], s33 offen offset:0 lds
    s_waitcnt vmcnt(10)
    s_cmp_lg_u32 s29, 4
    s_cbranch_scc1 L_w4_44
    s_waitcnt vmcnt(10)
    s_mov_b32 s72, 0
    s_branch L_chk_47
L_poll_45:
    v_mov_b32 v21, 0
    s_mov_b64 exec, 1
    buffer_atomic_add v21, off, s[44:47], s23 sc0 sc1
    s_mov_b64 exec, -1
    s_waitcnt vmcnt(0)
L_chk_47:
    v_readfirstlane_b32 s99, v21
    s_add_u32 s72, s72, 1
    s_nop 2
    s_cmp_eq_u32 s99, 16
    s_cbranch_scc1 L_polled_46
    s_sleep 6
    s_cmp_lt_u32 s72, 0x20000
    s_cbranch_scc1 L_poll_45
L_polled_46:
L_w4_44:
    s_barrier
    s_add_u32 s35, s22, 4
    s_and_b32 s35, s35, 3
    s_and_b32 s33, s35, 1
    s_lshl_b32 s33, s33, 4
    s_lshr_b32 s35, s35, 1
    s_add_u32 s35, s35, s33
    s_add_u32 s35, s35, 2
    s_add_u32 m0, s20, 0
    s_mul_i32 s32, s35, 81920
    buffer_load_dwordx4 v181, s[68:71], s32 offen offset:0 sc1 lds
    buffer_load_dwordx4 v182, s[68:71], s32 offen offset:1024 sc1 lds
    buffer_load_dwordx4 v183, s[68:71], s32 offen offset:2048 sc1 lds
    buffer_load_dwordx4 v184, s[68:71], s32 offen offset:3072 sc1 lds
    s_add_u32 m0, s20, 4096
    s_nop 0
    buffer_load_dwordx4 v185, s[68:71], s32 offen offset:0 sc1 lds
    s_add_u32 s35, s22, 4
    s_and_b32 s35, s35, 3
    s_and_b32 s33, s35, 1
    s_lshl_b32 s33, s33, 4
    s_lshr_b32 s35, s35, 1
    s_add_u32 s35, s35, s33
    s_add_u32 s35, s35, 2
    s_add_u32 m0, s20, 20480
    s_mul_i32 s33, s35, 25600
    buffer_load_dwordx4 v176, s[16:19], s33 offen offset:0 lds
    buffer_load_dwordx4 v177, s[16:19], s33 offen offset:1024 lds
    buffer_load_dwordx4 v178, s[16:19], s33 offen offset:2048 lds
    buffer_load_dwordx4 v179, s[16:19], s33 offen offset:3072 lds
    s_add_u32 m0, s20, 24576
    s_nop 0
    buffer_load_dwordx4 v180, s[16:19], s33 offen offset:0 lds
    s_waitcnt vmcnt(10)
    s_barrier
    s_add_u32 s35, s22, 5
    s_and_b32 s35, s35, 3
    s_and_b32 s33, s35, 1
    s_lshl_b32 s33, s33, 4
    s_lshr_b32 s35, s35, 1
    s_add_u32 s35, s35, s33
    s_add_u32 s35, s35, 2
    s_add_u32 m0, s20, 40960
    s_mul_i32 s32, s35, 81920
    buffer_load_dwordx4 v181, s[68:71], s32 offen offset:0 sc1 lds
    buffer_load_dwordx4 v182, s[68:71], s32 offen offset:1024 sc1 lds
    buffer_load_dwordx4 v183, s[68:71], s32 offen offset:2048 sc1 lds
    buffer_load_dwordx4 v184, s[68:71], s32 offen offset:3072 sc1 lds
    s_add_u32 m0, s20, 45056
    s_nop 0
    buffer_load_dwordx4 v185, s[68:71], s32 offen offset:0 sc1 lds
    s_add_u32 s35, s22, 5
    s_and_b32 s35, s35, 3
    s_and_b32 s33, s35, 1
    s_lshl_b32 s33, s33, 4
    s_lshr_b32 s35, s35, 1
    s_add_u32 s35, s35, s33
    s_add_u32 s35, s35, 2
    s_add_u32 m0, s20, 61440
    s_mul_i32 s33, s35, 25600
    buffer_load_dwordx4 v176, s[16:19], s33 offen offset:0 lds
    buffer_load_dwordx4 v177, s[16:19], s33 offen offset:1024 lds
    buffer_load_dwordx4 v178, s[16:19], s33 offen offset:2048 lds
    buffer_load_dwordx4 v179, s[16:19], s33 offen offset:3072 lds
    s_add_u32 m0, s20, 65536
    s_nop 0
    buffer_load_dwordx4 v180, s[16:19], s33 offen offset:0 lds
    s_waitcnt vmcnt(10)
    s_barrier
    s_add_u32 s35, s22, 6
    s_and_b32 s35, s35, 3
    s_and_b32 s33, s35, 1
    s_lshl_b32 s33, s33, 4
    s_lshr_b32 s35, s35, 1
    s_add_u32 s35, s35, s33
    s_add_u32 s35, s35, 2
    s_add_u32 m0, s20, 81920
    s_mul_i32 s32, s35, 81920
    buffer_load_dwordx4 v181, s[68:71], s32 offen offset:0 sc1 lds
    buffer_load_dwordx4 v182, s[68:71], s32 offen offset:1024 sc1 lds
    buffer_load_dwordx4 v183, s[68:71], s32 offen offset:2048 sc1 lds
    buffer_load_dwordx4 v184, s[68:71], s32 offen offset:3072 sc1 lds
    s_add_u32 m0, s20, 86016
    s_nop 0
    buffer_load_dwordx4 v185, s[68:71], s32 offen offset:0 sc1 lds
    s_add_u32 s35, s22, 6
    s_and_b32 s35, s35, 3
    s_and_b32 s33, s35, 1
    s_lshl_b32 s33, s33, 4
    s_lshr_b32 s35, s35, 1
    s_add_u32 s35, s35, s33
    s_add_u32 s35, s35, 2
    s_add_u32 m0, s20, 102400
    s_mul_i32 s33, s35, 25600
    buffer_load_dwordx4 v176, s[16:19], s33 offen offset:0 lds
    buffer_load_dwordx4 v177, s[16:19], s33 offen offset:1024 lds
    buffer_load_dwordx4 v178, s[16:19], s33 offen offset:2048 lds
    buffer_load_dwordx4 v179, s[16:19], s33 offen offset:3072 lds
    s_add_u32 m0, s20, 106496
    s_nop 0
    buffer_load_dwordx4 v180, s[16:19], s33 offen offset:0 lds
    s_waitcnt vmcnt(10)
    s_barrier
    s_add_u32 s35, s22, 7
    s_and_b32 s35, s35, 3
    s_and_b32 s33, s35, 1
    s_lshl_b32 s33, s33, 4
    s_lshr_b32 s35, s35, 1
    s_add_u32 s35, s35, s33
    s_add_u32 s35, s35, 2
    s_add_u32 m0, s20, 122880
    s_mul_i32 s32, s35, 81920
    buffer_load_dwordx4 v181, s[68:71], s32 offen offset:0 sc1 lds
    buffer_load_dwordx4 v182, s[68:71], s32 offen offset:1024 sc1 lds
    buffer_load_dwordx4 v183, s[68:71], s32 offen offset:2048 sc1 lds
    buffer_load_dwordx4 v184, s[68:71], s32 offen offset:3072 sc1 lds
    s_add_u32 m0, s20, 126976
    s_nop 0
    buffer_load_dwordx4 v185, s[68:71], s32 offen offset:0 sc1 lds
    s_add_u32 s35, s22, 7
    s_and_b32 s35, s35, 3
    s_and_b32 s33, s35, 1
    s_lshl_b32 s33, s33, 4
    s_lshr_b32 s35, s35, 1
    s_add_u32 s35, s35, s33
    s_add_u32 s35, s35, 2
    s_add_u32 m0, s20, 143360
    s_mul_i32 s33, s35, 25600
    buffer_load_dwordx4 v176, s[16:19], s33 offen offset:0 lds
    buffer_load_dwordx4 v177, s[16:19], s33 offen offset:1024 lds
    buffer_load_dwordx4 v178, s[16:19], s33 offen offset:2048 lds
    buffer_load_dwordx4 v179, s[16:19], s33 offen offset:3072 lds
    s_add_u32 m0, s20, 147456
    s_nop 0
    buffer_load_dwordx4 v180, s[16:19], s33 offen offset:0 lds
    s_waitcnt vmcnt(10)
    s_barrier
    s_waitcnt vmcnt(0)
    s_barrier
    s_endpgm
L_E_comp:
    s_barrier
    s_load_dwordx2 s[6:7], s[0:1], 96
    s_waitcnt vmcnt(0)
    s_barrier
    s_cmp_lg_u32 s29, 0
    s_cbranch_scc1 L_w4_48
    s_lshl_b32 s30, s42, 1
    s_bfe_u32 s31, s39, 0x10001
    s_add_u32 s30, s30, s31
    s_mul_i32 s30, s30, 4352
    s_add_u32 s30, s30, 217600
    v_mov_b32 v20, 1
    s_mov_b64 exec, 1
    buffer_atomic_add v20, off, s[44:47], s30 sc1
    s_mov_b64 exec, -1
L_w4_48:
    s_sub_u32 s30, s25, 20
    s_and_b32 s31, s30, 1
    s_lshl_b32 s26, s24, 1
    s_add_u32 s26, s26, s31
    s_lshr_b32 s27, s30, 1
    s_lshr_b32 s30, s29, 1
    s_mul_i32 s30, s30, 10240
    v_lshlrev_b32 v72, 4, v2
    v_add_u32 v72, s30, v72
    v_bfe_u32 v3, v2, 2, 2
    v_lshrrev_b32 v9, 5, v2
    v_bfe_u32 v11, v2, 4, 1
    v_lshlrev_b32 v11, 5, v11
    v_and_b32 v10, 3, v2
    v_lshl_add_u32 v11, v10, 3, v11
    v_and_b32 v10, 31, v2
    v_mul_u32_u24 v8, 2560, v9
    v_lshl_add_u32 v8, v10, 3, v8
    v_add_u32 v8, s30, v8
    v_add_u32 v73, 1024, v8
    v_lshl_add_u32 v11, v3, 8, v11
    v_add_u32 v11, 20480, v11
    s_and_b32 s30, s29, 1
    s_lshl_b32 s30, s30, 1
    v_mul_u32_u24 v12, 10240, v9
    v_add_u32 v12, 4096, v12
    s_add_u32 s31, s30, 0
    v_xor_b32 v10, s31, v3
    v_lshl_add_u32 v10, v10, 6, v11
    v_lshl_add_u32 v74, v9, 11, v10
    v_add_u32 v76, v12, v10
    s_add_u32 s31, s30, 1
    v_xor_b32 v10, s31, v3
    v_lshl_add_u32 v10, v10, 6, v11
    v_lshl_add_u32 v75, v9, 11, v10
    v_add_u32 v77, v12, v10
    v_add_u32 v78, 81920, v72
    v_add_u32 v79, 81920, v73
    v_add_u32 v80, 81920, v74
    v_add_u32 v81, 81920, v75
    v_add_u32 v82, 81920, v76
    v_add_u32 v83, 81920, v77
    s_lshl_b32 s35, s27, 7
    s_add_u32 s35, s35, 640
    s_lshr_b32 s30, s29, 1
    s_lshl_b32 s30, s30, 6
    s_lshl_b32 s31, s26, 7
    s_add_u32 s30, s30, s31
    v_lshrrev_b32 v9, 5, v2
    v_lshl_add_u32 v10, v9, 2, s30
    v_mul_u32_u24 v10, 5120, v10
    s_and_b32 s31, s29, 1
    s_mul_i32 s31, s31, 64
    s_add_u32 s31, s31, s35
    v_and_b32 v3, 31, v2
    v_add_u32 v11, s31, v3
    v_lshl_add_u32 v16, v11, 2, v10
    v_add_u32 v17, 128, v16
    s_waitcnt lgkmcnt(0)
    s_mov_b32 s20, s6
    s_and_b32 s21, s7, 0xffff
    s_mov_b32 s22, 10485760
    s_mov_b32 s23, 0x00020000
    s_lshl_b32 s30, s27, 1
    s_and_b32 s31, s29, 1
    s_add_u32 s30, s30, s31
    s_lshl_b32 s30, s30, 6
    v_add_u32 v8, s30, v2
    v_mul_u32_u24 v9, 1639, v8
    v_lshrrev_b32 v9, 16, v9
    v_mul_u32_u24 v10, 40, v9
    v_sub_u32 v8, v8, v10
    v_and_b32 v10, 14, v9
    v_add_u32 v9, v9, v10
    s_and_b32 s31, s29, 2
    v_add_u32 v9, s31, v9
    s_mov_b32 s31, 81920
    v_mul_lo_u32 v9, v9, s31
    s_mul_i32 s30, s26, 5120
    v_lshl_add_u32 v8, v8, 7, s30
    v_add_u32 v18, v8, v9
    s_barrier
    s_barrier
    ds_read_b128 v[40:43], v72 offset:0
    ds_read_b64_tr_b16 v[48:49], v74 offset:0
    ds_read_b64_tr_b16 v[50:51], v74 offset:1024
    ds_read_b128 v[44:47], v72 offset:5120
    ds_read_b64_tr_b16 v[52:53], v75 offset:0
    ds_read_b64_tr_b16 v[54:55], v75 offset:1024
    s_waitcnt lgkmcnt(3)
    v_mfma_f32_32x32x16_bf16 v[128:143], v[40:43], v[48:51], 0
    ds_read_b128 v[56:59], v72 offset:1280
    ds_read_b64_tr_b16 v[64:65], v74 offset:5120
    ds_read_b64_tr_b16 v[66:67], v74 offset:6144
    s_waitcnt lgkmcnt(5)
    v_mfma_f32_32x32x16_bf16 v[160:175], v[44:47], v[48:51], 0
    ds_read_b128 v[60:63], v72 offset:6400
    ds_read_b64_tr_b16 v[68:69], v75 offset:5120
    ds_read_b64_tr_b16 v[70:71], v75 offset:6144
    s_waitcnt lgkmcnt(6)
    v_mfma_f32_32x32x16_bf16 v[144:159], v[40:43], v[52:55], 0
    v_mfma_f32_32x32x16_bf16 v[176:191], v[44:47], v[52:55], 0
    s_waitcnt lgkmcnt(3)
    v_mfma_f32_32x32x16_bf16 v[128:143], v[56:59], v[64:67], v[128:143]
    ds_read_b128 v[40:43], v72 offset:2560
    ds_read_b64_tr_b16 v[48:49], v74 offset:10240
    ds_read_b64_tr_b16 v[50:51], v74 offset:11264
    s_waitcnt lgkmcnt(5)
    v_mfma_f32_32x32x16_bf16 v[160:175], v[60:63], v[64:67], v[160:175]
    ds_read_b128 v[44:47], v72 offset:7680
    ds_read_b64_tr_b16 v[52:53], v75 offset:10240
    ds_read_b64_tr_b16 v[54:55], v75 offset:11264
    s_waitcnt lgkmcnt(6)
    v_mfma_f32_32x32x16_bf16 v[144:159], v[56:59], v[68:71], v[144:159]
    v_mfma_f32_32x32x16_bf16 v[176:191], v[60:63], v[68:71], v[176:191]
    s_waitcnt lgkmcnt(3)
    v_mfma_f32_32x32x16_bf16 v[128:143], v[40:43], v[48:51], v[128:143]
    ds_read_b128 v[56:59], v72 offset:3840
    ds_read_b64_tr_b16 v[64:65], v74 offset:15360
    ds_read_b64_tr_b16 v[66:67], v74 offset:16384
    s_waitcnt lgkmcnt(5)
    v_mfma_f32_32x32x16_bf16 v[160:175], v[44:47], v[48:51], v[160:175]
    ds_read_b128 v[60:63], v72 offset:8960
    ds_read_b64_tr_b16 v[68:69], v75 offset:15360
    ds_read_b64_tr_b16 v[70:71], v75 offset:16384
    s_waitcnt lgkmcnt(6)
    v_mfma_f32_32x32x16_bf16 v[144:159], v[40:43], v[52:55], v[144:159]
    v_mfma_f32_32x32x16_bf16 v[176:191], v[44:47], v[52:55], v[176:191]
    s_waitcnt lgkmcnt(3)
    v_mfma_f32_32x32x16_bf16 v[128:143], v[56:59], v[64:67], v[128:143]
    ds_read_b64 v[40:41], v73 offset:0
    ds_read_b64 v[42:43], v73 offset:1280
    ds_read_b64_tr_b16 v[48:49], v76 offset:0
    s_waitcnt lgkmcnt(5)
    v_mfma_f32_32x32x16_bf16 v[160:175], v[60:63], v[64:67], v[160:175]
    ds_read_b64_tr_b16 v[50:51], v76 offset:5120
    ds_read_b64 v[44:45], v73 offset:5120
    ds_read_b64 v[46:47], v73 offset:6400
    s_waitcnt lgkmcnt(6)
    v_mfma_f32_32x32x16_bf16 v[144:159], v[56:59], v[68:71], v[144:159]
    ds_read_b64_tr_b16 v[52:53], v77 offset:0
    ds_read_b64_tr_b16 v[54:55], v77 offset:5120
    v_mfma_f32_32x32x16_bf16 v[176:191], v[60:63], v[68:71], v[176:191]
    s_barrier
    s_waitcnt lgkmcnt(4)
    v_mfma_f32_32x32x16_bf16 v[128:143], v[40:43], v[48:51], v[128:143]
    ds_read_b128 v[56:59], v72 offset:40960
    ds_read_b64_tr_b16 v[64:65], v74 offset:40960
    ds_read_b64_tr_b16 v[66:67], v74 offset:41984
    s_waitcnt lgkmcnt(5)
    v_mfma_f32_32x32x16_bf16 v[160:175], v[44:47], v[48:51], v[160:175]
    ds_read_b128 v[60:63], v72 offset:46080
    ds_read_b64_tr_b16 v[68:69], v75 offset:40960
    ds_read_b64_tr_b16 v[70:71], v75 offset:41984
    s_waitcnt lgkmcnt(6)
    v_mfma_f32_32x32x16_bf16 v[144:159], v[40:43], v[52:55], v[144:159]
    v_mfma_f32_32x32x16_bf16 v[176:191], v[44:47], v[52:55], v[176:191]
    s_waitcnt lgkmcnt(3)
    v_mfma_f32_32x32x16_bf16 v[128:143], v[56:59], v[64:67], v[128:143]
    ds_read_b128 v[40:43], v72 offset:42240
    ds_read_b64_tr_b16 v[48:49], v74 offset:46080
    ds_read_b64_tr_b16 v[50:51], v74 offset:47104
    s_waitcnt lgkmcnt(5)
    v_mfma_f32_32x32x16_bf16 v[160:175], v[60:63], v[64:67], v[160:175]
    ds_read_b128 v[44:47], v72 offset:47360
    ds_read_b64_tr_b16 v[52:53], v75 offset:46080
    ds_read_b64_tr_b16 v[54:55], v75 offset:47104
    s_waitcnt lgkmcnt(6)
    v_mfma_f32_32x32x16_bf16 v[144:159], v[56:59], v[68:71], v[144:159]
    v_mfma_f32_32x32x16_bf16 v[176:191], v[60:63], v[68:71], v[176:191]
    s_waitcnt lgkmcnt(3)
    v_mfma_f32_32x32x16_bf16 v[128:143], v[40:43], v[48:51], v[128:143]
    ds_read_b128 v[56:59], v72 offset:43520
    ds_read_b64_tr_b16 v[64:65], v74 offset:51200
    ds_read_b64_tr_b16 v[66:67], v74 offset:52224
    s_waitcnt lgkmcnt(5)
    v_mfma_f32_32x32x16_bf16 v[160:175], v[44:47], v[48:51], v[160:175]
    ds_read_b128 v[60:63], v72 offset:48640
    ds_read_b64_tr_b16 v[68:69], v75 offset:51200
    ds_read_b64_tr_b16 v[70:71], v75 offset:52224
    s_waitcnt lgkmcnt(6)
    v_mfma_f32_32x32x16_bf16 v[144:159], v[40:43], v[52:55], v[144:159]
    v_mfma_f32_32x32x16_bf16 v[176:191], v[44:47], v[52:55], v[176:191]
    s_waitcnt lgkmcnt(3)
    v_mfma_f32_32x32x16_bf16 v[128:143], v[56:59], v[64:67], v[128:143]
    ds_read_b128 v[40:43], v72 offset:44800
    ds_read_b64_tr_b16 v[48:49], v74 offset:56320
    ds_read_b64_tr_b16 v[50:51], v74 offset:57344
    s_waitcnt lgkmcnt(5)
    v_mfma_f32_32x32x16_bf16 v[160:175], v[60:63], v[64:67], v[160:175]
    ds_read_b128 v[44:47], v72 offset:49920
    ds_read_b64_tr_b16 v[52:53], v75 offset:56320
    ds_read_b64_tr_b16 v[54:55], v75 offset:57344
    s_waitcnt lgkmcnt(6)
    v_mfma_f32_32x32x16_bf16 v[144:159], v[56:59], v[68:71], v[144:159]
    v_mfma_f32_32x32x16_bf16 v[176:191], v[60:63], v[68:71], v[176:191]
    s_waitcnt lgkmcnt(3)
    v_mfma_f32_32x32x16_bf16 v[128:143], v[40:43], v[48:51], v[128:143]
    ds_read_b64 v[56:57], v73 offset:40960
    ds_read_b64 v[58:59], v73 offset:42240
    ds_read_b64_tr_b16 v[64:65], v76 offset:40960
    s_waitcnt lgkmcnt(5)
    v_mfma_f32_32x32x16_bf16 v[160:175], v[44:47], v[48:51], v[160:175]
    ds_read_b64_tr_b16 v[66:67], v76 offset:46080
    ds_read_b64 v[60:61], v73 offset:46080
    ds_read_b64 v[62:63], v73 offset:47360
    s_waitcnt lgkmcnt(6)
    v_mfma_f32_32x32x16_bf16 v[144:159], v[40:43], v[52:55], v[144:159]
    ds_read_b64_tr_b16 v[68:69], v77 offset:40960
    ds_read_b64_tr_b16 v[70:71], v77 offset:46080
    v_mfma_f32_32x32x16_bf16 v[176:191], v[44:47], v[52:55], v[176:191]
    s_barrier
    s_waitcnt lgkmcnt(4)
    v_mfma_f32_32x32x16_bf16 v[128:143], v[56:59], v[64:67], v[128:143]
    ds_read_b128 v[40:43], v78 offset:0
    ds_read_b64_tr_b16 v[48:49], v80 offset:0
    ds_read_b64_tr_b16 v[50:51], v80 offset:1024
    s_waitcnt lgkmcnt(5)
    v_mfma_f32_32x32x16_bf16 v[160:175], v[60:63], v[64:67], v[160:175]
    ds_read_b128 v[44:47], v78 offset:5120
    ds_read_b64_tr_b16 v[52:53], v81 offset:0
    ds_read_b64_tr_b16 v[54:55], v81 offset:1024
    s_waitcnt lgkmcnt(6)
    v_mfma_f32_32x32x16_bf16 v[144:159], v[56:59], v[68:71], v[144:159]
    v_mfma_f32_32x32x16_bf16 v[176:191], v[60:63], v[68:71], v[176:191]
    s_waitcnt lgkmcnt(3)
    v_mfma_f32_32x32x16_bf16 v[128:143], v[40:43], v[48:51], v[128:143]
    ds_read_b128 v[56:59], v78 offset:1280
    ds_read_b64_tr_b16 v[64:65], v80 offset:5120
    ds_read_b64_tr_b16 v[66:67], v80 offset:6144
    s_waitcnt lgkmcnt(5)
    v_mfma_f32_32x32x16_bf16 v[160:175], v[44:47], v[48:51], v[160:175]
    ds_read_b128 v[60:63], v78 offset:6400
    ds_read_b64_tr_b16 v[68:69], v81 offset:5120
    ds_read_b64_tr_b16 v[70:71], v81 offset:6144
    s_waitcnt lgkmcnt(6)
    v_mfma_f32_32x32x16_bf16 v[144:159], v[40:43], v[52:55], v[144:159]
    v_mfma_f32_32x32x16_bf16 v[176:191], v[44:47], v[52:55], v[176:191]
    s_waitcnt lgkmcnt(3)
    v_mfma_f32_32x32x16_bf16 v[128:143], v[56:59], v[64:67], v[128:143]
    ds_read_b128 v[40:43], v78 offset:2560
    ds_read_b64_tr_b16 v[48:49], v80 offset:10240
    ds_read_b64_tr_b16 v[50:51], v80 offset:11264
    s_waitcnt lgkmcnt(5)
    v_mfma_f32_32x32x16_bf16 v[160:175], v[60:63], v[64:67], v[160:175]
    ds_read_b128 v[44:47], v78 offset:7680
    ds_read_b64_tr_b16 v[52:53], v81 offset:10240
    ds_read_b64_tr_b16 v[54:55], v81 offset:11264
    s_waitcnt lgkmcnt(6)
    v_mfma_f32_32x32x16_bf16 v[144:159], v[56:59], v[68:71], v[144:159]
    v_mfma_f32_32x32x16_bf16 v[176:191], v[60:63], v[68:71], v[176:191]
    s_waitcnt lgkmcnt(3)
    v_mfma_f32_32x32x16_bf16 v[128:143], v[40:43], v[48:51], v[128:143]
    ds_read_b128 v[56:59], v78 offset:3840
    ds_read_b64_tr_b16 v[64:65], v80 offset:15360
    ds_read_b64_tr_b16 v[66:67], v80 offset:16384
    s_waitcnt lgkmcnt(5)
    v_mfma_f32_32x32x16_bf16 v[160:175], v[44:47], v[48:51], v[160:175]
    ds_read_b128 v[60:63], v78 offset:8960
    ds_read_b64_tr_b16 v[68:69], v81 offset:15360
    ds_read_b64_tr_b16 v[70:71], v81 offset:16384
    s_waitcnt lgkmcnt(6)
    v_mfma_f32_32x32x16_bf16 v[144:159], v[40:43], v[52:55], v[144:159]
    v_mfma_f32_32x32x16_bf16 v[176:191], v[44:47], v[52:55], v[176:191]
    s_waitcnt lgkmcnt(3)
    v_mfma_f32_32x32x16_bf16 v[128:143], v[56:59], v[64:67], v[128:143]
    ds_read_b64 v[40:41], v79 offset:0
    ds_read_b64 v[42:43], v79 offset:1280
    ds_read_b64_tr_b16 v[48:49], v82 offset:0
    s_waitcnt lgkmcnt(5)
    v_mfma_f32_32x32x16_bf16 v[160:175], v[60:63], v[64:67], v[160:175]
    ds_read_b64_tr_b16 v[50:51], v82 offset:5120
    ds_read_b64 v[44:45], v79 offset:5120
    ds_read_b64 v[46:47], v79 offset:6400
    s_waitcnt lgkmcnt(6)
    v_mfma_f32_32x32x16_bf16 v[144:159], v[56:59], v[68:71], v[144:159]
    ds_read_b64_tr_b16 v[52:53], v83 offset:0
    ds_read_b64_tr_b16 v[54:55], v83 offset:5120
    v_mfma_f32_32x32x16_bf16 v[176:191], v[60:63], v[68:71], v[176:191]
    s_barrier
    s_waitcnt lgkmcnt(4)
    v_mfma_f32_32x32x16_bf16 v[128:143], v[40:43], v[48:51], v[128:143]
    ds_read_b128 v[56:59], v78 offset:40960
    ds_read_b64_tr_b16 v[64:65], v80 offset:40960
    ds_read_b64_tr_b16 v[66:67], v80 offset:41984
    s_waitcnt lgkmcnt(5)
    v_mfma_f32_32x32x16_bf16 v[160:175], v[44:47], v[48:51], v[160:175]
    ds_read_b128 v[60:63], v78 offset:46080
    ds_read_b64_tr_b16 v[68:69], v81 offset:40960
    ds_read_b64_tr_b16 v[70:71], v81 offset:41984
    s_waitcnt lgkmcnt(6)
    v_mfma_f32_32x32x16_bf16 v[144:159], v[40:43], v[52:55], v[144:159]
    v_mfma_f32_32x32x16_bf16 v[176:191], v[44:47], v[52:55], v[176:191]
    s_waitcnt lgkmcnt(3)
    v_mfma_f32_32x32x16_bf16 v[128:143], v[56:59], v[64:67], v[128:143]
    ds_read_b128 v[40:43], v78 offset:42240
    ds_read_b64_tr_b16 v[48:49], v80 offset:46080
    ds_read_b64_tr_b16 v[50:51], v80 offset:47104
    s_waitcnt lgkmcnt(5)
    v_mfma_f32_32x32x16_bf16 v[160:175], v[60:63], v[64:67], v[160:175]
    ds_read_b128 v[44:47], v78 offset:47360
    ds_read_b64_tr_b16 v[52:53], v81 offset:46080
    ds_read_b64_tr_b16 v[54:55], v81 offset:47104
    s_waitcnt lgkmcnt(6)
    v_mfma_f32_32x32x16_bf16 v[144:159], v[56:59], v[68:71], v[144:159]
    v_mfma_f32_32x32x16_bf16 v[176:191], v[60:63], v[68:71], v[176:191]
    s_waitcnt lgkmcnt(3)
    v_mfma_f32_32x32x16_bf16 v[128:143], v[40:43], v[48:51], v[128:143]
    ds_read_b128 v[56:59], v78 offset:43520
    ds_read_b64_tr_b16 v[64:65], v80 offset:51200
    ds_read_b64_tr_b16 v[66:67], v80 offset:52224
    s_waitcnt lgkmcnt(5)
    v_mfma_f32_32x32x16_bf16 v[160:175], v[44:47], v[48:51], v[160:175]
    ds_read_b128 v[60:63], v78 offset:48640
    ds_read_b64_tr_b16 v[68:69], v81 offset:51200
    ds_read_b64_tr_b16 v[70:71], v81 offset:52224
    s_waitcnt lgkmcnt(6)
    v_mfma_f32_32x32x16_bf16 v[144:159], v[40:43], v[52:55], v[144:159]
    v_mfma_f32_32x32x16_bf16 v[176:191], v[44:47], v[52:55], v[176:191]
    s_waitcnt lgkmcnt(3)
    v_mfma_f32_32x32x16_bf16 v[128:143], v[56:59], v[64:67], v[128:143]
    ds_read_b128 v[40:43], v78 offset:44800
    ds_read_b64_tr_b16 v[48:49], v80 offset:56320
    ds_read_b64_tr_b16 v[50:51], v80 offset:57344
    s_waitcnt lgkmcnt(5)
    v_mfma_f32_32x32x16_bf16 v[160:175], v[60:63], v[64:67], v[160:175]
    ds_read_b128 v[44:47], v78 offset:49920
    ds_read_b64_tr_b16 v[52:53], v81 offset:56320
    ds_read_b64_tr_b16 v[54:55], v81 offset:57344
    s_waitcnt lgkmcnt(6)
    v_mfma_f32_32x32x16_bf16 v[144:159], v[56:59], v[68:71], v[144:159]
    v_mfma_f32_32x32x16_bf16 v[176:191], v[60:63], v[68:71], v[176:191]
    s_waitcnt lgkmcnt(3)
    v_mfma_f32_32x32x16_bf16 v[128:143], v[40:43], v[48:51], v[128:143]
    ds_read_b64 v[56:57], v79 offset:40960
    ds_read_b64 v[58:59], v79 offset:42240
    ds_read_b64_tr_b16 v[64:65], v82 offset:40960
    s_waitcnt lgkmcnt(5)
    v_mfma_f32_32x32x16_bf16 v[160:175], v[44:47], v[48:51], v[160:175]
    ds_read_b64_tr_b16 v[66:67], v82 offset:46080
    ds_read_b64 v[60:61], v79 offset:46080
    ds_read_b64 v[62:63], v79 offset:47360
    s_waitcnt lgkmcnt(6)
    v_mfma_f32_32x32x16_bf16 v[144:159], v[40:43], v[52:55], v[144:159]
    ds_read_b64_tr_b16 v[68:69], v83 offset:40960
    ds_read_b64_tr_b16 v[70:71], v83 offset:46080
    v_mfma_f32_32x32x16_bf16 v[176:191], v[44:47], v[52:55], v[176:191]
    s_barrier
    s_waitcnt lgkmcnt(4)
    v_mfma_f32_32x32x16_bf16 v[128:143], v[56:59], v[64:67], v[128:143]
    ds_read_b128 v[40:43], v72 offset:0
    ds_read_b64_tr_b16 v[48:49], v74 offset:0
    ds_read_b64_tr_b16 v[50:51], v74 offset:1024
    s_waitcnt lgkmcnt(5)
    v_mfma_f32_32x32x16_bf16 v[160:175], v[60:63], v[64:67], v[160:175]
    ds_read_b128 v[44:47], v72 offset:5120
    ds_read_b64_tr_b16 v[52:53], v75 offset:0
    ds_read_b64_tr_b16 v[54:55], v75 offset:1024
    s_waitcnt lgkmcnt(6)
    v_mfma_f32_32x32x16_bf16 v[144:159], v[56:59], v[68:71], v[144:159]
    v_mfma_f32_32x32x16_bf16 v[176:191], v[60:63], v[68:71], v[176:191]
    s_waitcnt lgkmcnt(3)
    v_mfma_f32_32x32x16_bf16 v[128:143], v[40:43], v[48:51], v[128:143]
    ds_read_b128 v[56:59], v72 offset:1280
    ds_read_b64_tr_b16 v[64:65], v74 offset:5120
    ds_read_b64_tr_b16 v[66:67], v74 offset:6144
    s_waitcnt lgkmcnt(5)
    v_mfma_f32_32x32x16_bf16 v[160:175], v[44:47], v[48:51], v[160:175]
    ds_read_b128 v[60:63], v72 offset:6400
    ds_read_b64_tr_b16 v[68:69], v75 offset:5120
    ds_read_b64_tr_b16 v[70:71], v75 offset:6144
    s_waitcnt lgkmcnt(6)
    v_mfma_f32_32x32x16_bf16 v[144:159], v[40:43], v[52:55], v[144:159]
    v_mfma_f32_32x32x16_bf16 v[176:191], v[44:47], v[52:55], v[176:191]
    s_waitcnt lgkmcnt(3)
    v_mfma_f32_32x32x16_bf16 v[128:143], v[56:59], v[64:67], v[128:143]
    ds_read_b128 v[40:43], v72 offset:2560
    ds_read_b64_tr_b16 v[48:49], v74 offset:10240
    ds_read_b64_tr_b16 v[50:51], v74 offset:11264
    s_waitcnt lgkmcnt(5)
    v_mfma_f32_32x32x16_bf16 v[160:175], v[60:63], v[64:67], v[160:175]
    ds_read_b128 v[44:47], v72 offset:7680
    ds_read_b64_tr_b16 v[52:53], v75 offset:10240
    ds_read_b64_tr_b16 v[54:55], v75 offset:11264
    s_waitcnt lgkmcnt(6)
    v_mfma_f32_32x32x16_bf16 v[144:159], v[56:59], v[68:71], v[144:159]
    v_mfma_f32_32x32x16_bf16 v[176:191], v[60:63], v[68:71], v[176:191]
    s_waitcnt lgkmcnt(3)
    v_mfma_f32_32x32x16_bf16 v[128:143], v[40:43], v[48:51], v[128:143]
    ds_read_b128 v[56:59], v72 offset:3840
    ds_read_b64_tr_b16 v[64:65], v74 offset:15360
    ds_read_b64_tr_b16 v[66:67], v74 offset:16384
    s_waitcnt lgkmcnt(5)
    v_mfma_f32_32x32x16_bf16 v[160:175], v[44:47], v[48:51], v[160:175]
    ds_read_b128 v[60:63], v72 offset:8960
    ds_read_b64_tr_b16 v[68:69], v75 offset:15360
    ds_read_b64_tr_b16 v[70:71], v75 offset:16384
    s_waitcnt lgkmcnt(6)
    v_mfma_f32_32x32x16_bf16 v[144:159], v[40:43], v[52:55], v[144:159]
    v_mfma_f32_32x32x16_bf16 v[176:191], v[44:47], v[52:55], v[176:191]
    s_waitcnt lgkmcnt(3)
    v_mfma_f32_32x32x16_bf16 v[128:143], v[56:59], v[64:67], v[128:143]
    ds_read_b64 v[40:41], v73 offset:0
    ds_read_b64 v[42:43], v73 offset:1280
    ds_read_b64_tr_b16 v[48:49], v76 offset:0
    s_waitcnt lgkmcnt(5)
    v_mfma_f32_32x32x16_bf16 v[160:175], v[60:63], v[64:67], v[160:175]
    ds_read_b64_tr_b16 v[50:51], v76 offset:5120
    ds_read_b64 v[44:45], v73 offset:5120
    ds_read_b64 v[46:47], v73 offset:6400
    s_waitcnt lgkmcnt(6)
    v_mfma_f32_32x32x16_bf16 v[144:159], v[56:59], v[68:71], v[144:159]
    ds_read_b64_tr_b16 v[52:53], v77 offset:0
    ds_read_b64_tr_b16 v[54:55], v77 offset:5120
    v_mfma_f32_32x32x16_bf16 v[176:191], v[60:63], v[68:71], v[176:191]
    s_barrier
    s_waitcnt lgkmcnt(4)
    v_mfma_f32_32x32x16_bf16 v[128:143], v[40:43], v[48:51], v[128:143]
    ds_read_b128 v[56:59], v72 offset:40960
    ds_read_b64_tr_b16 v[64:65], v74 offset:40960
    ds_read_b64_tr_b16 v[66:67], v74 offset:41984
    s_waitcnt lgkmcnt(5)
    v_mfma_f32_32x32x16_bf16 v[160:175], v[44:47], v[48:51], v[160:175]
    ds_read_b128 v[60:63], v72 offset:46080
    ds_read_b64_tr_b16 v[68:69], v75 offset:40960
    ds_read_b64_tr_b16 v[70:71], v75 offset:41984
    s_waitcnt lgkmcnt(6)
    v_mfma_f32_32x32x16_bf16 v[144:159], v[40:43], v[52:55], v[144:159]
    v_mfma_f32_32x32x16_bf16 v[176:191], v[44:47], v[52:55], v[176:191]
    s_waitcnt lgkmcnt(3)
    v_mfma_f32_32x32x16_bf16 v[128:143], v[56:59], v[64:67], v[128:143]
    ds_read_b128 v[40:43], v72 offset:42240
    ds_read_b64_tr_b16 v[48:49], v74 offset:46080
    ds_read_b64_tr_b16 v[50:51], v74 offset:47104
    s_waitcnt lgkmcnt(5)
    v_mfma_f32_32x32x16_bf16 v[160:175], v[60:63], v[64:67], v[160:175]
    ds_read_b128 v[44:47], v72 offset:47360
    ds_read_b64_tr_b16 v[52:53], v75 offset:46080
    ds_read_b64_tr_b16 v[54:55], v75 offset:47104
    s_waitcnt lgkmcnt(6)
    v_mfma_f32_32x32x16_bf16 v[144:159], v[56:59], v[68:71], v[144:159]
    v_mfma_f32_32x32x16_bf16 v[176:191], v[60:63], v[68:71], v[176:191]
    s_waitcnt lgkmcnt(3)
    v_mfma_f32_32x32x16_bf16 v[128:143], v[40:43], v[48:51], v[128:143]
    ds_read_b128 v[56:59], v72 offset:43520
    ds_read_b64_tr_b16 v[64:65], v74 offset:51200
    ds_read_b64_tr_b16 v[66:67], v74 offset:52224
    s_waitcnt lgkmcnt(5)
    v_mfma_f32_32x32x16_bf16 v[160:175], v[44:47], v[48:51], v[160:175]
    ds_read_b128 v[60:63], v72 offset:48640
    ds_read_b64_tr_b16 v[68:69], v75 offset:51200
    ds_read_b64_tr_b16 v[70:71], v75 offset:52224
    s_waitcnt lgkmcnt(6)
    v_mfma_f32_32x32x16_bf16 v[144:159], v[40:43], v[52:55], v[144:159]
    v_mfma_f32_32x32x16_bf16 v[176:191], v[44:47], v[52:55], v[176:191]
    s_waitcnt lgkmcnt(3)
    v_mfma_f32_32x32x16_bf16 v[128:143], v[56:59], v[64:67], v[128:143]
    ds_read_b128 v[40:43], v72 offset:44800
    ds_read_b64_tr_b16 v[48:49], v74 offset:56320
    ds_read_b64_tr_b16 v[50:51], v74 offset:57344
    s_waitcnt lgkmcnt(5)
    v_mfma_f32_32x32x16_bf16 v[160:175], v[60:63], v[64:67], v[160:175]
    ds_read_b128 v[44:47], v72 offset:49920
    ds_read_b64_tr_b16 v[52:53], v75 offset:56320
    ds_read_b64_tr_b16 v[54:55], v75 offset:57344
    s_waitcnt lgkmcnt(6)
    v_mfma_f32_32x32x16_bf16 v[144:159], v[56:59], v[68:71], v[144:159]
    v_mfma_f32_32x32x16_bf16 v[176:191], v[60:63], v[68:71], v[176:191]
    s_waitcnt lgkmcnt(3)
    v_mfma_f32_32x32x16_bf16 v[128:143], v[40:43], v[48:51], v[128:143]
    ds_read_b64 v[56:57], v73 offset:40960
    ds_read_b64 v[58:59], v73 offset:42240
    ds_read_b64_tr_b16 v[64:65], v76 offset:40960
    s_waitcnt lgkmcnt(5)
    v_mfma_f32_32x32x16_bf16 v[160:175], v[44:47], v[48:51], v[160:175]
    ds_read_b64_tr_b16 v[66:67], v76 offset:46080
    ds_read_b64 v[60:61], v73 offset:46080
    ds_read_b64 v[62:63], v73 offset:47360
    s_waitcnt lgkmcnt(6)
    v_mfma_f32_32x32x16_bf16 v[144:159], v[40:43], v[52:55], v[144:159]
    ds_read_b64_tr_b16 v[68:69], v77 offset:40960
    ds_read_b64_tr_b16 v[70:71], v77 offset:46080
    v_mfma_f32_32x32x16_bf16 v[176:191], v[44:47], v[52:55], v[176:191]
    s_barrier
    s_waitcnt lgkmcnt(4)
    v_mfma_f32_32x32x16_bf16 v[128:143], v[56:59], v[64:67], v[128:143]
    ds_read_b128 v[40:43], v78 offset:0
    ds_read_b64_tr_b16 v[48:49], v80 offset:0
    ds_read_b64_tr_b16 v[50:51], v80 offset:1024
    s_waitcnt lgkmcnt(5)
    v_mfma_f32_32x32x16_bf16 v[160:175], v[60:63], v[64:67], v[160:175]
    ds_read_b128 v[44:47], v78 offset:5120
    ds_read_b64_tr_b16 v[52:53], v81 offset:0
    ds_read_b64_tr_b16 v[54:55], v81 offset:1024
    s_waitcnt lgkmcnt(6)
    v_mfma_f32_32x32x16_bf16 v[144:159], v[56:59], v[68:71], v[144:159]
    v_mfma_f32_32x32x16_bf16 v[176:191], v[60:63], v[68:71], v[176:191]
    s_waitcnt lgkmcnt(3)
    v_mfma_f32_32x32x16_bf16 v[128:143], v[40:43], v[48:51], v[128:143]
    ds_read_b128 v[56:59], v78 offset:1280
    ds_read_b64_tr_b16 v[64:65], v80 offset:5120
    ds_read_b64_tr_b16 v[66:67], v80 offset:6144
    s_waitcnt lgkmcnt(5)
    v_mfma_f32_32x32x16_bf16 v[160:175], v[44:47], v[48:51], v[160:175]
    ds_read_b128 v[60:63], v78 offset:6400
    ds_read_b64_tr_b16 v[68:69], v81 offset:5120
    ds_read_b64_tr_b16 v[70:71], v81 offset:6144
    s_waitcnt lgkmcnt(6)
    v_mfma_f32_32x32x16_bf16 v[144:159], v[40:43], v[52:55], v[144:159]
    v_mfma_f32_32x32x16_bf16 v[176:191], v[44:47], v[52:55], v[176:191]
    s_waitcnt lgkmcnt(3)
    v_mfma_f32_32x32x16_bf16 v[128:143], v[56:59], v[64:67], v[128:143]
    ds_read_b128 v[40:43], v78 offset:2560
    ds_read_b64_tr_b16 v[48:49], v80 offset:10240
    ds_read_b64_tr_b16 v[50:51], v80 offset:11264
    s_waitcnt lgkmcnt(5)
    v_mfma_f32_32x32x16_bf16 v[160:175], v[60:63], v[64:67], v[160:175]
    ds_read_b128 v[44:47], v78 offset:7680
    ds_read_b64_tr_b16 v[52:53], v81 offset:10240
    ds_read_b64_tr_b16 v[54:55], v81 offset:11264
    s_waitcnt lgkmcnt(6)
    v_mfma_f32_32x32x16_bf16 v[144:159], v[56:59], v[68:71], v[144:159]
    v_mfma_f32_32x32x16_bf16 v[176:191], v[60:63], v[68:71], v[176:191]
    s_waitcnt lgkmcnt(3)
    v_mfma_f32_32x32x16_bf16 v[128:143], v[40:43], v[48:51], v[128:143]
    ds_read_b128 v[56:59], v78 offset:3840
    ds_read_b64_tr_b16 v[64:65], v80 offset:15360
    ds_read_b64_tr_b16 v[66:67], v80 offset:16384
    s_waitcnt lgkmcnt(5)
    v_mfma_f32_32x32x16_bf16 v[160:175], v[44:47], v[48:51], v[160:175]
    ds_read_b128 v[60:63], v78 offset:8960
    ds_read_b64_tr_b16 v[68:69], v81 offset:15360
    ds_read_b64_tr_b16 v[70:71], v81 offset:16384
    s_waitcnt lgkmcnt(6)
    v_mfma_f32_32x32x16_bf16 v[144:159], v[40:43], v[52:55], v[144:159]
    v_mfma_f32_32x32x16_bf16 v[176:191], v[44:47], v[52:55], v[176:191]
    s_waitcnt lgkmcnt(3)
    v_mfma_f32_32x32x16_bf16 v[128:143], v[56:59], v[64:67], v[128:143]
    ds_read_b64 v[40:41], v79 offset:0
    ds_read_b64 v[42:43], v79 offset:1280
    ds_read_b64_tr_b16 v[48:49], v82 offset:0
    s_waitcnt lgkmcnt(5)
    v_mfma_f32_32x32x16_bf16 v[160:175], v[60:63], v[64:67], v[160:175]
    ds_read_b64_tr_b16 v[50:51], v82 offset:5120
    ds_read_b64 v[44:45], v79 offset:5120
    ds_read_b64 v[46:47], v79 offset:6400
    s_waitcnt lgkmcnt(6)
    v_mfma_f32_32x32x16_bf16 v[144:159], v[56:59], v[68:71], v[144:159]
    ds_read_b64_tr_b16 v[52:53], v83 offset:0
    ds_read_b64_tr_b16 v[54:55], v83 offset:5120
    v_mfma_f32_32x32x16_bf16 v[176:191], v[60:63], v[68:71], v[176:191]
    s_barrier
    s_waitcnt lgkmcnt(4)
    v_mfma_f32_32x32x16_bf16 v[128:143], v[40:43], v[48:51], v[128:143]
    ds_read_b128 v[192:195], v78 offset:40960
    ds_read_b64_tr_b16 v[232:233], v80 offset:40960
    ds_read_b64_tr_b16 v[234:235], v80 offset:41984
    s_waitcnt lgkmcnt(5)
    v_mfma_f32_32x32x16_bf16 v[160:175], v[44:47], v[48:51], v[160:175]
    ds_read_b128 v[196:199], v78 offset:42240
    ds_read_b64_tr_b16 v[236:237], v80 offset:46080
    ds_read_b64_tr_b16 v[238:239], v80 offset:47104
    s_waitcnt lgkmcnt(6)
    v_mfma_f32_32x32x16_bf16 v[144:159], v[40:43], v[52:55], v[144:159]
    v_mfma_f32_32x32x16_bf16 v[176:191], v[44:47], v[52:55], v[176:191]
    s_waitcnt lgkmcnt(3)
    v_mfma_f32_32x32x16_bf16 v[128:143], v[192:195], v[232:235], v[128:143]
    ds_read_b128 v[200:203], v78 offset:43520
    ds_read_b64_tr_b16 v[240:241], v80 offset:51200
    ds_read_b64_tr_b16 v[242:243], v80 offset:52224
    s_waitcnt lgkmcnt(3)
    v_mfma_f32_32x32x16_bf16 v[128:143], v[196:199], v[236:239], v[128:143]
    ds_read_b128 v[204:207], v78 offset:44800
    ds_read_b64_tr_b16 v[244:245], v80 offset:56320
    ds_read_b64_tr_b16 v[246:247], v80 offset:57344
    s_waitcnt lgkmcnt(3)
    v_mfma_f32_32x32x16_bf16 v[128:143], v[200:203], v[240:243], v[128:143]
    ds_read_b64 v[208:209], v79 offset:40960
    ds_read_b64 v[210:211], v79 offset:42240
    ds_read_b64_tr_b16 v[248:249], v82 offset:40960
    ds_read_b64_tr_b16 v[250:251], v82 offset:46080
    s_waitcnt lgkmcnt(4)
    v_mfma_f32_32x32x16_bf16 v[128:143], v[204:207], v[244:247], v[128:143]
    ds_read_b128 v[212:215], v78 offset:46080
    s_waitcnt lgkmcnt(1)
    v_mfma_f32_32x32x16_bf16 v[128:143], v[208:211], v[248:251], v[128:143]
    ds_read_b128 v[216:219], v78 offset:47360
    s_waitcnt lgkmcnt(1)
    v_mfma_f32_32x32x16_bf16 v[160:175], v[212:215], v[232:235], v[160:175]
    ds_read_b128 v[220:223], v78 offset:48640
    s_waitcnt lgkmcnt(1)
    v_mfma_f32_32x32x16_bf16 v[160:175], v[216:219], v[236:239], v[160:175]
    ds_read_b128 v[224:227], v78 offset:49920
    s_waitcnt lgkmcnt(1)
    v_mfma_f32_32x32x16_bf16 v[160:175], v[220:223], v[240:243], v[160:175]
    ds_read_b64 v[228:229], v79 offset:46080
    ds_read_b64 v[230:231], v79 offset:47360
    s_waitcnt lgkmcnt(2)
    v_mfma_f32_32x32x16_bf16 v[160:175], v[224:227], v[244:247], v[160:175]
    ds_read_b64_tr_b16 v[84:85], v81 offset:40960
    ds_read_b64_tr_b16 v[86:87], v81 offset:41984
    s_waitcnt lgkmcnt(2)
    v_mfma_f32_32x32x16_bf16 v[160:175], v[228:231], v[248:251], v[160:175]
    ds_read_b64_tr_b16 v[88:89], v81 offset:46080
    ds_read_b64_tr_b16 v[90:91], v81 offset:47104
    s_mov_b32 s30, 0
    buffer_store_dword v128, v16, s[20:23], s30 offen sc0 sc1
    s_mov_b32 s30, 5120
    buffer_store_dword v129, v16, s[20:23], s30 offen sc0 sc1
    s_waitcnt lgkmcnt(2)
    v_mfma_f32_32x32x16_bf16 v[144:159], v[192:195], v[84:87], v[144:159]
    ds_read_b64_tr_b16 v[92:93], v81 offset:51200
    ds_read_b64_tr_b16 v[94:95], v81 offset:52224
    s_mov_b32 s30, 10240
    buffer_store_dword v130, v16, s[20:23], s30 offen sc0 sc1
    s_mov_b32 s30, 15360
    buffer_store_dword v131, v16, s[20:23], s30 offen sc0 sc1
    s_waitcnt lgkmcnt(2)
    v_mfma_f32_32x32x16_bf16 v[144:159], v[196:199], v[88:91], v[144:159]
    ds_read_b64_tr_b16 v[96:97], v81 offset:56320
    ds_read_b64_tr_b16 v[98:99], v81 offset:57344
    s_mov_b32 s30, 40960
    buffer_store_dword v132, v16, s[20:23], s30 offen sc0 sc1
    s_mov_b32 s30, 46080
    buffer_store_dword v133, v16, s[20:23], s30 offen sc0 sc1
    s_waitcnt lgkmcnt(2)
    v_mfma_f32_32x32x16_bf16 v[144:159], v[200:203], v[92:95], v[144:159]
    ds_read_b64_tr_b16 v[100:101], v83 offset:40960
    ds_read_b64_tr_b16 v[102:103], v83 offset:46080
    s_mov_b32 s30, 51200
    buffer_store_dword v134, v16, s[20:23], s30 offen sc0 sc1
    s_mov_b32 s30, 56320
    buffer_store_dword v135, v16, s[20:23], s30 offen sc0 sc1
    s_waitcnt lgkmcnt(2)
    v_mfma_f32_32x32x16_bf16 v[144:159], v[204:207], v[96:99], v[144:159]
    s_mov_b32 s30, 81920
    buffer_store_dword v136, v16, s[20:23], s30 offen sc0 sc1
    s_mov_b32 s30, 87040
    buffer_store_dword v137, v16, s[20:23], s30 offen sc0 sc1
    s_waitcnt lgkmcnt(0)
    v_mfma_f32_32x32x16_bf16 v[144:159], v[208:211], v[100:103], v[144:159]
    s_mov_b32 s30, 92160
    buffer_store_dword v138, v16, s[20:23], s30 offen sc0 sc1
    s_mov_b32 s30, 97280
    buffer_store_dword v139, v16, s[20:23], s30 offen sc0 sc1
    v_mfma_f32_32x32x16_bf16 v[176:191], v[212:215], v[84:87], v[176:191]
    s_mov_b32 s30, 122880
    buffer_store_dword v140, v16, s[20:23], s30 offen sc0 sc1
    s_mov_b32 s30, 128000
    buffer_store_dword v141, v16, s[20:23], s30 offen sc0 sc1
    v_mfma_f32_32x32x16_bf16 v[176:191], v[216:219], v[88:91], v[176:191]
    s_mov_b32 s30, 133120
    buffer_store_dword v142, v16, s[20:23], s30 offen sc0 sc1
    s_mov_b32 s30, 138240
    buffer_store_dword v143, v16, s[20:23], s30 offen sc0 sc1
    v_mfma_f32_32x32x16_bf16 v[176:191], v[220:223], v[92:95], v[176:191]
    s_mov_b32 s30, 163840
    buffer_store_dword v160, v16, s[20:23], s30 offen sc0 sc1
    s_mov_b32 s30, 168960
    buffer_store_dword v161, v16, s[20:23], s30 offen sc0 sc1
    v_mfma_f32_32x32x16_bf16 v[176:191], v[224:227], v[96:99], v[176:191]
    s_mov_b32 s30, 174080
    buffer_store_dword v162, v16, s[20:23], s30 offen sc0 sc1
    s_mov_b32 s30, 179200
    buffer_store_dword v163, v16, s[20:23], s30 offen sc0 sc1
    v_mfma_f32_32x32x16_bf16 v[176:191], v[228:231], v[100:103], v[176:191]
    s_mov_b32 s30, 204800
    buffer_store_dword v164, v16, s[20:23], s30 offen sc0 sc1
    s_mov_b32 s30, 209920
    buffer_store_dword v165, v16, s[20:23], s30 offen sc0 sc1
    s_mov_b32 s30, 215040
    buffer_store_dword v166, v16, s[20:23], s30 offen sc0 sc1
    s_mov_b32 s30, 220160
    buffer_store_dword v167, v16, s[20:23], s30 offen sc0 sc1
    s_mov_b32 s30, 245760
    buffer_store_dword v168, v16, s[20:23], s30 offen sc0 sc1
    s_mov_b32 s30, 250880
    buffer_store_dword v169, v16, s[20:23], s30 offen sc0 sc1
    s_mov_b32 s30, 256000
    buffer_store_dword v170, v16, s[20:23], s30 offen sc0 sc1
    s_mov_b32 s30, 261120
    buffer_store_dword v171, v16, s[20:23], s30 offen sc0 sc1
    s_mov_b32 s30, 286720
    buffer_store_dword v172, v16, s[20:23], s30 offen sc0 sc1
    s_mov_b32 s30, 291840
    buffer_store_dword v173, v16, s[20:23], s30 offen sc0 sc1
    s_mov_b32 s30, 296960
    buffer_store_dword v174, v16, s[20:23], s30 offen sc0 sc1
    s_mov_b32 s30, 302080
    buffer_store_dword v175, v16, s[20:23], s30 offen sc0 sc1
    s_mov_b32 s30, 0
    buffer_store_dword v144, v17, s[20:23], s30 offen sc0 sc1
    s_mov_b32 s30, 5120
    buffer_store_dword v145, v17, s[20:23], s30 offen sc0 sc1
    s_mov_b32 s30, 10240
    buffer_store_dword v146, v17, s[20:23], s30 offen sc0 sc1
    s_mov_b32 s30, 15360
    buffer_store_dword v147, v17, s[20:23], s30 offen sc0 sc1
    s_mov_b32 s30, 40960
    buffer_store_dword v148, v17, s[20:23], s30 offen sc0 sc1
    s_mov_b32 s30, 46080
    buffer_store_dword v149, v17, s[20:23], s30 offen sc0 sc1
    s_mov_b32 s30, 51200
    buffer_store_dword v150, v17, s[20:23], s30 offen sc0 sc1
    s_mov_b32 s30, 56320
    buffer_store_dword v151, v17, s[20:23], s30 offen sc0 sc1
    s_mov_b32 s30, 81920
    buffer_store_dword v152, v17, s[20:23], s30 offen sc0 sc1
    s_mov_b32 s30, 87040
    buffer_store_dword v153, v17, s[20:23], s30 offen sc0 sc1
    s_mov_b32 s30, 92160
    buffer_store_dword v154, v17, s[20:23], s30 offen sc0 sc1
    s_mov_b32 s30, 97280
    buffer_store_dword v155, v17, s[20:23], s30 offen sc0 sc1
    s_mov_b32 s30, 122880
    buffer_store_dword v156, v17, s[20:23], s30 offen sc0 sc1
    s_mov_b32 s30, 128000
    buffer_store_dword v157, v17, s[20:23], s30 offen sc0 sc1
    s_mov_b32 s30, 133120
    buffer_store_dword v158, v17, s[20:23], s30 offen sc0 sc1
    s_mov_b32 s30, 138240
    buffer_store_dword v159, v17, s[20:23], s30 offen sc0 sc1
    s_mov_b32 s30, 163840
    buffer_store_dword v176, v17, s[20:23], s30 offen sc0 sc1
    s_mov_b32 s30, 168960
    buffer_store_dword v177, v17, s[20:23], s30 offen sc0 sc1
    s_mov_b32 s30, 174080
    buffer_store_dword v178, v17, s[20:23], s30 offen sc0 sc1
    s_mov_b32 s30, 179200
    buffer_store_dword v179, v17, s[20:23], s30 offen sc0 sc1
    s_mov_b32 s30, 204800
    buffer_store_dword v180, v17, s[20:23], s30 offen sc0 sc1
    s_mov_b32 s30, 209920
    buffer_store_dword v181, v17, s[20:23], s30 offen sc0 sc1
    s_mov_b32 s30, 215040
    buffer_store_dword v182, v17, s[20:23], s30 offen sc0 sc1
    s_mov_b32 s30, 220160
    buffer_store_dword v183, v17, s[20:23], s30 offen sc0 sc1
    s_mov_b32 s30, 245760
    buffer_store_dword v184, v17, s[20:23], s30 offen sc0 sc1
    s_mov_b32 s30, 250880
    buffer_store_dword v185, v17, s[20:23], s30 offen sc0 sc1
    s_mov_b32 s30, 256000
    buffer_store_dword v186, v17, s[20:23], s30 offen sc0 sc1
    s_mov_b32 s30, 261120
    buffer_store_dword v187, v17, s[20:23], s30 offen sc0 sc1
    s_mov_b32 s30, 286720
    buffer_store_dword v188, v17, s[20:23], s30 offen sc0 sc1
    s_mov_b32 s30, 291840
    buffer_store_dword v189, v17, s[20:23], s30 offen sc0 sc1
    s_mov_b32 s30, 296960
    buffer_store_dword v190, v17, s[20:23], s30 offen sc0 sc1
    s_mov_b32 s30, 302080
    buffer_store_dword v191, v17, s[20:23], s30 offen sc0 sc1
    s_endpgm
L_att_slow:
    s_waitcnt lgkmcnt(0)
    s_mov_b32 s60, s8
    s_and_b32 s61, s9, 0xffff
    s_mov_b32 s62, 7864320
    s_mov_b32 s63, 0x00020000
    s_mul_i32 s64, s29, 2560
    s_add_u32 s64, s64, 102400
    s_sub_u32 s30, s64, 163840
    v_add_u32 v116, s30, v104
    v_add_u32 v117, s30, v105
    v_add_u32 v118, s30, v106
    v_subrev_u32 v118, 8960, v118
    v_lshlrev_b32 v123, 4, v2
    v_mov_b32 v120, 0xff800000
    v_mov_b32 v48, 0
    v_mov_b32 v49, 0
    v_mov_b32 v50, 0
    v_mov_b32 v51, 0
    v_mov_b32 v52, 0
    v_mov_b32 v53, 0
    v_mov_b32 v54, 0
    v_mov_b32 v55, 0
    v_mov_b32 v56, 0
    v_mov_b32 v57, 0
    v_mov_b32 v58, 0
    v_mov_b32 v59, 0
    v_mov_b32 v60, 0
    v_mov_b32 v61, 0
    v_mov_b32 v62, 0
    v_mov_b32 v63, 0
    s_mul_i32 s30, s39, 81920
    s_add_u32 s30, s30, 2621440
    s_mov_b32 s31, 0
L_att_slow0:
    s_add_u32 m0, s64, 0
    s_add_u32 s32, s30, 0
    buffer_load_dwordx4 v123, s[60:63], s32 offen sc1 lds
    s_mov_b64 exec, 0xffff
    buffer_load_dwordx4 v123, s[60:63], s32 offen offset:1024 sc1 lds
    s_mov_b64 exec, -1
    s_waitcnt vmcnt(0)
    ds_read_b64_tr_b16 v[86:87], v117
    ds_read_b64_tr_b16 v[88:89], v116
    ds_read_b64_tr_b16 v[90:91], v116 offset:128
    s_waitcnt lgkmcnt(0)
    v_mfma_f32_32x32x8_bf16 v[16:31], v[86:87], v[84:85], 0
    v_mfma_f32_32x32x16_bf16 v[16:31], v[88:91], v[80:83], v[16:31]
    s_nop 11
    v_max3_f32 v121, v16, v17, v18
    v_max3_f32 v121, v121, v19, v20
    v_max3_f32 v121, v121, v21, v22
    v_max3_f32 v121, v121, v23, v24
    v_max3_f32 v121, v121, v25, v26
    v_max3_f32 v121, v121, v27, v28
    v_max3_f32 v121, v121, v29, v30
    v_max_f32 v121, v121, v31
    v_mov_b32 v119, v121
    s_nop 1
    v_permlane32_swap_b32 v119, v121
    s_nop 1
    v_max_f32 v121, v121, v119
    v_max_f32 v120, v120, v121
    s_add_u32 s30, s30, 1280
    s_add_u32 s31, s31, 1
    s_cmp_lt_u32 s31, 64
    s_cbranch_scc1 L_att_slow0
    s_nop 7
    v_sub_f32 v64, 0, v120
    v_sub_f32 v65, 0, v120
    v_sub_f32 v66, 0, v120
    v_sub_f32 v67, 0, v120
    v_sub_f32 v68, 0, v120
    v_sub_f32 v69, 0, v120
    v_sub_f32 v70, 0, v120
    v_sub_f32 v71, 0, v120
    v_sub_f32 v72, 0, v120
    v_sub_f32 v73, 0, v120
    v_sub_f32 v74, 0, v120
    v_sub_f32 v75, 0, v120
    v_sub_f32 v76, 0, v120
    v_sub_f32 v77, 0, v120
    v_sub_f32 v78, 0, v120
    v_sub_f32 v79, 0, v120
    s_mul_i32 s30, s39, 81920
    s_add_u32 s30, s30, 2621440
    s_mov_b32 s31, 0
L_att_slow1:
    s_add_u32 m0, s64, 0
    s_add_u32 s32, s30, 0
    buffer_load_dwordx4 v123, s[60:63], s32 offen sc1 lds
    s_mov_b64 exec, 0xffff
    buffer_load_dwordx4 v123, s[60:63], s32 offen offset:1024 sc1 lds
    s_mov_b64 exec, -1
    s_add_u32 m0, s64, 1280
    s_add_u32 s32, s30, 2621440
    buffer_load_dwordx4 v123, s[60:63], s32 offen sc1 lds
    s_mov_b64 exec, 0xffff
    buffer_load_dwordx4 v123, s[60:63], s32 offen offset:1024 sc1 lds
    s_mov_b64 exec, -1
    s_waitcnt vmcnt(0)
    ds_read_b64_tr_b16 v[86:87], v117
    ds_read_b64_tr_b16 v[88:89], v116
    ds_read_b64_tr_b16 v[90:91], v116 offset:128
    s_mov_b64 exec, s[40:41]
    ds_read_b128 v[92:95], v118
    ds_read_b128 v[96:99], v118 offset:640
    s_mov_b64 exec, -1
    s_waitcnt lgkmcnt(0)
    v_mfma_f32_32x32x8_bf16 v[16:31], v[86:87], v[84:85], v[64:79]
    v_mfma_f32_32x32x16_bf16 v[16:31], v[88:91], v[80:83], v[16:31]
    s_nop 11
    v_exp_f32 v16, v16
    v_exp_f32 v17, v17
    v_exp_f32 v18, v18
    v_exp_f32 v19, v19
    v_exp_f32 v20, v20
    v_exp_f32 v21, v21
    v_exp_f32 v22, v22
    v_exp_f32 v23, v23
    v_exp_f32 v24, v24
    v_exp_f32 v25, v25
    v_exp_f32 v26, v26
    v_exp_f32 v27, v27
    v_exp_f32 v28, v28
    v_exp_f32 v29, v29
    v_exp_f32 v30, v30
    v_exp_f32 v31, v31
    s_nop 0
    v_cvt_pk_bf16_f32 v32, v16, v17
    v_cvt_pk_bf16_f32 v33, v18, v19
    v_cvt_pk_bf16_f32 v34, v20, v21
    v_cvt_pk_bf16_f32 v35, v22, v23
    v_cvt_pk_bf16_f32 v36, v24, v25
    v_cvt_pk_bf16_f32 v37, v26, v27
    v_cvt_pk_bf16_f32 v38, v28, v29
    v_cvt_pk_bf16_f32 v39, v30, v31
    s_nop 1
    v_mfma_f32_32x32x16_bf16 v[48:63], v[92:95], v[32:35], v[48:63]
    v_mfma_f32_32x32x16_bf16 v[48:63], v[96:99], v[36:39], v[48:63]
    s_add_u32 s30, s30, 1280
    s_add_u32 s31, s31, 1
    s_cmp_lt_u32 s31, 64
    s_cbranch_scc1 L_att_slow1
    s_mov_b32 s43, 1
    s_nop 10
    s_branch L_att_store
L_prep:
    s_load_dwordx4 s[12:15], s[0:1], 8
    s_load_dwordx4 s[16:19], s[0:1], 40
    s_load_dwordx4 s[20:23], s[0:1], 56
    s_lshl_b32 s43, s24, 1
    s_add_u32 s43, s43, s25
    s_sub_u32 s43, s43, 30
    s_mul_i32 s35, s43, 40
    v_mul_u32_u24 v1, 410, v0
    v_lshrrev_b32 v1, 16, v1
    v_mul_u32_u24 v9, 160, v1
    v_sub_u32 v10, v0, v9
    v_lshrrev_b32 v11, 3, v10
    v_and_b32 v9, 3, v10
    v_lshl_add_u32 v11, v11, 2, v9
    v_add_u32 v3, s35, v1
    v_mul_u32_u24 v4, 1280, v3
    v_lshl_add_u32 v4, v11, 4, v4
    v_mul_u32_u24 v5, 2816, v3
    v_lshl_add_u32 v5, v10, 4, v5
    v_mov_b32 v6, 0x7f000000
    v_cmp_gt_u32 vcc, 480, v0
    s_nop 1
    v_cndmask_b32 v4, v6, v4, vcc
    v_cndmask_b32 v5, v6, v5, vcc
    v_cmp_eq_u32 vcc, 0, v1
    s_nop 1
    v_cndmask_b32 v7, v6, v4, vcc
    v_cndmask_b32 v8, v6, v5, vcc
    v_lshlrev_b32 v9, 1, v0
    s_waitcnt lgkmcnt(0)
    s_mov_b32 s64, s12
    s_and_b32 s65, s13, 0xffff
    s_mov_b32 s66, 1280
    s_mov_b32 s67, 0x00020000
    buffer_load_ushort v12, v9, s[64:67], 0 offen offset:0
    buffer_load_ushort v15, v9, s[64:67], 0 offen offset:1024
    s_mov_b32 s64, s14
    s_and_b32 s65, s15, 0xffff
    s_mov_b32 s66, 1280
    s_mov_b32 s67, 0x00020000
    buffer_load_ushort v13, v9, s[64:67], 0 offen offset:0
    buffer_load_ushort v16, v9, s[64:67], 0 offen offset:1024
    s_mov_b32 s64, s20
    s_and_b32 s65, s21, 0xffff
    s_mov_b32 s66, 1280
    s_mov_b32 s67, 0x00020000
    buffer_load_ushort v14, v9, s[64:67], 0 offen offset:0
    buffer_load_ushort v17, v9, s[64:67], 0 offen offset:1024
    s_mov_b32 s64, s22
    s_and_b32 s65, s23, 0xffff
    s_mov_b32 s66, 1280
    s_mov_b32 s67, 0x00020000
    v_add_u32 v20, 0, v0
    v_lshrrev_b32 v21, 4, v20
    v_add_u32 v21, s35, v21
    v_lshlrev_b32 v22, 1, v21
    buffer_load_ushort v36, v22, s[64:67], 0 offen
    v_and_b32 v22, 15, v20
    v_mul_u32_u24 v23, 2816, v21
    v_lshl_add_u32 v23, v22, 4, v23
    v_add_u32 v38, 2560, v23
    v_and_b32 v21, 127, v21
    v_lshlrev_b32 v22, 3, v22
    v_sub_u32 v40, v21, v22
    v_add_u32 v20, 512, v0
    v_lshrrev_b32 v21, 4, v20
    v_add_u32 v21, s35, v21
    v_lshlrev_b32 v22, 1, v21
    buffer_load_ushort v37, v22, s[64:67], 0 offen
    v_and_b32 v22, 15, v20
    v_mul_u32_u24 v23, 2816, v21
    v_lshl_add_u32 v23, v22, 4, v23
    v_add_u32 v39, 2560, v23
    v_and_b32 v21, 127, v21
    v_lshlrev_b32 v22, 3, v22
    v_sub_u32 v41, v21, v22
    v_cmp_gt_u32 vcc, 128, v0
    s_mov_b32 s52, s16
    s_and_b32 s53, s17, 0xffff
    s_mov_b32 s54, 819200
    s_mov_b32 s55, 0x00020000
    v_cndmask_b32 v39, v6, v39, vcc
    s_mov_b32 s56, s18
    s_and_b32 s57, s19, 0xffff
    s_mov_b32 s58, 819200
    s_mov_b32 s59, 0x00020000
    s_add_u32 s60, s8, 15728640
    s_addc_u32 s61, s9, 0
    s_and_b32 s61, s61, 0xffff
    s_mov_b32 s62, 1802240
    s_mov_b32 s63, 0x00020000
    s_mov_b32 s30, 0
    buffer_load_dwordx4 v[128:131], v4, s[52:55], s30 offen
    buffer_load_dwordx4 v[132:135], v4, s[56:59], s30 offen
    s_mov_b32 s30, 3840
    buffer_load_dwordx4 v[136:139], v4, s[52:55], s30 offen
    buffer_load_dwordx4 v[140:143], v4, s[56:59], s30 offen
    s_mov_b32 s30, 7680
    buffer_load_dwordx4 v[144:147], v4, s[52:55], s30 offen
    buffer_load_dwordx4 v[148:151], v4, s[56:59], s30 offen
    s_mov_b32 s30, 11520
    buffer_load_dwordx4 v[152:155], v4, s[52:55], s30 offen
    buffer_load_dwordx4 v[156:159], v4, s[56:59], s30 offen
    s_mov_b32 s30, 15360
    buffer_load_dwordx4 v[160:163], v4, s[52:55], s30 offen
    buffer_load_dwordx4 v[164:167], v4, s[56:59], s30 offen
    s_mov_b32 s30, 19200
    buffer_load_dwordx4 v[168:171], v4, s[52:55], s30 offen
    buffer_load_dwordx4 v[172:175], v4, s[56:59], s30 offen
    s_mov_b32 s30, 23040
    buffer_load_dwordx4 v[176:179], v4, s[52:55], s30 offen
    buffer_load_dwordx4 v[180:183], v4, s[56:59], s30 offen
    s_mov_b32 s30, 26880
    buffer_load_dwordx4 v[184:187], v4, s[52:55], s30 offen
    buffer_load_dwordx4 v[188:191], v4, s[56:59], s30 offen
    s_mov_b32 s30, 30720
    buffer_load_dwordx4 v[192:195], v4, s[52:55], s30 offen
    buffer_load_dwordx4 v[196:199], v4, s[56:59], s30 offen
    s_mov_b32 s30, 34560
    buffer_load_dwordx4 v[200:203], v4, s[52:55], s30 offen
    buffer_load_dwordx4 v[204:207], v4, s[56:59], s30 offen
    s_mov_b32 s30, 38400
    buffer_load_dwordx4 v[208:211], v4, s[52:55], s30 offen
    buffer_load_dwordx4 v[212:215], v4, s[56:59], s30 offen
    s_mov_b32 s30, 42240
    buffer_load_dwordx4 v[216:219], v4, s[52:55], s30 offen
    buffer_load_dwordx4 v[220:223], v4, s[56:59], s30 offen
    s_mov_b32 s30, 46080
    buffer_load_dwordx4 v[224:227], v4, s[52:55], s30 offen
    buffer_load_dwordx4 v[228:231], v4, s[56:59], s30 offen
    s_mov_b32 s30, 49920
    buffer_load_dwordx4 v[232:235], v7, s[52:55], s30 offen
    buffer_load_dwordx4 v[236:239], v7, s[56:59], s30 offen
    s_waitcnt vmcnt(28)
    v_lshlrev_b32 v12, 16, v12
    v_lshlrev_b32 v13, 16, v13
    v_lshlrev_b32 v14, 16, v14
    v_mul_f32 v14, 1069066811, v14
    v_exp_f32 v14, v14
    s_nop 0
    v_cvt_pk_bf16_f32 v14, v14, v14
    v_lshlrev_b32 v14, 16, v14
    v_mul_f32 v20, v14, v12
    v_mul_f32 v21, v14, v13
    v_mul_f32 v20, 1069066811, v20
    v_mul_f32 v21, 1042479491, v21
    v_exp_f32 v20, v20
    v_fract_f32 v21, v21
    v_cos_f32 v22, v21
    v_sin_f32 v23, v21
    s_nop 0
    v_mul_f32 v26, v20, v22
    v_mul_f32 v27, v20, v23
    v_add_f32 v20, -1.0, v26
    v_mul_f32 v21, v12, v12
    v_fma_f32 v21, v13, v13, v21
    v_rcp_f32 v21, v21
    v_mul_f32 v22, v20, v12
    v_fma_f32 v22, v27, v13, v22
    v_mul_f32 v23, v27, v12
    v_fma_f32 v23, -v20, v13, v23
    v_add_f32 v21, v21, v21
    v_mul_f32 v22, v22, v21
    v_mul_f32 v23, v23, v21
    v_lshlrev_b32 v20, 3, v0
    ds_write_b64 v20, v[22:23] offset:0
    v_lshlrev_b32 v15, 16, v15
    v_lshlrev_b32 v16, 16, v16
    v_lshlrev_b32 v17, 16, v17
    v_mul_f32 v17, 1069066811, v17
    v_exp_f32 v17, v17
    s_nop 0
    v_cvt_pk_bf16_f32 v17, v17, v17
    v_lshlrev_b32 v17, 16, v17
    v_mul_f32 v20, v17, v15
    v_mul_f32 v21, v17, v16
    v_mul_f32 v20, 1069066811, v20
    v_mul_f32 v21, 1042479491, v21
    v_exp_f32 v20, v20
    v_fract_f32 v21, v21
    v_cos_f32 v22, v21
    v_sin_f32 v23, v21
    s_nop 0
    v_mul_f32 v26, v20, v22
    v_mul_f32 v27, v20, v23
    v_add_f32 v20, -1.0, v26
    v_mul_f32 v21, v15, v15
    v_fma_f32 v21, v16, v16, v21
    v_rcp_f32 v21, v21
    v_mul_f32 v22, v20, v15
    v_fma_f32 v22, v27, v16, v22
    v_mul_f32 v23, v27, v15
    v_fma_f32 v23, -v20, v16, v23
    v_add_f32 v21, v21, v21
    v_mul_f32 v22, v22, v21
    v_mul_f32 v23, v23, v21
    v_lshlrev_b32 v20, 3, v0
    ds_write_b64 v20, v[22:23] offset:4096
    v_and_b32 v20, 1, v40
    v_lshlrev_b32 v20, 4, v20
    v_lshlrev_b32 v21, v20, v36
    v_lshrrev_b32 v20, 1, v40
    v_cmp_eq_u32 vcc, 0, v20
    s_nop 1
    v_cndmask_b32 v240, 0, v21, vcc
    v_cmp_eq_u32 vcc, 1, v20
    s_nop 1
    v_cndmask_b32 v241, 0, v21, vcc
    v_cmp_eq_u32 vcc, 2, v20
    s_nop 1
    v_cndmask_b32 v242, 0, v21, vcc
    v_cmp_eq_u32 vcc, 3, v20
    s_nop 1
    v_cndmask_b32 v243, 0, v21, vcc
    v_mov_b32 v248, v38
    v_and_b32 v20, 1, v41
    v_lshlrev_b32 v20, 4, v20
    v_lshlrev_b32 v21, v20, v37
    v_lshrrev_b32 v20, 1, v41
    v_cmp_eq_u32 vcc, 0, v20
    s_nop 1
    v_cndmask_b32 v244, 0, v21, vcc
    v_cmp_eq_u32 vcc, 1, v20
    s_nop 1
    v_cndmask_b32 v245, 0, v21, vcc
    v_cmp_eq_u32 vcc, 2, v20
    s_nop 1
    v_cndmask_b32 v246, 0, v21, vcc
    v_cmp_eq_u32 vcc, 3, v20
    s_nop 1
    v_cndmask_b32 v247, 0, v21, vcc
    v_mov_b32 v249, v39
    s_waitcnt lgkmcnt(0)
    s_barrier
    v_lshlrev_b32 v20, 6, v11
    ds_read_b128 v[44:47], v20 offset:0
    ds_read_b128 v[48:51], v20 offset:16
    ds_read_b128 v[52:55], v20 offset:32
    ds_read_b128 v[56:59], v20 offset:48
    v_and_b32 v20, 4, v10
    v_cmp_eq_u32 vcc, 0, v20
    s_mov_b32 s31, 0xffff0000
    s_waitcnt lgkmcnt(0)
    v_sub_f32 v45, 0, v45
    v_sub_f32 v20, 0, v44
    v_cndmask_b32 v44, v45, v44, vcc
    v_cndmask_b32 v45, v20, v45, vcc
    v_sub_f32 v47, 0, v47
    v_sub_f32 v20, 0, v46
    v_cndmask_b32 v46, v47, v46, vcc
    v_cndmask_b32 v47, v20, v47, vcc
    v_sub_f32 v49, 0, v49
    v_sub_f32 v20, 0, v48
    v_cndmask_b32 v48, v49, v48, vcc
    v_cndmask_b32 v49, v20, v49, vcc
    v_sub_f32 v51, 0, v51
    v_sub_f32 v20, 0, v50
    v_cndmask_b32 v50, v51, v50, vcc
    v_cndmask_b32 v51, v20, v51, vcc
    v_sub_f32 v53, 0, v53
    v_sub_f32 v20, 0, v52
    v_cndmask_b32 v52, v53, v52, vcc
    v_cndmask_b32 v53, v20, v53, vcc
    v_sub_f32 v55, 0, v55
    v_sub_f32 v20, 0, v54
    v_cndmask_b32 v54, v55, v54, vcc
    v_cndmask_b32 v55, v20, v55, vcc
    v_sub_f32 v57, 0, v57
    v_sub_f32 v20, 0, v56
    v_cndmask_b32 v56, v57, v56, vcc
    v_cndmask_b32 v57, v20, v57, vcc
    v_sub_f32 v59, 0, v59
    v_sub_f32 v20, 0, v58
    v_cndmask_b32 v58, v59, v58, vcc
    v_cndmask_b32 v59, v20, v59, vcc
    s_waitcnt vmcnt(20)
    v_lshlrev_b32 v20, 16, v128
    v_lshlrev_b32 v21, 16, v132
    v_mul_f32 v22, v44, v20
    v_fma_f32 v22, v45, v21, v22
    v_and_b32 v20, s31, v128
    v_and_b32 v21, s31, v132
    v_mul_f32 v23, v46, v20
    v_fma_f32 v23, v47, v21, v23
    v_cvt_pk_bf16_f32 v128, v22, v23
    v_lshlrev_b32 v20, 16, v129
    v_lshlrev_b32 v21, 16, v133
    v_mul_f32 v22, v48, v20
    v_fma_f32 v22, v49, v21, v22
    v_and_b32 v20, s31, v129
    v_and_b32 v21, s31, v133
    v_mul_f32 v23, v50, v20
    v_fma_f32 v23, v51, v21, v23
    v_cvt_pk_bf16_f32 v129, v22, v23
    v_lshlrev_b32 v20, 16, v130
    v_lshlrev_b32 v21, 16, v134
    v_mul_f32 v22, v52, v20
    v_fma_f32 v22, v53, v21, v22
    v_and_b32 v20, s31, v130
    v_and_b32 v21, s31, v134
    v_mul_f32 v23, v54, v20
    v_fma_f32 v23, v55, v21, v23
    v_cvt_pk_bf16_f32 v130, v22, v23
    v_lshlrev_b32 v20, 16, v131
    v_lshlrev_b32 v21, 16, v135
    v_mul_f32 v22, v56, v20
    v_fma_f32 v22, v57, v21, v22
    v_and_b32 v20, s31, v131
    v_and_b32 v21, s31, v135
    v_mul_f32 v23, v58, v20
    v_fma_f32 v23, v59, v21, v23
    v_cvt_pk_bf16_f32 v131, v22, v23
    v_lshlrev_b32 v20, 16, v136
    v_lshlrev_b32 v21, 16, v140
    v_mul_f32 v22, v44, v20
    v_fma_f32 v22, v45, v21, v22
    v_and_b32 v20, s31, v136
    v_and_b32 v21, s31, v140
    v_mul_f32 v23, v46, v20
    v_fma_f32 v23, v47, v21, v23
    v_cvt_pk_bf16_f32 v136, v22, v23
    v_lshlrev_b32 v20, 16, v137
    v_lshlrev_b32 v21, 16, v141
    v_mul_f32 v22, v48, v20
    v_fma_f32 v22, v49, v21, v22
    v_and_b32 v20, s31, v137
    v_and_b32 v21, s31, v141
    v_mul_f32 v23, v50, v20
    v_fma_f32 v23, v51, v21, v23
    v_cvt_pk_bf16_f32 v137, v22, v23
    v_lshlrev_b32 v20, 16, v138
    v_lshlrev_b32 v21, 16, v142
    v_mul_f32 v22, v52, v20
    v_fma_f32 v22, v53, v21, v22
    v_and_b32 v20, s31, v138
    v_and_b32 v21, s31, v142
    v_mul_f32 v23, v54, v20
    v_fma_f32 v23, v55, v21, v23
    v_cvt_pk_bf16_f32 v138, v22, v23
    v_lshlrev_b32 v20, 16, v139
    v_lshlrev_b32 v21, 16, v143
    v_mul_f32 v22, v56, v20
    v_fma_f32 v22, v57, v21, v22
    v_and_b32 v20, s31, v139
    v_and_b32 v21, s31, v143
    v_mul_f32 v23, v58, v20
    v_fma_f32 v23, v59, v21, v23
    v_cvt_pk_bf16_f32 v139, v22, v23
    v_lshlrev_b32 v20, 16, v144
    v_lshlrev_b32 v21, 16, v148
    v_mul_f32 v22, v44, v20
    v_fma_f32 v22, v45, v21, v22
    v_and_b32 v20, s31, v144
    v_and_b32 v21, s31, v148
    v_mul_f32 v23, v46, v20
    v_fma_f32 v23, v47, v21, v23
    v_cvt_pk_bf16_f32 v144, v22, v23
    v_lshlrev_b32 v20, 16, v145
    v_lshlrev_b32 v21, 16, v149
    v_mul_f32 v22, v48, v20
    v_fma_f32 v22, v49, v21, v22
    v_and_b32 v20, s31, v145
    v_and_b32 v21, s31, v149
    v_mul_f32 v23, v50, v20
    v_fma_f32 v23, v51, v21, v23
    v_cvt_pk_bf16_f32 v145, v22, v23
    v_lshlrev_b32 v20, 16, v146
    v_lshlrev_b32 v21, 16, v150
    v_mul_f32 v22, v52, v20
    v_fma_f32 v22, v53, v21, v22
    v_and_b32 v20, s31, v146
    v_and_b32 v21, s31, v150
    v_mul_f32 v23, v54, v20
    v_fma_f32 v23, v55, v21, v23
    v_cvt_pk_bf16_f32 v146, v22, v23
    v_lshlrev_b32 v20, 16, v147
    v_lshlrev_b32 v21, 16, v151
    v_mul_f32 v22, v56, v20
    v_fma_f32 v22, v57, v21, v22
    v_and_b32 v20, s31, v147
    v_and_b32 v21, s31, v151
    v_mul_f32 v23, v58, v20
    v_fma_f32 v23, v59, v21, v23
    v_cvt_pk_bf16_f32 v147, v22, v23
    v_lshlrev_b32 v20, 16, v152
    v_lshlrev_b32 v21, 16, v156
    v_mul_f32 v22, v44, v20
    v_fma_f32 v22, v45, v21, v22
    v_and_b32 v20, s31, v152
    v_and_b32 v21, s31, v156
    v_mul_f32 v23, v46, v20
    v_fma_f32 v23, v47, v21, v23
    v_cvt_pk_bf16_f32 v152, v22, v23
    v_lshlrev_b32 v20, 16, v153
    v_lshlrev_b32 v21, 16, v157
    v_mul_f32 v22, v48, v20
    v_fma_f32 v22, v49, v21, v22
    v_and_b32 v20, s31, v153
    v_and_b32 v21, s31, v157
    v_mul_f32 v23, v50, v20
    v_fma_f32 v23, v51, v21, v23
    v_cvt_pk_bf16_f32 v153, v22, v23
    v_lshlrev_b32 v20, 16, v154
    v_lshlrev_b32 v21, 16, v158
    v_mul_f32 v22, v52, v20
    v_fma_f32 v22, v53, v21, v22
    v_and_b32 v20, s31, v154
    v_and_b32 v21, s31, v158
    v_mul_f32 v23, v54, v20
    v_fma_f32 v23, v55, v21, v23
    v_cvt_pk_bf16_f32 v154, v22, v23
    v_lshlrev_b32 v20, 16, v155
    v_lshlrev_b32 v21, 16, v159
    v_mul_f32 v22, v56, v20
    v_fma_f32 v22, v57, v21, v22
    v_and_b32 v20, s31, v155
    v_and_b32 v21, s31, v159
    v_mul_f32 v23, v58, v20
    v_fma_f32 v23, v59, v21, v23
    v_cvt_pk_bf16_f32 v155, v22, v23
    s_waitcnt vmcnt(12)
    v_lshlrev_b32 v20, 16, v160
    v_lshlrev_b32 v21, 16, v164
    v_mul_f32 v22, v44, v20
    v_fma_f32 v22, v45, v21, v22
    v_and_b32 v20, s31, v160
    v_and_b32 v21, s31, v164
    v_mul_f32 v23, v46, v20
    v_fma_f32 v23, v47, v21, v23
    v_cvt_pk_bf16_f32 v160, v22, v23
    v_lshlrev_b32 v20, 16, v161
    v_lshlrev_b32 v21, 16, v165
    v_mul_f32 v22, v48, v20
    v_fma_f32 v22, v49, v21, v22
    v_and_b32 v20, s31, v161
    v_and_b32 v21, s31, v165
    v_mul_f32 v23, v50, v20
    v_fma_f32 v23, v51, v21, v23
    v_cvt_pk_bf16_f32 v161, v22, v23
    v_lshlrev_b32 v20, 16, v162
    v_lshlrev_b32 v21, 16, v166
    v_mul_f32 v22, v52, v20
    v_fma_f32 v22, v53, v21, v22
    v_and_b32 v20, s31, v162
    v_and_b32 v21, s31, v166
    v_mul_f32 v23, v54, v20
    v_fma_f32 v23, v55, v21, v23
    v_cvt_pk_bf16_f32 v162, v22, v23
    v_lshlrev_b32 v20, 16, v163
    v_lshlrev_b32 v21, 16, v167
    v_mul_f32 v22, v56, v20
    v_fma_f32 v22, v57, v21, v22
    v_and_b32 v20, s31, v163
    v_and_b32 v21, s31, v167
    v_mul_f32 v23, v58, v20
    v_fma_f32 v23, v59, v21, v23
    v_cvt_pk_bf16_f32 v163, v22, v23
    v_lshlrev_b32 v20, 16, v168
    v_lshlrev_b32 v21, 16, v172
    v_mul_f32 v22, v44, v20
    v_fma_f32 v22, v45, v21, v22
    v_and_b32 v20, s31, v168
    v_and_b32 v21, s31, v172
    v_mul_f32 v23, v46, v20
    v_fma_f32 v23, v47, v21, v23
    v_cvt_pk_bf16_f32 v168, v22, v23
    v_lshlrev_b32 v20, 16, v169
    v_lshlrev_b32 v21, 16, v173
    v_mul_f32 v22, v48, v20
    v_fma_f32 v22, v49, v21, v22
    v_and_b32 v20, s31, v169
    v_and_b32 v21, s31, v173
    v_mul_f32 v23, v50, v20
    v_fma_f32 v23, v51, v21, v23
    v_cvt_pk_bf16_f32 v169, v22, v23
    v_lshlrev_b32 v20, 16, v170
    v_lshlrev_b32 v21, 16, v174
    v_mul_f32 v22, v52, v20
    v_fma_f32 v22, v53, v21, v22
    v_and_b32 v20, s31, v170
    v_and_b32 v21, s31, v174
    v_mul_f32 v23, v54, v20
    v_fma_f32 v23, v55, v21, v23
    v_cvt_pk_bf16_f32 v170, v22, v23
    v_lshlrev_b32 v20, 16, v171
    v_lshlrev_b32 v21, 16, v175
    v_mul_f32 v22, v56, v20
    v_fma_f32 v22, v57, v21, v22
    v_and_b32 v20, s31, v171
    v_and_b32 v21, s31, v175
    v_mul_f32 v23, v58, v20
    v_fma_f32 v23, v59, v21, v23
    v_cvt_pk_bf16_f32 v171, v22, v23
    v_lshlrev_b32 v20, 16, v176
    v_lshlrev_b32 v21, 16, v180
    v_mul_f32 v22, v44, v20
    v_fma_f32 v22, v45, v21, v22
    v_and_b32 v20, s31, v176
    v_and_b32 v21, s31, v180
    v_mul_f32 v23, v46, v20
    v_fma_f32 v23, v47, v21, v23
    v_cvt_pk_bf16_f32 v176, v22, v23
    v_lshlrev_b32 v20, 16, v177
    v_lshlrev_b32 v21, 16, v181
    v_mul_f32 v22, v48, v20
    v_fma_f32 v22, v49, v21, v22
    v_and_b32 v20, s31, v177
    v_and_b32 v21, s31, v181
    v_mul_f32 v23, v50, v20
    v_fma_f32 v23, v51, v21, v23
    v_cvt_pk_bf16_f32 v177, v22, v23
    v_lshlrev_b32 v20, 16, v178
    v_lshlrev_b32 v21, 16, v182
    v_mul_f32 v22, v52, v20
    v_fma_f32 v22, v53, v21, v22
    v_and_b32 v20, s31, v178
    v_and_b32 v21, s31, v182
    v_mul_f32 v23, v54, v20
    v_fma_f32 v23, v55, v21, v23
    v_cvt_pk_bf16_f32 v178, v22, v23
    v_lshlrev_b32 v20, 16, v179
    v_lshlrev_b32 v21, 16, v183
    v_mul_f32 v22, v56, v20
    v_fma_f32 v22, v57, v21, v22
    v_and_b32 v20, s31, v179
    v_and_b32 v21, s31, v183
    v_mul_f32 v23, v58, v20
    v_fma_f32 v23, v59, v21, v23
    v_cvt_pk_bf16_f32 v179, v22, v23
    v_lshlrev_b32 v20, 16, v184
    v_lshlrev_b32 v21, 16, v188
    v_mul_f32 v22, v44, v20
    v_fma_f32 v22, v45, v21, v22
    v_and_b32 v20, s31, v184
    v_and_b32 v21, s31, v188
    v_mul_f32 v23, v46, v20
    v_fma_f32 v23, v47, v21, v23
    v_cvt_pk_bf16_f32 v184, v22, v23
    v_lshlrev_b32 v20, 16, v185
    v_lshlrev_b32 v21, 16, v189
    v_mul_f32 v22, v48, v20
    v_fma_f32 v22, v49, v21, v22
    v_and_b32 v20, s31, v185
    v_and_b32 v21, s31, v189
    v_mul_f32 v23, v50, v20
    v_fma_f32 v23, v51, v21, v23
    v_cvt_pk_bf16_f32 v185, v22, v23
    v_lshlrev_b32 v20, 16, v186
    v_lshlrev_b32 v21, 16, v190
    v_mul_f32 v22, v52, v20
    v_fma_f32 v22, v53, v21, v22
    v_and_b32 v20, s31, v186
    v_and_b32 v21, s31, v190
    v_mul_f32 v23, v54, v20
    v_fma_f32 v23, v55, v21, v23
    v_cvt_pk_bf16_f32 v186, v22, v23
    v_lshlrev_b32 v20, 16, v187
    v_lshlrev_b32 v21, 16, v191
    v_mul_f32 v22, v56, v20
    v_fma_f32 v22, v57, v21, v22
    v_and_b32 v20, s31, v187
    v_and_b32 v21, s31, v191
    v_mul_f32 v23, v58, v20
    v_fma_f32 v23, v59, v21, v23
    v_cvt_pk_bf16_f32 v187, v22, v23
    s_waitcnt vmcnt(4)
    v_lshlrev_b32 v20, 16, v192
    v_lshlrev_b32 v21, 16, v196
    v_mul_f32 v22, v44, v20
    v_fma_f32 v22, v45, v21, v22
    v_and_b32 v20, s31, v192
    v_and_b32 v21, s31, v196
    v_mul_f32 v23, v46, v20
    v_fma_f32 v23, v47, v21, v23
    v_cvt_pk_bf16_f32 v192, v22, v23
    v_lshlrev_b32 v20, 16, v193
    v_lshlrev_b32 v21, 16, v197
    v_mul_f32 v22, v48, v20
    v_fma_f32 v22, v49, v21, v22
    v_and_b32 v20, s31, v193
    v_and_b32 v21, s31, v197
    v_mul_f32 v23, v50, v20
    v_fma_f32 v23, v51, v21, v23
    v_cvt_pk_bf16_f32 v193, v22, v23
    v_lshlrev_b32 v20, 16, v194
    v_lshlrev_b32 v21, 16, v198
    v_mul_f32 v22, v52, v20
    v_fma_f32 v22, v53, v21, v22
    v_and_b32 v20, s31, v194
    v_and_b32 v21, s31, v198
    v_mul_f32 v23, v54, v20
    v_fma_f32 v23, v55, v21, v23
    v_cvt_pk_bf16_f32 v194, v22, v23
    v_lshlrev_b32 v20, 16, v195
    v_lshlrev_b32 v21, 16, v199
    v_mul_f32 v22, v56, v20
    v_fma_f32 v22, v57, v21, v22
    v_and_b32 v20, s31, v195
    v_and_b32 v21, s31, v199
    v_mul_f32 v23, v58, v20
    v_fma_f32 v23, v59, v21, v23
    v_cvt_pk_bf16_f32 v195, v22, v23
    v_lshlrev_b32 v20, 16, v200
    v_lshlrev_b32 v21, 16, v204
    v_mul_f32 v22, v44, v20
    v_fma_f32 v22, v45, v21, v22
    v_and_b32 v20, s31, v200
    v_and_b32 v21, s31, v204
    v_mul_f32 v23, v46, v20
    v_fma_f32 v23, v47, v21, v23
    v_cvt_pk_bf16_f32 v200, v22, v23
    v_lshlrev_b32 v20, 16, v201
    v_lshlrev_b32 v21, 16, v205
    v_mul_f32 v22, v48, v20
    v_fma_f32 v22, v49, v21, v22
    v_and_b32 v20, s31, v201
    v_and_b32 v21, s31, v205
    v_mul_f32 v23, v50, v20
    v_fma_f32 v23, v51, v21, v23
    v_cvt_pk_bf16_f32 v201, v22, v23
    v_lshlrev_b32 v20, 16, v202
    v_lshlrev_b32 v21, 16, v206
    v_mul_f32 v22, v52, v20
    v_fma_f32 v22, v53, v21, v22
    v_and_b32 v20, s31, v202
    v_and_b32 v21, s31, v206
    v_mul_f32 v23, v54, v20
    v_fma_f32 v23, v55, v21, v23
    v_cvt_pk_bf16_f32 v202, v22, v23
    v_lshlrev_b32 v20, 16, v203
    v_lshlrev_b32 v21, 16, v207
    v_mul_f32 v22, v56, v20
    v_fma_f32 v22, v57, v21, v22
    v_and_b32 v20, s31, v203
    v_and_b32 v21, s31, v207
    v_mul_f32 v23, v58, v20
    v_fma_f32 v23, v59, v21, v23
    v_cvt_pk_bf16_f32 v203, v22, v23
    v_lshlrev_b32 v20, 16, v208
    v_lshlrev_b32 v21, 16, v212
    v_mul_f32 v22, v44, v20
    v_fma_f32 v22, v45, v21, v22
    v_and_b32 v20, s31, v208
    v_and_b32 v21, s31, v212
    v_mul_f32 v23, v46, v20
    v_fma_f32 v23, v47, v21, v23
    v_cvt_pk_bf16_f32 v208, v22, v23
    v_lshlrev_b32 v20, 16, v209
    v_lshlrev_b32 v21, 16, v213
    v_mul_f32 v22, v48, v20
    v_fma_f32 v22, v49, v21, v22
    v_and_b32 v20, s31, v209
    v_and_b32 v21, s31, v213
    v_mul_f32 v23, v50, v20
    v_fma_f32 v23, v51, v21, v23
    v_cvt_pk_bf16_f32 v209, v22, v23
    v_lshlrev_b32 v20, 16, v210
    v_lshlrev_b32 v21, 16, v214
    v_mul_f32 v22, v52, v20
    v_fma_f32 v22, v53, v21, v22
    v_and_b32 v20, s31, v210
    v_and_b32 v21, s31, v214
    v_mul_f32 v23, v54, v20
    v_fma_f32 v23, v55, v21, v23
    v_cvt_pk_bf16_f32 v210, v22, v23
    v_lshlrev_b32 v20, 16, v211
    v_lshlrev_b32 v21, 16, v215
    v_mul_f32 v22, v56, v20
    v_fma_f32 v22, v57, v21, v22
    v_and_b32 v20, s31, v211
    v_and_b32 v21, s31, v215
    v_mul_f32 v23, v58, v20
    v_fma_f32 v23, v59, v21, v23
    v_cvt_pk_bf16_f32 v211, v22, v23
    v_lshlrev_b32 v20, 16, v216
    v_lshlrev_b32 v21, 16, v220
    v_mul_f32 v22, v44, v20
    v_fma_f32 v22, v45, v21, v22
    v_and_b32 v20, s31, v216
    v_and_b32 v21, s31, v220
    v_mul_f32 v23, v46, v20
    v_fma_f32 v23, v47, v21, v23
    v_cvt_pk_bf16_f32 v216, v22, v23
    v_lshlrev_b32 v20, 16, v217
    v_lshlrev_b32 v21, 16, v221
    v_mul_f32 v22, v48, v20
    v_fma_f32 v22, v49, v21, v22
    v_and_b32 v20, s31, v217
    v_and_b32 v21, s31, v221
    v_mul_f32 v23, v50, v20
    v_fma_f32 v23, v51, v21, v23
    v_cvt_pk_bf16_f32 v217, v22, v23
    v_lshlrev_b32 v20, 16, v218
    v_lshlrev_b32 v21, 16, v222
    v_mul_f32 v22, v52, v20
    v_fma_f32 v22, v53, v21, v22
    v_and_b32 v20, s31, v218
    v_and_b32 v21, s31, v222
    v_mul_f32 v23, v54, v20
    v_fma_f32 v23, v55, v21, v23
    v_cvt_pk_bf16_f32 v218, v22, v23
    v_lshlrev_b32 v20, 16, v219
    v_lshlrev_b32 v21, 16, v223
    v_mul_f32 v22, v56, v20
    v_fma_f32 v22, v57, v21, v22
    v_and_b32 v20, s31, v219
    v_and_b32 v21, s31, v223
    v_mul_f32 v23, v58, v20
    v_fma_f32 v23, v59, v21, v23
    v_cvt_pk_bf16_f32 v219, v22, v23
    s_waitcnt vmcnt(0)
    v_lshlrev_b32 v20, 16, v224
    v_lshlrev_b32 v21, 16, v228
    v_mul_f32 v22, v44, v20
    v_fma_f32 v22, v45, v21, v22
    v_and_b32 v20, s31, v224
    v_and_b32 v21, s31, v228
    v_mul_f32 v23, v46, v20
    v_fma_f32 v23, v47, v21, v23
    v_cvt_pk_bf16_f32 v224, v22, v23
    v_lshlrev_b32 v20, 16, v225
    v_lshlrev_b32 v21, 16, v229
    v_mul_f32 v22, v48, v20
    v_fma_f32 v22, v49, v21, v22
    v_and_b32 v20, s31, v225
    v_and_b32 v21, s31, v229
    v_mul_f32 v23, v50, v20
    v_fma_f32 v23, v51, v21, v23
    v_cvt_pk_bf16_f32 v225, v22, v23
    v_lshlrev_b32 v20, 16, v226
    v_lshlrev_b32 v21, 16, v230
    v_mul_f32 v22, v52, v20
    v_fma_f32 v22, v53, v21, v22
    v_and_b32 v20, s31, v226
    v_and_b32 v21, s31, v230
    v_mul_f32 v23, v54, v20
    v_fma_f32 v23, v55, v21, v23
    v_cvt_pk_bf16_f32 v226, v22, v23
    v_lshlrev_b32 v20, 16, v227
    v_lshlrev_b32 v21, 16, v231
    v_mul_f32 v22, v56, v20
    v_fma_f32 v22, v57, v21, v22
    v_and_b32 v20, s31, v227
    v_and_b32 v21, s31, v231
    v_mul_f32 v23, v58, v20
    v_fma_f32 v23, v59, v21, v23
    v_cvt_pk_bf16_f32 v227, v22, v23
    v_lshlrev_b32 v20, 16, v232
    v_lshlrev_b32 v21, 16, v236
    v_mul_f32 v22, v44, v20
    v_fma_f32 v22, v45, v21, v22
    v_and_b32 v20, s31, v232
    v_and_b32 v21, s31, v236
    v_mul_f32 v23, v46, v20
    v_fma_f32 v23, v47, v21, v23
    v_cvt_pk_bf16_f32 v232, v22, v23
    v_lshlrev_b32 v20, 16, v233
    v_lshlrev_b32 v21, 16, v237
    v_mul_f32 v22, v48, v20
    v_fma_f32 v22, v49, v21, v22
    v_and_b32 v20, s31, v233
    v_and_b32 v21, s31, v237
    v_mul_f32 v23, v50, v20
    v_fma_f32 v23, v51, v21, v23
    v_cvt_pk_bf16_f32 v233, v22, v23
    v_lshlrev_b32 v20, 16, v234
    v_lshlrev_b32 v21, 16, v238
    v_mul_f32 v22, v52, v20
    v_fma_f32 v22, v53, v21, v22
    v_and_b32 v20, s31, v234
    v_and_b32 v21, s31, v238
    v_mul_f32 v23, v54, v20
    v_fma_f32 v23, v55, v21, v23
    v_cvt_pk_bf16_f32 v234, v22, v23
    v_lshlrev_b32 v20, 16, v235
    v_lshlrev_b32 v21, 16, v239
    v_mul_f32 v22, v56, v20
    v_fma_f32 v22, v57, v21, v22
    v_and_b32 v20, s31, v235
    v_and_b32 v21, s31, v239
    v_mul_f32 v23, v58, v20
    v_fma_f32 v23, v59, v21, v23
    v_cvt_pk_bf16_f32 v235, v22, v23
    v_mov_b32 v250, v5
    v_mov_b32 v251, v8
    buffer_load_dword v25, off, s[48:51], 0 sc1
    s_mov_b32 s40, 0x000fffff
    s_mov_b32 s41, 0x000fffff
    v_bfe_u32 v8, v2, 4, 1
    v_mul_u32_u24 v8, 640, v8
    v_bfe_u32 v9, v2, 2, 2
    v_lshl_add_u32 v8, v9, 5, v8
    v_and_b32 v9, 1, v2
    v_lshl_add_u32 v8, v9, 4, v8
    v_bfe_u32 v9, v2, 1, 1
    v_lshl_add_u32 v8, v9, 3, v8
    v_add_u32 v121, 512, v8
    v_lshrrev_b32 v9, 5, v2
    v_mul_u32_u24 v10, 1280, v9
    v_add_u32 v105, v10, v121
    v_lshl_add_u32 v104, v9, 8, v8
    v_and_b32 v10, 31, v2
    v_lshlrev_b32 v11, 4, v9
    v_lshl_add_u32 v11, v10, 5, v11
    v_add_u32 v106, 10240, v11
    s_mul_i32 s30, s39, 81920
    s_lshl_b32 s31, s42, 3
    s_add_u32 s31, s31, s29
    s_mul_i32 s31, s31, 1280
    s_add_u32 s30, s30, s31
    v_lshlrev_b32 v11, 3, v9
    v_lshl_add_u32 v11, v10, 4, v11
    v_add_u32 v114, s30, v11
    v_lshlrev_b32 v11, 3, v10
    v_add_u32 v11, s30, v11
    v_mov_b32 v8, 0x7f000000
    v_cmp_gt_u32 vcc, 32, v2
    s_mul_i32 s30, s29, 1280
    s_add_u32 s30, s30, 147456
    v_cndmask_b32 v115, v8, v11, vcc
    v_add_u32 v120, s30, v104
    v_add_u32 v121, s30, v121
    s_waitcnt vmcnt(0)
    s_mov_b32 s72, 0
    v_readfirstlane_b32 s37, v25
    s_nop 3
    s_cmp_lg_u32 s37, 0
    s_cbranch_scc1 L_nonced_50
L_nonce_49:
    buffer_load_dword v25, off, s[48:51], 0 sc1
    s_waitcnt vmcnt(0)
    v_readfirstlane_b32 s37, v25
    s_add_u32 s72, s72, 1
    s_nop 2
    s_cmp_lg_u32 s37, 0
    s_cbranch_scc1 L_nonced_50
    s_sleep 1
    s_cmp_lt_u32 s72, 0x20000
    s_cbranch_scc1 L_nonce_49
L_nonced_50:
    s_barrier
    s_cmp_ge_u32 s29, 4
    s_cbranch_scc1 L_load_tail
    s_branch L_comp_tail
L_end:
    s_endpgm
.section .rodata,"a"
.p2align 6
.amdhsa_kernel concat_heads__ssm_conv_s5__mha_block__prompt_kernel
  .amdhsa_next_free_vgpr 256
  .amdhsa_next_free_sgpr 102
  .amdhsa_accum_offset 256
  .amdhsa_group_segment_fixed_size 0
  .amdhsa_kernarg_size 120
  .amdhsa_user_sgpr_count 2
  .amdhsa_user_sgpr_kernarg_segment_ptr 1
  .amdhsa_system_sgpr_workgroup_id_x 1
.end_amdhsa_kernel
```
